```python
import torch

def _softmax(x, axis=-1):
    return torch.softmax(x, dim=axis)
def _gelu(x):
    return torch.nn.functional.gelu(x, approximate="tanh")
def _silu(x):
    return torch.nn.functional.silu(x)
def _sigmoid(x):
    return torch.sigmoid(x)
def _layernorm(x, axis=-1, eps=1e-5):
    m = x.mean(dim=axis, keepdim=True)
    v = x.var(dim=axis, keepdim=True, unbiased=False)
    return (x - m) / torch.sqrt(v + eps)
def _scatter_add(tgt, idx, src, axis=0):
    return tgt.clone().index_add_(axis, idx, src)
def _segment_sum(src, seg, n):
    out = torch.zeros((n,) + src.shape[1:], dtype=src.dtype)
    return out.index_add_(0, seg, src)
def _pad(x, pw):
    flat = tuple(v for pair in reversed(pw) for v in pair)
    return torch.nn.functional.pad(x, flat)

kernel_name = 'parallel_sum__softmax_full_mha__glu_gated_geglu__prompt'

def setup_inputs():

    _w = (lambda a: (lambda t: t.to(torch.bfloat16) if t.is_floating_point() else t)(torch.as_tensor(a)))
    def _A_setup():
        B, S, D = 1, 2048, 576
        return {
            "x": _w((lambda *s: torch.randn(*s, dtype=torch.bfloat16) * 0.05)(B, S, D)),
            "wqkv": _w((lambda *s: torch.randn(*s, dtype=torch.bfloat16) * 0.05)(D, 3 * D)),
            "wo": _w((lambda *s: torch.randn(*s, dtype=torch.bfloat16) * 0.05)(D, D)),
        }
    _A_in = _A_setup()

    def _B_setup():
        B, S, Dm, Df = 1, 2048, 576, 4608
        return {
            "x": _w((lambda *s: torch.randn(*s, dtype=torch.bfloat16) * 0.05)(B, S, Dm)),
            "w_gate": _w((lambda *s: torch.randn(*s, dtype=torch.bfloat16) * 0.8)(Dm, Df) * (Dm ** -0.5)),
            "w_up": _w((lambda *s: torch.randn(*s, dtype=torch.bfloat16) * 0.8)(Dm, Df) * (Dm ** -0.5)),
            "w_down": _w((lambda *s: torch.randn(*s, dtype=torch.bfloat16) * 0.8)(Df, Dm) * (Df ** -0.5)),
        }
    _B_in = _B_setup()

    return {
        "A_x": _A_in["x"],
        "A_wqkv": _A_in["wqkv"],
        "A_wo": _A_in["wo"],
        "B_x": _B_in["x"],
        "B_w_gate": _B_in["w_gate"],
        "B_w_up": _B_in["w_up"],
        "B_w_down": _B_in["w_down"],
    }

def reference(A_x, A_wqkv, A_wo, B_x, B_w_gate, B_w_up, B_w_down):
    def _A_ref(x, wqkv, wo):
        B, S, D = x.shape
        H = 32; Dh = D // H
        qkv = (lambda x, *d: x.permute(*d))((x @ wqkv).reshape(B, S, 3, H, Dh), 2, 0, 3, 1, 4)
        q, k, v = qkv[0], qkv[1], qkv[2]
        scale = Dh ** -0.5
        scores = torch.einsum("bhqd,bhkd->bhqk", q, k) * scale
        p = _softmax(scores, axis=-1)
        o = torch.einsum("bhqk,bhkd->bhqd", p, v)
        return (lambda x, *d: x.permute(*d))(o, 0, 2, 1, 3).reshape(B, S, D) @ wo

    def _B_ref(x, w_gate, w_up, w_down):
        g = torch.einsum("bsd,df->bsf", x, w_gate)
        u = torch.einsum("bsd,df->bsf", x, w_up)
        h = _gelu(g) * u
        return torch.einsum("bsf,fd->bsd", h, w_down)

    x = A_x
    xn = _layernorm(x, axis=-1)
    return x + _A_ref(xn, A_wqkv, A_wo) + _B_ref(xn, B_w_gate, B_w_up, B_w_down)
```

```asm
; @launch kernel=ln_kernel grid=(256,1,1) block=(512,1,1) lds=8192
; @launch kernel=gemm1_kernel grid=(256,1,1) block=(512,1,1) lds=148480
; @launch kernel=mix_kernel grid=(768,1,1) block=(256,1,1) lds=81920
.amdgcn_target "amdgcn-amd-amdhsa--gfx950"

.text
.globl ln_kernel
.p2align 8
.type ln_kernel,@function
ln_kernel:
  s_cmp_ge_u32 s2, 256
  s_cbranch_scc1 L_k0_end
  s_load_dwordx2 s[4:5], s[0:1], 0
  s_load_dwordx2 s[6:7], s[0:1], 72
  v_readfirstlane_b32 s45, v0
  s_nop 3
  s_cmp_ge_u32 s45, 256
  s_cbranch_scc1 L_k0_aux
  v_lshrrev_b32 v1, 5, v0
  s_lshl_b32 s3, s2, 3
  v_add_u32 v1, s3, v1
  v_and_b32 v2, 31, v0
  v_mul_u32_u24 v3, 1152, v1
  v_lshl_add_u32 v3, v2, 2, v3
  v_lshrrev_b32 v4, 5, v1
  v_mul_u32_u24 v4, 36864, v4
  v_lshrrev_b32 v5, 4, v2
  v_lshl_add_u32 v4, v5, 11, v4
  v_bfe_u32 v5, v1, 4, 1
  v_lshl_add_u32 v4, v5, 10, v4
  v_bfe_u32 v5, v2, 2, 2
  v_lshl_add_u32 v4, v5, 8, v4
  v_and_b32 v5, 15, v1
  v_lshl_add_u32 v4, v5, 4, v4
  v_and_b32 v5, 3, v2
  v_lshl_add_u32 v4, v5, 2, v4
  s_waitcnt lgkmcnt(0)
  s_mov_b32 s8, s4
  s_mov_b32 s9, s5
  s_mov_b32 s10, 2359296
  s_mov_b32 s11, 0x20000
  s_mov_b32 s12, s6
  s_mov_b32 s13, s7
  s_mov_b32 s14, 2359296
  s_mov_b32 s15, 0x20000
  buffer_load_dword v8, v3, s[8:11], 0 offen offset:0
  buffer_load_dword v9, v3, s[8:11], 0 offen offset:128
  buffer_load_dword v10, v3, s[8:11], 0 offen offset:256
  buffer_load_dword v11, v3, s[8:11], 0 offen offset:384
  buffer_load_dword v12, v3, s[8:11], 0 offen offset:512
  buffer_load_dword v13, v3, s[8:11], 0 offen offset:640
  buffer_load_dword v14, v3, s[8:11], 0 offen offset:768
  buffer_load_dword v15, v3, s[8:11], 0 offen offset:896
  buffer_load_dword v16, v3, s[8:11], 0 offen offset:1024
  s_waitcnt vmcnt(8)
  v_lshlrev_b32 v20, 16, v8
  v_and_b32 v21, 0xffff0000, v8
  s_waitcnt vmcnt(7)
  v_lshlrev_b32 v22, 16, v9
  v_and_b32 v23, 0xffff0000, v9
  s_waitcnt vmcnt(6)
  v_lshlrev_b32 v24, 16, v10
  v_and_b32 v25, 0xffff0000, v10
  s_waitcnt vmcnt(5)
  v_lshlrev_b32 v26, 16, v11
  v_and_b32 v27, 0xffff0000, v11
  s_waitcnt vmcnt(4)
  v_lshlrev_b32 v28, 16, v12
  v_and_b32 v29, 0xffff0000, v12
  s_waitcnt vmcnt(3)
  v_lshlrev_b32 v30, 16, v13
  v_and_b32 v31, 0xffff0000, v13
  s_waitcnt vmcnt(2)
  v_lshlrev_b32 v32, 16, v14
  v_and_b32 v33, 0xffff0000, v14
  s_waitcnt vmcnt(1)
  v_lshlrev_b32 v34, 16, v15
  v_and_b32 v35, 0xffff0000, v15
  s_waitcnt vmcnt(0)
  v_lshlrev_b32 v36, 16, v16
  v_and_b32 v37, 0xffff0000, v16
  v_add_f32 v40, v20, v21
  v_add_f32 v41, v22, v23
  v_add_f32 v40, v40, v24
  v_add_f32 v41, v41, v25
  v_add_f32 v40, v40, v26
  v_add_f32 v41, v41, v27
  v_add_f32 v40, v40, v28
  v_add_f32 v41, v41, v29
  v_add_f32 v40, v40, v30
  v_add_f32 v41, v41, v31
  v_add_f32 v40, v40, v32
  v_add_f32 v41, v41, v33
  v_add_f32 v40, v40, v34
  v_add_f32 v41, v41, v35
  v_add_f32 v40, v40, v36
  v_add_f32 v41, v41, v37
  v_add_f32 v40, v40, v41
  s_nop 1
  v_add_f32_dpp v40, v40, v40 quad_perm:[1,0,3,2] row_mask:0xf bank_mask:0xf
  s_nop 1
  v_add_f32_dpp v40, v40, v40 quad_perm:[2,3,0,1] row_mask:0xf bank_mask:0xf
  s_nop 1
  v_add_f32_dpp v40, v40, v40 row_half_mirror row_mask:0xf bank_mask:0xf
  s_nop 1
  v_add_f32_dpp v40, v40, v40 row_mirror row_mask:0xf bank_mask:0xf
  s_nop 0
  v_mov_b32 v42, v40
  s_nop 1
  v_permlane16_swap_b32 v40, v42
  s_nop 0
  v_add_f32 v40, v40, v42
  v_mul_f32 v40, 0x3ae38e39, v40
  v_sub_f32 v43, v20, v40
  v_mul_f32 v44, v43, v43
  v_sub_f32 v43, v21, v40
  v_mul_f32 v45, v43, v43
  v_sub_f32 v43, v22, v40
  v_sub_f32 v46, v23, v40
  v_fmac_f32 v44, v43, v43
  v_fmac_f32 v45, v46, v46
  v_sub_f32 v43, v24, v40
  v_sub_f32 v46, v25, v40
  v_fmac_f32 v44, v43, v43
  v_fmac_f32 v45, v46, v46
  v_sub_f32 v43, v26, v40
  v_sub_f32 v46, v27, v40
  v_fmac_f32 v44, v43, v43
  v_fmac_f32 v45, v46, v46
  v_sub_f32 v43, v28, v40
  v_sub_f32 v46, v29, v40
  v_fmac_f32 v44, v43, v43
  v_fmac_f32 v45, v46, v46
  v_sub_f32 v43, v30, v40
  v_sub_f32 v46, v31, v40
  v_fmac_f32 v44, v43, v43
  v_fmac_f32 v45, v46, v46
  v_sub_f32 v43, v32, v40
  v_sub_f32 v46, v33, v40
  v_fmac_f32 v44, v43, v43
  v_fmac_f32 v45, v46, v46
  v_sub_f32 v43, v34, v40
  v_sub_f32 v46, v35, v40
  v_fmac_f32 v44, v43, v43
  v_fmac_f32 v45, v46, v46
  v_sub_f32 v43, v36, v40
  v_sub_f32 v46, v37, v40
  v_fmac_f32 v44, v43, v43
  v_fmac_f32 v45, v46, v46
  v_add_f32 v44, v44, v45
  s_nop 1
  v_add_f32_dpp v44, v44, v44 quad_perm:[1,0,3,2] row_mask:0xf bank_mask:0xf
  s_nop 1
  v_add_f32_dpp v44, v44, v44 quad_perm:[2,3,0,1] row_mask:0xf bank_mask:0xf
  s_nop 1
  v_add_f32_dpp v44, v44, v44 row_half_mirror row_mask:0xf bank_mask:0xf
  s_nop 1
  v_add_f32_dpp v44, v44, v44 row_mirror row_mask:0xf bank_mask:0xf
  s_nop 0
  v_mov_b32 v42, v44
  s_nop 1
  v_permlane16_swap_b32 v44, v42
  s_nop 0
  v_add_f32 v44, v44, v42
  v_mul_f32 v44, 0x3ae38e39, v44
  v_cvt_pk_bf16_f32 v45, v40, v44
  v_lshlrev_b32 v40, 16, v45
  v_and_b32 v44, 0xffff0000, v45
  v_add_f32 v44, 0x3727c5ac, v44
  v_cvt_pk_bf16_f32 v44, v44, v44
  v_and_b32 v44, 0xffff0000, v44
  v_sqrt_f32 v44, v44
  s_nop 0
  v_cvt_pk_bf16_f32 v44, v44, v44
  v_and_b32 v44, 0xffff0000, v44
  v_rcp_f32 v44, v44
  v_sub_f32 v20, v20, v40
  v_sub_f32 v21, v21, v40
  v_cvt_pk_bf16_f32 v8, v20, v21
  v_sub_f32 v22, v22, v40
  v_sub_f32 v23, v23, v40
  v_cvt_pk_bf16_f32 v9, v22, v23
  v_sub_f32 v24, v24, v40
  v_sub_f32 v25, v25, v40
  v_cvt_pk_bf16_f32 v10, v24, v25
  v_sub_f32 v26, v26, v40
  v_sub_f32 v27, v27, v40
  v_cvt_pk_bf16_f32 v11, v26, v27
  v_sub_f32 v28, v28, v40
  v_sub_f32 v29, v29, v40
  v_cvt_pk_bf16_f32 v12, v28, v29
  v_sub_f32 v30, v30, v40
  v_sub_f32 v31, v31, v40
  v_cvt_pk_bf16_f32 v13, v30, v31
  v_sub_f32 v32, v32, v40
  v_sub_f32 v33, v33, v40
  v_cvt_pk_bf16_f32 v14, v32, v33
  v_sub_f32 v34, v34, v40
  v_sub_f32 v35, v35, v40
  v_cvt_pk_bf16_f32 v15, v34, v35
  v_sub_f32 v36, v36, v40
  v_sub_f32 v37, v37, v40
  v_cvt_pk_bf16_f32 v16, v36, v37
  v_lshlrev_b32 v20, 16, v8
  v_and_b32 v21, 0xffff0000, v8
  v_mul_f32 v20, v20, v44
  v_mul_f32 v21, v21, v44
  v_cvt_pk_bf16_f32 v8, v20, v21
  s_mov_b32 s16, 0
  buffer_store_dword v8, v4, s[12:15], s16 offen
  v_lshlrev_b32 v22, 16, v9
  v_and_b32 v23, 0xffff0000, v9
  v_mul_f32 v22, v22, v44
  v_mul_f32 v23, v23, v44
  v_cvt_pk_bf16_f32 v9, v22, v23
  s_mov_b32 s16, 4096
  buffer_store_dword v9, v4, s[12:15], s16 offen
  v_lshlrev_b32 v24, 16, v10
  v_and_b32 v25, 0xffff0000, v10
  v_mul_f32 v24, v24, v44
  v_mul_f32 v25, v25, v44
  v_cvt_pk_bf16_f32 v10, v24, v25
  s_mov_b32 s16, 8192
  buffer_store_dword v10, v4, s[12:15], s16 offen
  v_lshlrev_b32 v26, 16, v11
  v_and_b32 v27, 0xffff0000, v11
  v_mul_f32 v26, v26, v44
  v_mul_f32 v27, v27, v44
  v_cvt_pk_bf16_f32 v11, v26, v27
  s_mov_b32 s16, 12288
  buffer_store_dword v11, v4, s[12:15], s16 offen
  v_lshlrev_b32 v28, 16, v12
  v_and_b32 v29, 0xffff0000, v12
  v_mul_f32 v28, v28, v44
  v_mul_f32 v29, v29, v44
  v_cvt_pk_bf16_f32 v12, v28, v29
  s_mov_b32 s16, 16384
  buffer_store_dword v12, v4, s[12:15], s16 offen
  v_lshlrev_b32 v30, 16, v13
  v_and_b32 v31, 0xffff0000, v13
  v_mul_f32 v30, v30, v44
  v_mul_f32 v31, v31, v44
  v_cvt_pk_bf16_f32 v13, v30, v31
  s_mov_b32 s16, 20480
  buffer_store_dword v13, v4, s[12:15], s16 offen
  v_lshlrev_b32 v32, 16, v14
  v_and_b32 v33, 0xffff0000, v14
  v_mul_f32 v32, v32, v44
  v_mul_f32 v33, v33, v44
  v_cvt_pk_bf16_f32 v14, v32, v33
  s_mov_b32 s16, 24576
  buffer_store_dword v14, v4, s[12:15], s16 offen
  v_lshlrev_b32 v34, 16, v15
  v_and_b32 v35, 0xffff0000, v15
  v_mul_f32 v34, v34, v44
  v_mul_f32 v35, v35, v44
  v_cvt_pk_bf16_f32 v15, v34, v35
  s_mov_b32 s16, 28672
  buffer_store_dword v15, v4, s[12:15], s16 offen
  v_lshlrev_b32 v36, 16, v16
  v_and_b32 v37, 0xffff0000, v16
  v_mul_f32 v36, v36, v44
  v_mul_f32 v37, v37, v44
  v_cvt_pk_bf16_f32 v16, v36, v37
  s_mov_b32 s16, 32768
  buffer_store_dword v16, v4, s[12:15], s16 offen
  s_branch L_k0_done
L_k0_aux:
  v_subrev_u32 v0, 256, v0
  s_nop 0
  s_load_dwordx2 s[20:21], s[0:1], 32
  s_load_dwordx2 s[24:25], s[0:1], 40
  s_load_dwordx2 s[28:29], s[0:1], 8
  s_load_dwordx2 s[36:37], s[0:1], 16
  v_readfirstlane_b32 s34, v0
  v_and_b32 v53, 63, v0
  s_lshr_b32 s34, s34, 6
  s_lshl_b32 s35, s2, 2
  s_add_u32 s35, s35, s34
  s_mul_i32 s40, s35, 3641
  s_lshr_b32 s40, s40, 16
  s_mul_i32 s41, s40, 18
  s_sub_u32 s41, s35, s41
  v_lshrrev_b32 v54, 2, v53
  v_mul_u32_u24 v55, 1152, v54
  v_bfe_u32 v64, v54, 2, 1
  v_add_u32 v64, 0, v64
  v_lshlrev_b32 v64, 2, v64
  v_lshrrev_b32 v65, 3, v54
  v_lshlrev_b32 v65, 1, v65
  v_add_u32 v64, v64, v65
  v_bfe_u32 v65, v54, 1, 1
  v_add_u32 v64, v64, v65
  v_mul_u32_u24 v64, 18, v64
  v_and_b32 v65, 1, v54
  v_add_u32 v64, v64, v65
  v_add_u32 v64, 16, v64
  v_mul_u32_u24 v64, 1152, v64
  s_cmp_lt_u32 s40, 16
  s_cselect_b64 vcc, -1, 0
  v_cndmask_b32 v55, v64, v55, vcc
  v_and_b32 v65, 3, v53
  v_lshl_add_u32 v55, v65, 4, v55
  v_mul_u32_u24 v70, 1152, v54
  v_bfe_u32 v64, v54, 2, 1
  v_add_u32 v64, 2, v64
  v_lshlrev_b32 v64, 2, v64
  v_lshrrev_b32 v65, 3, v54
  v_lshlrev_b32 v65, 1, v65
  v_add_u32 v64, v64, v65
  v_bfe_u32 v65, v54, 1, 1
  v_add_u32 v64, v64, v65
  v_mul_u32_u24 v64, 18, v64
  v_and_b32 v65, 1, v54
  v_add_u32 v64, v64, v65
  v_add_u32 v64, 16, v64
  v_mul_u32_u24 v64, 1152, v64
  s_cmp_lt_u32 s40, 16
  s_cselect_b64 vcc, -1, 0
  v_cndmask_b32 v70, v64, v70, vcc
  v_and_b32 v65, 3, v53
  v_lshl_add_u32 v70, v65, 4, v70
  s_mul_i32 s42, s40, 41472
  s_sub_u32 s43, s40, 16
  s_mul_i32 s43, s43, 331776
  s_cmp_lt_u32 s40, 16
  s_cselect_b32 s42, s42, s43
  s_cselect_b32 s44, 20736, 0
  s_lshl_b32 s43, s41, 6
  s_add_u32 s42, s42, s43
  s_cmp_lt_u32 s35, 324
  s_cselect_b32 s42, s42, 0x7f000000
  s_add_u32 s44, s44, s42
  s_waitcnt lgkmcnt(0)
  s_mov_b32 s38, 663552
  s_mov_b32 s39, 0x20000
  s_lshl_b32 s43, s34, 11
  s_mov_b32 m0, s43
  s_nop 0
  buffer_load_dwordx4 v55, s[36:39], s42 offen lds
  s_add_u32 m0, s43, 1024
  s_nop 0
  buffer_load_dwordx4 v70, s[36:39], s44 offen lds
  s_mov_b32 s22, 5308416
  s_mov_b32 s23, 0x20000
  s_mov_b32 s26, 5308416
  s_mov_b32 s27, 0x20000
  s_mov_b32 s30, 1990656
  s_mov_b32 s31, 0x20000
  s_and_b32 s17, s2, 7
  s_bfe_u32 s18, s2, 0x20003
  s_lshl_b32 s18, s18, 3
  s_add_u32 s17, s17, s18
  s_lshr_b32 s18, s2, 5
  s_mul_i32 s18, s18, 72
  s_mul_i32 s19, s17, 5
  s_lshl_b32 s32, s17, 2
  s_add_u32 s32, s32, 16
  s_cmp_lt_u32 s17, 16
  s_cselect_b32 s19, s19, s32
  s_lshl_b32 s19, s19, 6
  s_mul_i32 s32, s18, 9216
  s_add_u32 s19, s19, s32
  s_lshl_b32 s33, s17, 6
  s_mul_i32 s32, s18, 3456
  s_add_u32 s33, s33, s32
  v_add_u32 v50, 0, v0
  v_lshrrev_b32 v51, 3, v50
  v_mul_u32_u24 v51, 9216, v51
  v_and_b32 v52, 7, v50
  v_lshl_add_u32 v51, v52, 4, v51
  buffer_load_dwordx4 v[56:59], v51, s[20:23], s19 offen
  buffer_load_dwordx4 v[60:63], v51, s[24:27], s19 offen
  v_add_u32 v50, 256, v0
  v_lshrrev_b32 v51, 3, v50
  v_mul_u32_u24 v51, 9216, v51
  v_and_b32 v52, 7, v50
  v_lshl_add_u32 v51, v52, 4, v51
  buffer_load_dwordx4 v[56:59], v51, s[20:23], s19 offen
  buffer_load_dwordx4 v[60:63], v51, s[24:27], s19 offen
  v_add_u32 v50, 512, v0
  v_lshrrev_b32 v51, 3, v50
  v_mul_u32_u24 v51, 9216, v51
  v_and_b32 v52, 7, v50
  v_lshl_add_u32 v51, v52, 4, v51
  v_cmp_gt_u32 vcc, 576, v50
  v_mov_b32 v52, 0x7f000000
  s_nop 0
  v_cndmask_b32 v51, v52, v51, vcc
  buffer_load_dwordx4 v[56:59], v51, s[20:23], s19 offen
  buffer_load_dwordx4 v[60:63], v51, s[24:27], s19 offen
  v_add_u32 v50, 0, v0
  v_lshrrev_b32 v51, 2, v50
  v_mul_u32_u24 v51, 3456, v51
  v_and_b32 v52, 3, v50
  v_lshl_add_u32 v51, v52, 4, v51
  buffer_load_dwordx4 v[56:59], v51, s[28:31], s33 offen
  v_add_u32 v50, 256, v0
  v_lshrrev_b32 v51, 2, v50
  v_mul_u32_u24 v51, 3456, v51
  v_and_b32 v52, 3, v50
  v_lshl_add_u32 v51, v52, 4, v51
  v_cmp_gt_u32 vcc, 288, v50
  v_mov_b32 v52, 0x7f000000
  s_nop 0
  v_cndmask_b32 v51, v52, v51, vcc
  buffer_load_dwordx4 v[56:59], v51, s[28:31], s33 offen
  s_cmp_lt_u32 s2, 3
  s_cbranch_scc0 L_k0_noflg
  s_add_u32 s52, s6, 50216960
  s_addc_u32 s53, s7, 0
  s_mov_b32 s54, 0x3000
  s_mov_b32 s55, 0x20000
  s_lshl_b32 s56, s2, 12
  v_lshlrev_b32 v50, 4, v0
  v_mov_b32 v74, 0
  v_mov_b32 v75, 0
  v_mov_b32 v76, 0
  v_mov_b32 v77, 0
  buffer_store_dwordx4 v[74:77], v50, s[52:55], s56 offen
L_k0_noflg:
  v_lshrrev_b32 v54, 5, v53
  v_lshlrev_b32 v54, 10, v54
  v_bfe_u32 v55, v53, 4, 1
  v_lshl_add_u32 v54, v55, 8, v54
  v_bfe_u32 v55, v53, 2, 2
  v_lshl_add_u32 v54, v55, 6, v54
  v_and_b32 v55, 3, v53
  v_lshl_add_u32 v54, v55, 3, v54
  v_add_u32 v54, s43, v54
  v_lshlrev_b32 v55, 4, v53
  s_mul_i32 s42, s40, 36
  s_lshl_b32 s44, s41, 1
  s_add_u32 s42, s42, s44
  s_lshl_b32 s42, s42, 10
  s_cmp_lt_u32 s35, 324
  s_cselect_b32 s42, s42, 0x7f000000
  s_add_u32 s36, s6, 49545216
  s_addc_u32 s37, s7, 0
  s_mov_b32 s38, 663552
  s_mov_b32 s39, 0x20000
  s_waitcnt vmcnt(8)
  ds_read_b64_tr_b16 v[66:67], v54 offset:0
  ds_read_b64_tr_b16 v[68:69], v54 offset:512
  ds_read_b64_tr_b16 v[70:71], v54 offset:32
  ds_read_b64_tr_b16 v[72:73], v54 offset:544
  s_waitcnt lgkmcnt(0)
  buffer_store_dwordx4 v[66:69], v55, s[36:39], s42 offen
  buffer_store_dwordx4 v[70:73], v55, s[36:39], s42 offen offset:1024
L_k0_done:
L_k0_end:
  s_endpgm

.section .rodata,"a"
.p2align 6
.amdhsa_kernel ln_kernel
  .amdhsa_next_free_vgpr 80
  .amdhsa_next_free_sgpr 100
  .amdhsa_accum_offset 80
  .amdhsa_group_segment_fixed_size 0
  .amdhsa_kernarg_size 80
  .amdhsa_user_sgpr_count 2
  .amdhsa_user_sgpr_kernarg_segment_ptr 1
  .amdhsa_system_sgpr_workgroup_id_x 1
.end_amdhsa_kernel

.text
.globl gemm1_kernel
.p2align 8
.type gemm1_kernel,@function
gemm1_kernel:
  s_cmp_ge_u32 s2, 256
  s_cbranch_scc1 L_k1_end
  s_load_dwordx2 s[4:5], s[0:1], 72
  s_load_dwordx2 s[6:7], s[0:1], 8
  s_load_dwordx2 s[8:9], s[0:1], 32
  s_load_dwordx2 s[10:11], s[0:1], 40
  s_load_dwordx2 s[58:59], s[0:1], 48
  v_readfirstlane_b32 s32, v0
  v_and_b32 v0, 63, v0
  s_lshr_b32 s32, s32, 6
  v_lshlrev_b32 v2, 4, v0
  v_lshrrev_b32 v12, 2, v0
  v_bfe_u32 v13, v0, 1, 1
  v_bfe_u32 v14, v0, 5, 1
  v_xor_b32 v13, v13, v14
  v_lshlrev_b32 v13, 5, v13
  v_and_b32 v14, 1, v0
  v_lshl_add_u32 v13, v14, 4, v13
  v_mul_u32_u24 v3, 3456, v12
  v_add_u32 v3, v3, v13
  v_mul_u32_u24 v4, 9216, v12
  v_add_u32 v4, v4, v13
  v_mov_b32 v5, v4
  v_bfe_u32 v12, v0, 4, 1
  v_mul_u32_u24 v13, 544, v12
  v_bfe_u32 v14, v0, 2, 2
  v_lshl_add_u32 v13, v14, 6, v13
  v_and_b32 v14, 3, v0
  v_lshl_add_u32 v11, v14, 3, v13
  v_bfe_u32 v12, v0, 4, 1
  v_lshlrev_b32 v12, 9, v12
  v_and_b32 v13, 15, v0
  v_lshl_add_u32 v12, v13, 4, v12
  v_lshrrev_b32 v13, 5, v0
  v_lshl_add_u32 v1, v13, 3, v12
  v_lshrrev_b32 v7, 5, v0
  v_lshlrev_b32 v7, 11, v7
  v_add_u32 v7, v7, v11
  v_add_u32 v7, 0, v7
  v_xor_b32 v8, 32, v7
  v_add_u32 v9, 0x10000, v7
  v_add_u32 v10, 0x10000, v8
  v_lshrrev_b32 v12, 5, v0
  v_lshlrev_b32 v12, 11, v12
  v_add_u32 v12, v12, v11
  v_add_u32 v12, 73728, v12
  v_xor_b32 v13, 32, v12
  v_add_u32 v14, 0x10000, v12
  v_add_u32 v15, 0x10000, v13
  v_mov_b32 v6, 0xbdd2d3e8
  s_and_b32 s47, s2, 7
  s_lshr_b32 s42, s2, 3
  s_and_b32 s42, s42, 3
  s_lshl_b32 s42, s42, 3
  s_add_u32 s47, s47, s42
  s_lshr_b32 s46, s2, 5
  s_lshl_b32 s33, s46, 3
  s_add_u32 s33, s33, s32
  s_mul_i32 s37, s47, 5
  s_lshl_b32 s42, s47, 2
  s_add_u32 s42, s42, 16
  s_cmp_lt_u32 s47, 16
  s_cselect_b32 s37, s37, s42
  s_movk_i32 s52, 128
  s_movk_i32 s53, 192
  s_movk_i32 s54, 256
  s_movk_i32 s55, 2048
  s_movk_i32 s56, 2048
  s_mov_b32 s36, s47
  s_mov_b32 s35, 0
  s_mul_i32 s38, s33, 288
  s_lshl_b32 s42, s37, 1
  s_add_u32 s38, s38, s42
  s_lshl_b32 s38, s38, 10
  s_lshl_b32 s37, s37, 6
  s_lshr_b32 s42, s32, 1
  s_mul_i32 s42, s42, 147456
  s_add_u32 s37, s37, s42
  s_lshl_b32 s39, s32, 10
  s_lshl_b32 s40, s36, 6
  s_mul_i32 s42, s32, 55296
  s_add_u32 s40, s40, s42
  s_waitcnt lgkmcnt(0)
  s_mov_b32 s12, s4
  s_mov_b32 s13, s5
  s_mov_b32 s14, 2359296
  s_mov_b32 s15, 0x20000
  s_and_b32 s42, s32, 1
  s_cmp_eq_u32 s42, 0
  s_cselect_b32 s28, s8, s10
  s_cselect_b32 s29, s9, s11
  s_mov_b32 s30, 5308416
  s_mov_b32 s31, 0x20000
  s_mov_b32 s48, s6
  s_mov_b32 s49, s7
  s_mov_b32 s50, 1990656
  s_mov_b32 s51, 0x20000
  s_mov_b32 s16, s6
  s_mov_b32 s17, s7
  s_mov_b32 s18, 1990656
  s_mov_b32 s19, 0x20000
  s_add_u32 s20, s4, 11796480
  s_addc_u32 s21, s5, 0
  s_mov_b32 s22, 18874368
  s_mov_b32 s23, 0x20000
  s_add_u32 s24, s4, 2359296
  s_addc_u32 s25, s5, 0
  s_mov_b32 s26, 7077888
  s_mov_b32 s27, 0x20000
  s_mul_i32 s45, s33, 36864
  s_add_u32 m0, s39, 0
  s_add_u32 s42, s37, 0
  buffer_load_dwordx4 v4, s[28:31], s42 offen lds
  s_add_u32 m0, s39, 73728
  s_add_u32 s42, s37, 64
  buffer_load_dwordx4 v4, s[28:31], s42 offen lds
  s_add_u32 m0, s39, 8192
  s_add_u32 s42, s37, 589824
  buffer_load_dwordx4 v4, s[28:31], s42 offen lds
  s_add_u32 m0, s39, 81920
  s_add_u32 s42, s37, 589888
  buffer_load_dwordx4 v4, s[28:31], s42 offen lds
  buffer_load_dwordx4 a[0:3], v2, s[12:15], s45 offen offset:0
  buffer_load_dwordx4 a[4:7], v2, s[12:15], s45 offen offset:1024
  buffer_load_dwordx4 a[8:11], v2, s[12:15], s45 offen offset:2048
  buffer_load_dwordx4 a[12:15], v2, s[12:15], s45 offen offset:3072
  s_add_u32 s45, s45, 4096
  buffer_load_dwordx4 a[16:19], v2, s[12:15], s45 offen offset:0
  buffer_load_dwordx4 a[20:23], v2, s[12:15], s45 offen offset:1024
  buffer_load_dwordx4 a[24:27], v2, s[12:15], s45 offen offset:2048
  buffer_load_dwordx4 a[28:31], v2, s[12:15], s45 offen offset:3072
  s_waitcnt vmcnt(10)
  s_barrier
  ds_read_b64_tr_b16 v[80:81], v7 offset:0
  ds_read_b64_tr_b16 v[82:83], v7 offset:256
  ds_read_b64_tr_b16 v[84:85], v8 offset:0
  ds_read_b64_tr_b16 v[86:87], v8 offset:256
  ds_read_b64_tr_b16 v[88:89], v7 offset:1024
  ds_read_b64_tr_b16 v[90:91], v7 offset:1280
  ds_read_b64_tr_b16 v[92:93], v8 offset:1024
  ds_read_b64_tr_b16 v[94:95], v8 offset:1280
  s_waitcnt vmcnt(8)
  s_barrier
  s_waitcnt vmcnt(7)
  s_waitcnt vmcnt(6)
  s_waitcnt lgkmcnt(6)
  v_mfma_f32_16x16x32_bf16 v[16:19], v[80:83], a[0:3], 0
  ds_read_b64_tr_b16 v[96:97], v12 offset:0
  v_mfma_f32_16x16x32_bf16 v[20:23], v[80:83], a[4:7], 0
  ds_read_b64_tr_b16 v[98:99], v12 offset:256
  s_waitcnt lgkmcnt(6)
  v_mfma_f32_16x16x32_bf16 v[24:27], v[84:87], a[0:3], 0
  s_add_u32 m0, s39, 16384
  s_add_u32 s42, s37, 1179648
  buffer_load_dwordx4 v4, s[28:31], s42 offen lds
  ds_read_b64_tr_b16 v[100:101], v13 offset:0
  v_mfma_f32_16x16x32_bf16 v[28:31], v[84:87], a[4:7], 0
  ds_read_b64_tr_b16 v[102:103], v13 offset:256
  s_waitcnt lgkmcnt(6)
  v_mfma_f32_16x16x32_bf16 v[32:35], v[88:91], a[0:3], 0
  ds_read_b64_tr_b16 v[104:105], v12 offset:1024
  v_mfma_f32_16x16x32_bf16 v[36:39], v[88:91], a[4:7], 0
  ds_read_b64_tr_b16 v[106:107], v12 offset:1280
  s_waitcnt lgkmcnt(6)
  v_mfma_f32_16x16x32_bf16 v[40:43], v[92:95], a[0:3], 0
  s_add_u32 m0, s39, 90112
  s_add_u32 s42, s37, 1179712
  buffer_load_dwordx4 v4, s[28:31], s42 offen lds
  ds_read_b64_tr_b16 v[108:109], v13 offset:1024
  v_mfma_f32_16x16x32_bf16 v[44:47], v[92:95], a[4:7], 0
  ds_read_b64_tr_b16 v[110:111], v13 offset:1280
  s_waitcnt lgkmcnt(6)
  v_mfma_f32_16x16x32_bf16 v[48:51], v[96:99], a[0:3], 0
  ds_read_b64_tr_b16 v[80:81], v7 offset:4096
  v_mfma_f32_16x16x32_bf16 v[52:55], v[96:99], a[4:7], 0
  ds_read_b64_tr_b16 v[82:83], v7 offset:4352
  s_waitcnt lgkmcnt(6)
  v_mfma_f32_16x16x32_bf16 v[56:59], v[100:103], a[0:3], 0
  s_add_u32 s45, s45, 4096
  buffer_load_dwordx4 a[32:35], v2, s[12:15], s45 offen offset:0
  ds_read_b64_tr_b16 v[84:85], v8 offset:4096
  v_mfma_f32_16x16x32_bf16 v[60:63], v[100:103], a[4:7], 0
  ds_read_b64_tr_b16 v[86:87], v8 offset:4352
  s_waitcnt lgkmcnt(6)
  v_mfma_f32_16x16x32_bf16 v[64:67], v[104:107], a[0:3], 0
  ds_read_b64_tr_b16 v[88:89], v7 offset:5120
  v_mfma_f32_16x16x32_bf16 v[68:71], v[104:107], a[4:7], 0
  ds_read_b64_tr_b16 v[90:91], v7 offset:5376
  s_waitcnt lgkmcnt(6)
  v_mfma_f32_16x16x32_bf16 v[72:75], v[108:111], a[0:3], 0
  buffer_load_dwordx4 a[36:39], v2, s[12:15], s45 offen offset:1024
  ds_read_b64_tr_b16 v[92:93], v8 offset:5120
  v_mfma_f32_16x16x32_bf16 v[76:79], v[108:111], a[4:7], 0
  ds_read_b64_tr_b16 v[94:95], v8 offset:5376
  s_waitcnt vmcnt(9)
  s_waitcnt vmcnt(8)
  s_waitcnt lgkmcnt(6)
  v_mfma_f32_16x16x32_bf16 v[16:19], v[80:83], a[8:11], v[16:19]
  ds_read_b64_tr_b16 v[96:97], v12 offset:4096
  v_mfma_f32_16x16x32_bf16 v[20:23], v[80:83], a[12:15], v[20:23]
  ds_read_b64_tr_b16 v[98:99], v12 offset:4352
  s_waitcnt lgkmcnt(6)
  v_mfma_f32_16x16x32_bf16 v[24:27], v[84:87], a[8:11], v[24:27]
  buffer_load_dwordx4 a[40:43], v2, s[12:15], s45 offen offset:2048
  ds_read_b64_tr_b16 v[100:101], v13 offset:4096
  v_mfma_f32_16x16x32_bf16 v[28:31], v[84:87], a[12:15], v[28:31]
  ds_read_b64_tr_b16 v[102:103], v13 offset:4352
  s_waitcnt lgkmcnt(6)
  v_mfma_f32_16x16x32_bf16 v[32:35], v[88:91], a[8:11], v[32:35]
  ds_read_b64_tr_b16 v[104:105], v12 offset:5120
  v_mfma_f32_16x16x32_bf16 v[36:39], v[88:91], a[12:15], v[36:39]
  ds_read_b64_tr_b16 v[106:107], v12 offset:5376
  s_waitcnt lgkmcnt(6)
  v_mfma_f32_16x16x32_bf16 v[40:43], v[92:95], a[8:11], v[40:43]
  buffer_load_dwordx4 a[44:47], v2, s[12:15], s45 offen offset:3072
  ds_read_b64_tr_b16 v[108:109], v13 offset:5120
  v_mfma_f32_16x16x32_bf16 v[44:47], v[92:95], a[12:15], v[44:47]
  ds_read_b64_tr_b16 v[110:111], v13 offset:5376
  s_waitcnt lgkmcnt(6)
  v_mfma_f32_16x16x32_bf16 v[48:51], v[96:99], a[8:11], v[48:51]
  ds_read_b64_tr_b16 v[80:81], v7 offset:8192
  v_mfma_f32_16x16x32_bf16 v[52:55], v[96:99], a[12:15], v[52:55]
  ds_read_b64_tr_b16 v[82:83], v7 offset:8448
  s_waitcnt lgkmcnt(6)
  v_mfma_f32_16x16x32_bf16 v[56:59], v[100:103], a[8:11], v[56:59]
  ds_read_b64_tr_b16 v[84:85], v8 offset:8192
  v_mfma_f32_16x16x32_bf16 v[60:63], v[100:103], a[12:15], v[60:63]
  ds_read_b64_tr_b16 v[86:87], v8 offset:8448
  s_waitcnt lgkmcnt(6)
  v_mfma_f32_16x16x32_bf16 v[64:67], v[104:107], a[8:11], v[64:67]
  ds_read_b64_tr_b16 v[88:89], v7 offset:9216
  v_mfma_f32_16x16x32_bf16 v[68:71], v[104:107], a[12:15], v[68:71]
  ds_read_b64_tr_b16 v[90:91], v7 offset:9472
  s_waitcnt lgkmcnt(6)
  v_mfma_f32_16x16x32_bf16 v[72:75], v[108:111], a[8:11], v[72:75]
  ds_read_b64_tr_b16 v[92:93], v8 offset:9216
  v_mfma_f32_16x16x32_bf16 v[76:79], v[108:111], a[12:15], v[76:79]
  ds_read_b64_tr_b16 v[94:95], v8 offset:9472
  s_waitcnt vmcnt(4)
  s_barrier
  s_waitcnt lgkmcnt(6)
  v_mfma_f32_16x16x32_bf16 v[16:19], v[80:83], a[16:19], v[16:19]
  ds_read_b64_tr_b16 v[96:97], v12 offset:8192
  v_mfma_f32_16x16x32_bf16 v[20:23], v[80:83], a[20:23], v[20:23]
  ds_read_b64_tr_b16 v[98:99], v12 offset:8448
  s_waitcnt lgkmcnt(6)
  v_mfma_f32_16x16x32_bf16 v[24:27], v[84:87], a[16:19], v[24:27]
  s_add_u32 m0, s39, 24576
  s_add_u32 s42, s37, 1769472
  buffer_load_dwordx4 v4, s[28:31], s42 offen lds
  ds_read_b64_tr_b16 v[100:101], v13 offset:8192
  v_mfma_f32_16x16x32_bf16 v[28:31], v[84:87], a[20:23], v[28:31]
  ds_read_b64_tr_b16 v[102:103], v13 offset:8448
  s_waitcnt lgkmcnt(6)
  v_mfma_f32_16x16x32_bf16 v[32:35], v[88:91], a[16:19], v[32:35]
  ds_read_b64_tr_b16 v[104:105], v12 offset:9216
  v_mfma_f32_16x16x32_bf16 v[36:39], v[88:91], a[20:23], v[36:39]
  ds_read_b64_tr_b16 v[106:107], v12 offset:9472
  s_waitcnt lgkmcnt(6)
  v_mfma_f32_16x16x32_bf16 v[40:43], v[92:95], a[16:19], v[40:43]
  s_add_u32 m0, s39, 98304
  s_add_u32 s42, s37, 1769536
  buffer_load_dwordx4 v4, s[28:31], s42 offen lds
  ds_read_b64_tr_b16 v[108:109], v13 offset:9216
  v_mfma_f32_16x16x32_bf16 v[44:47], v[92:95], a[20:23], v[44:47]
  ds_read_b64_tr_b16 v[110:111], v13 offset:9472
  s_waitcnt lgkmcnt(6)
  v_mfma_f32_16x16x32_bf16 v[48:51], v[96:99], a[16:19], v[48:51]
  ds_read_b64_tr_b16 v[80:81], v7 offset:12288
  v_mfma_f32_16x16x32_bf16 v[52:55], v[96:99], a[20:23], v[52:55]
  ds_read_b64_tr_b16 v[82:83], v7 offset:12544
  s_waitcnt lgkmcnt(6)
  v_mfma_f32_16x16x32_bf16 v[56:59], v[100:103], a[16:19], v[56:59]
  s_add_u32 s45, s45, 4096
  buffer_load_dwordx4 a[48:51], v2, s[12:15], s45 offen offset:0
  ds_read_b64_tr_b16 v[84:85], v8 offset:12288
  v_mfma_f32_16x16x32_bf16 v[60:63], v[100:103], a[20:23], v[60:63]
  ds_read_b64_tr_b16 v[86:87], v8 offset:12544
  s_waitcnt lgkmcnt(6)
  v_mfma_f32_16x16x32_bf16 v[64:67], v[104:107], a[16:19], v[64:67]
  ds_read_b64_tr_b16 v[88:89], v7 offset:13312
  v_mfma_f32_16x16x32_bf16 v[68:71], v[104:107], a[20:23], v[68:71]
  ds_read_b64_tr_b16 v[90:91], v7 offset:13568
  s_waitcnt lgkmcnt(6)
  v_mfma_f32_16x16x32_bf16 v[72:75], v[108:111], a[16:19], v[72:75]
  buffer_load_dwordx4 a[52:55], v2, s[12:15], s45 offen offset:1024
  ds_read_b64_tr_b16 v[92:93], v8 offset:13312
  v_mfma_f32_16x16x32_bf16 v[76:79], v[108:111], a[20:23], v[76:79]
  ds_read_b64_tr_b16 v[94:95], v8 offset:13568
  s_waitcnt lgkmcnt(6)
  v_mfma_f32_16x16x32_bf16 v[16:19], v[80:83], a[24:27], v[16:19]
  ds_read_b64_tr_b16 v[96:97], v12 offset:12288
  v_mfma_f32_16x16x32_bf16 v[20:23], v[80:83], a[28:31], v[20:23]
  ds_read_b64_tr_b16 v[98:99], v12 offset:12544
  s_waitcnt lgkmcnt(6)
  v_mfma_f32_16x16x32_bf16 v[24:27], v[84:87], a[24:27], v[24:27]
  buffer_load_dwordx4 a[56:59], v2, s[12:15], s45 offen offset:2048
  ds_read_b64_tr_b16 v[100:101], v13 offset:12288
  v_mfma_f32_16x16x32_bf16 v[28:31], v[84:87], a[28:31], v[28:31]
  ds_read_b64_tr_b16 v[102:103], v13 offset:12544
  s_waitcnt lgkmcnt(6)
  v_mfma_f32_16x16x32_bf16 v[32:35], v[88:91], a[24:27], v[32:35]
  ds_read_b64_tr_b16 v[104:105], v12 offset:13312
  v_mfma_f32_16x16x32_bf16 v[36:39], v[88:91], a[28:31], v[36:39]
  ds_read_b64_tr_b16 v[106:107], v12 offset:13568
  s_waitcnt lgkmcnt(6)
  v_mfma_f32_16x16x32_bf16 v[40:43], v[92:95], a[24:27], v[40:43]
  buffer_load_dwordx4 a[60:63], v2, s[12:15], s45 offen offset:3072
  ds_read_b64_tr_b16 v[108:109], v13 offset:13312
  v_mfma_f32_16x16x32_bf16 v[44:47], v[92:95], a[28:31], v[44:47]
  ds_read_b64_tr_b16 v[110:111], v13 offset:13568
  s_waitcnt lgkmcnt(6)
  v_mfma_f32_16x16x32_bf16 v[48:51], v[96:99], a[24:27], v[48:51]
  ds_read_b64_tr_b16 v[80:81], v7 offset:16384
  v_mfma_f32_16x16x32_bf16 v[52:55], v[96:99], a[28:31], v[52:55]
  ds_read_b64_tr_b16 v[82:83], v7 offset:16640
  s_waitcnt lgkmcnt(6)
  v_mfma_f32_16x16x32_bf16 v[56:59], v[100:103], a[24:27], v[56:59]
  ds_read_b64_tr_b16 v[84:85], v8 offset:16384
  v_mfma_f32_16x16x32_bf16 v[60:63], v[100:103], a[28:31], v[60:63]
  ds_read_b64_tr_b16 v[86:87], v8 offset:16640
  s_waitcnt lgkmcnt(6)
  v_mfma_f32_16x16x32_bf16 v[64:67], v[104:107], a[24:27], v[64:67]
  s_add_u32 m0, s39, 0
  s_add_u32 s42, s40, 0
  buffer_load_dwordx4 v3, s[48:51], s42 offen lds
  ds_read_b64_tr_b16 v[88:89], v7 offset:17408
  v_mfma_f32_16x16x32_bf16 v[68:71], v[104:107], a[28:31], v[68:71]
  ds_read_b64_tr_b16 v[90:91], v7 offset:17664
  s_waitcnt lgkmcnt(6)
  v_mfma_f32_16x16x32_bf16 v[72:75], v[108:111], a[24:27], v[72:75]
  ds_read_b64_tr_b16 v[92:93], v8 offset:17408
  v_mfma_f32_16x16x32_bf16 v[76:79], v[108:111], a[28:31], v[76:79]
  ds_read_b64_tr_b16 v[94:95], v8 offset:17664
  s_waitcnt vmcnt(5)
  s_barrier
  s_waitcnt lgkmcnt(6)
  v_mfma_f32_16x16x32_bf16 v[16:19], v[80:83], a[32:35], v[16:19]
  ds_read_b64_tr_b16 v[96:97], v12 offset:16384
  v_mfma_f32_16x16x32_bf16 v[20:23], v[80:83], a[36:39], v[20:23]
  ds_read_b64_tr_b16 v[98:99], v12 offset:16640
  s_waitcnt lgkmcnt(6)
  v_mfma_f32_16x16x32_bf16 v[24:27], v[84:87], a[32:35], v[24:27]
  s_add_u32 m0, s39, 32768
  s_add_u32 s42, s37, 2359296
  buffer_load_dwordx4 v4, s[28:31], s42 offen lds
  ds_read_b64_tr_b16 v[100:101], v13 offset:16384
  v_mfma_f32_16x16x32_bf16 v[28:31], v[84:87], a[36:39], v[28:31]
  ds_read_b64_tr_b16 v[102:103], v13 offset:16640
  s_waitcnt lgkmcnt(6)
  v_mfma_f32_16x16x32_bf16 v[32:35], v[88:91], a[32:35], v[32:35]
  ds_read_b64_tr_b16 v[104:105], v12 offset:17408
  v_mfma_f32_16x16x32_bf16 v[36:39], v[88:91], a[36:39], v[36:39]
  ds_read_b64_tr_b16 v[106:107], v12 offset:17664
  s_waitcnt lgkmcnt(6)
  v_mfma_f32_16x16x32_bf16 v[40:43], v[92:95], a[32:35], v[40:43]
  s_add_u32 m0, s39, 106496
  s_add_u32 s42, s37, 2359360
  buffer_load_dwordx4 v4, s[28:31], s42 offen lds
  ds_read_b64_tr_b16 v[108:109], v13 offset:17408
  v_mfma_f32_16x16x32_bf16 v[44:47], v[92:95], a[36:39], v[44:47]
  ds_read_b64_tr_b16 v[110:111], v13 offset:17664
  s_waitcnt lgkmcnt(6)
  v_mfma_f32_16x16x32_bf16 v[48:51], v[96:99], a[32:35], v[48:51]
  ds_read_b64_tr_b16 v[80:81], v7 offset:20480
  v_mfma_f32_16x16x32_bf16 v[52:55], v[96:99], a[36:39], v[52:55]
  ds_read_b64_tr_b16 v[82:83], v7 offset:20736
  s_waitcnt lgkmcnt(6)
  v_mfma_f32_16x16x32_bf16 v[56:59], v[100:103], a[32:35], v[56:59]
  s_add_u32 s45, s45, 4096
  buffer_load_dwordx4 a[64:67], v2, s[12:15], s45 offen offset:0
  ds_read_b64_tr_b16 v[84:85], v8 offset:20480
  v_mfma_f32_16x16x32_bf16 v[60:63], v[100:103], a[36:39], v[60:63]
  ds_read_b64_tr_b16 v[86:87], v8 offset:20736
  s_waitcnt lgkmcnt(6)
  v_mfma_f32_16x16x32_bf16 v[64:67], v[104:107], a[32:35], v[64:67]
  ds_read_b64_tr_b16 v[88:89], v7 offset:21504
  v_mfma_f32_16x16x32_bf16 v[68:71], v[104:107], a[36:39], v[68:71]
  ds_read_b64_tr_b16 v[90:91], v7 offset:21760
  s_waitcnt lgkmcnt(6)
  v_mfma_f32_16x16x32_bf16 v[72:75], v[108:111], a[32:35], v[72:75]
  buffer_load_dwordx4 a[68:71], v2, s[12:15], s45 offen offset:1024
  ds_read_b64_tr_b16 v[92:93], v8 offset:21504
  v_mfma_f32_16x16x32_bf16 v[76:79], v[108:111], a[36:39], v[76:79]
  ds_read_b64_tr_b16 v[94:95], v8 offset:21760
  s_waitcnt lgkmcnt(6)
  v_mfma_f32_16x16x32_bf16 v[16:19], v[80:83], a[40:43], v[16:19]
  ds_read_b64_tr_b16 v[96:97], v12 offset:20480
  v_mfma_f32_16x16x32_bf16 v[20:23], v[80:83], a[44:47], v[20:23]
  ds_read_b64_tr_b16 v[98:99], v12 offset:20736
  s_waitcnt lgkmcnt(6)
  v_mfma_f32_16x16x32_bf16 v[24:27], v[84:87], a[40:43], v[24:27]
  buffer_load_dwordx4 a[72:75], v2, s[12:15], s45 offen offset:2048
  ds_read_b64_tr_b16 v[100:101], v13 offset:20480
  v_mfma_f32_16x16x32_bf16 v[28:31], v[84:87], a[44:47], v[28:31]
  ds_read_b64_tr_b16 v[102:103], v13 offset:20736
  s_waitcnt lgkmcnt(6)
  v_mfma_f32_16x16x32_bf16 v[32:35], v[88:91], a[40:43], v[32:35]
  ds_read_b64_tr_b16 v[104:105], v12 offset:21504
  v_mfma_f32_16x16x32_bf16 v[36:39], v[88:91], a[44:47], v[36:39]
  ds_read_b64_tr_b16 v[106:107], v12 offset:21760
  s_waitcnt lgkmcnt(6)
  v_mfma_f32_16x16x32_bf16 v[40:43], v[92:95], a[40:43], v[40:43]
  buffer_load_dwordx4 a[76:79], v2, s[12:15], s45 offen offset:3072
  ds_read_b64_tr_b16 v[108:109], v13 offset:21504
  v_mfma_f32_16x16x32_bf16 v[44:47], v[92:95], a[44:47], v[44:47]
  ds_read_b64_tr_b16 v[110:111], v13 offset:21760
  s_waitcnt lgkmcnt(6)
  v_mfma_f32_16x16x32_bf16 v[48:51], v[96:99], a[40:43], v[48:51]
  ds_read_b64_tr_b16 v[80:81], v7 offset:24576
  v_mfma_f32_16x16x32_bf16 v[52:55], v[96:99], a[44:47], v[52:55]
  ds_read_b64_tr_b16 v[82:83], v7 offset:24832
  s_waitcnt lgkmcnt(6)
  v_mfma_f32_16x16x32_bf16 v[56:59], v[100:103], a[40:43], v[56:59]
  ds_read_b64_tr_b16 v[84:85], v8 offset:24576
  v_mfma_f32_16x16x32_bf16 v[60:63], v[100:103], a[44:47], v[60:63]
  ds_read_b64_tr_b16 v[86:87], v8 offset:24832
  s_waitcnt lgkmcnt(6)
  v_mfma_f32_16x16x32_bf16 v[64:67], v[104:107], a[40:43], v[64:67]
  s_add_u32 m0, s39, 8192
  s_add_u32 s42, s40, 442368
  buffer_load_dwordx4 v3, s[48:51], s42 offen lds
  ds_read_b64_tr_b16 v[88:89], v7 offset:25600
  v_mfma_f32_16x16x32_bf16 v[68:71], v[104:107], a[44:47], v[68:71]
  ds_read_b64_tr_b16 v[90:91], v7 offset:25856
  s_waitcnt lgkmcnt(6)
  v_mfma_f32_16x16x32_bf16 v[72:75], v[108:111], a[40:43], v[72:75]
  ds_read_b64_tr_b16 v[92:93], v8 offset:25600
  v_mfma_f32_16x16x32_bf16 v[76:79], v[108:111], a[44:47], v[76:79]
  ds_read_b64_tr_b16 v[94:95], v8 offset:25856
  s_waitcnt vmcnt(5)
  s_barrier
  s_waitcnt lgkmcnt(6)
  v_mfma_f32_16x16x32_bf16 v[16:19], v[80:83], a[48:51], v[16:19]
  ds_read_b64_tr_b16 v[96:97], v12 offset:24576
  v_mfma_f32_16x16x32_bf16 v[20:23], v[80:83], a[52:55], v[20:23]
  ds_read_b64_tr_b16 v[98:99], v12 offset:24832
  s_waitcnt lgkmcnt(6)
  v_mfma_f32_16x16x32_bf16 v[24:27], v[84:87], a[48:51], v[24:27]
  s_add_u32 m0, s39, 40960
  s_add_u32 s42, s37, 2949120
  buffer_load_dwordx4 v4, s[28:31], s42 offen lds
  ds_read_b64_tr_b16 v[100:101], v13 offset:24576
  v_mfma_f32_16x16x32_bf16 v[28:31], v[84:87], a[52:55], v[28:31]
  ds_read_b64_tr_b16 v[102:103], v13 offset:24832
  s_waitcnt lgkmcnt(6)
  v_mfma_f32_16x16x32_bf16 v[32:35], v[88:91], a[48:51], v[32:35]
  ds_read_b64_tr_b16 v[104:105], v12 offset:25600
  v_mfma_f32_16x16x32_bf16 v[36:39], v[88:91], a[52:55], v[36:39]
  ds_read_b64_tr_b16 v[106:107], v12 offset:25856
  s_waitcnt lgkmcnt(6)
  v_mfma_f32_16x16x32_bf16 v[40:43], v[92:95], a[48:51], v[40:43]
  s_add_u32 m0, s39, 114688
  s_add_u32 s42, s37, 2949184
  buffer_load_dwordx4 v4, s[28:31], s42 offen lds
  ds_read_b64_tr_b16 v[108:109], v13 offset:25600
  v_mfma_f32_16x16x32_bf16 v[44:47], v[92:95], a[52:55], v[44:47]
  ds_read_b64_tr_b16 v[110:111], v13 offset:25856
  s_waitcnt lgkmcnt(6)
  v_mfma_f32_16x16x32_bf16 v[48:51], v[96:99], a[48:51], v[48:51]
  ds_read_b64_tr_b16 v[80:81], v7 offset:28672
  v_mfma_f32_16x16x32_bf16 v[52:55], v[96:99], a[52:55], v[52:55]
  ds_read_b64_tr_b16 v[82:83], v7 offset:28928
  s_waitcnt lgkmcnt(6)
  v_mfma_f32_16x16x32_bf16 v[56:59], v[100:103], a[48:51], v[56:59]
  s_add_u32 s45, s45, 4096
  buffer_load_dwordx4 a[80:83], v2, s[12:15], s45 offen offset:0
  ds_read_b64_tr_b16 v[84:85], v8 offset:28672
  v_mfma_f32_16x16x32_bf16 v[60:63], v[100:103], a[52:55], v[60:63]
  ds_read_b64_tr_b16 v[86:87], v8 offset:28928
  s_waitcnt lgkmcnt(6)
  v_mfma_f32_16x16x32_bf16 v[64:67], v[104:107], a[48:51], v[64:67]
  ds_read_b64_tr_b16 v[88:89], v7 offset:29696
  v_mfma_f32_16x16x32_bf16 v[68:71], v[104:107], a[52:55], v[68:71]
  ds_read_b64_tr_b16 v[90:91], v7 offset:29952
  s_waitcnt lgkmcnt(6)
  v_mfma_f32_16x16x32_bf16 v[72:75], v[108:111], a[48:51], v[72:75]
  buffer_load_dwordx4 a[84:87], v2, s[12:15], s45 offen offset:1024
  ds_read_b64_tr_b16 v[92:93], v8 offset:29696
  v_mfma_f32_16x16x32_bf16 v[76:79], v[108:111], a[52:55], v[76:79]
  ds_read_b64_tr_b16 v[94:95], v8 offset:29952
  s_waitcnt lgkmcnt(6)
  v_mfma_f32_16x16x32_bf16 v[16:19], v[80:83], a[56:59], v[16:19]
  ds_read_b64_tr_b16 v[96:97], v12 offset:28672
  v_mfma_f32_16x16x32_bf16 v[20:23], v[80:83], a[60:63], v[20:23]
  ds_read_b64_tr_b16 v[98:99], v12 offset:28928
  s_waitcnt lgkmcnt(6)
  v_mfma_f32_16x16x32_bf16 v[24:27], v[84:87], a[56:59], v[24:27]
  buffer_load_dwordx4 a[88:91], v2, s[12:15], s45 offen offset:2048
  ds_read_b64_tr_b16 v[100:101], v13 offset:28672
  v_mfma_f32_16x16x32_bf16 v[28:31], v[84:87], a[60:63], v[28:31]
  ds_read_b64_tr_b16 v[102:103], v13 offset:28928
  s_waitcnt lgkmcnt(6)
  v_mfma_f32_16x16x32_bf16 v[32:35], v[88:91], a[56:59], v[32:35]
  ds_read_b64_tr_b16 v[104:105], v12 offset:29696
  v_mfma_f32_16x16x32_bf16 v[36:39], v[88:91], a[60:63], v[36:39]
  ds_read_b64_tr_b16 v[106:107], v12 offset:29952
  s_waitcnt lgkmcnt(6)
  v_mfma_f32_16x16x32_bf16 v[40:43], v[92:95], a[56:59], v[40:43]
  buffer_load_dwordx4 a[92:95], v2, s[12:15], s45 offen offset:3072
  ds_read_b64_tr_b16 v[108:109], v13 offset:29696
  v_mfma_f32_16x16x32_bf16 v[44:47], v[92:95], a[60:63], v[44:47]
  ds_read_b64_tr_b16 v[110:111], v13 offset:29952
  s_waitcnt lgkmcnt(6)
  v_mfma_f32_16x16x32_bf16 v[48:51], v[96:99], a[56:59], v[48:51]
  ds_read_b64_tr_b16 v[80:81], v7 offset:32768
  v_mfma_f32_16x16x32_bf16 v[52:55], v[96:99], a[60:63], v[52:55]
  ds_read_b64_tr_b16 v[82:83], v7 offset:33024
  s_waitcnt lgkmcnt(6)
  v_mfma_f32_16x16x32_bf16 v[56:59], v[100:103], a[56:59], v[56:59]
  ds_read_b64_tr_b16 v[84:85], v8 offset:32768
  v_mfma_f32_16x16x32_bf16 v[60:63], v[100:103], a[60:63], v[60:63]
  ds_read_b64_tr_b16 v[86:87], v8 offset:33024
  s_waitcnt lgkmcnt(6)
  v_mfma_f32_16x16x32_bf16 v[64:67], v[104:107], a[56:59], v[64:67]
  s_add_u32 m0, s39, 16384
  s_add_u32 s42, s40, 884736
  buffer_load_dwordx4 v3, s[48:51], s42 offen lds
  ds_read_b64_tr_b16 v[88:89], v7 offset:33792
  v_mfma_f32_16x16x32_bf16 v[68:71], v[104:107], a[60:63], v[68:71]
  ds_read_b64_tr_b16 v[90:91], v7 offset:34048
  s_waitcnt lgkmcnt(6)
  v_mfma_f32_16x16x32_bf16 v[72:75], v[108:111], a[56:59], v[72:75]
  ds_read_b64_tr_b16 v[92:93], v8 offset:33792
  v_mfma_f32_16x16x32_bf16 v[76:79], v[108:111], a[60:63], v[76:79]
  ds_read_b64_tr_b16 v[94:95], v8 offset:34048
  s_waitcnt vmcnt(5)
  s_barrier
  s_waitcnt lgkmcnt(6)
  v_mfma_f32_16x16x32_bf16 v[16:19], v[80:83], a[64:67], v[16:19]
  ds_read_b64_tr_b16 v[96:97], v12 offset:32768
  v_mfma_f32_16x16x32_bf16 v[20:23], v[80:83], a[68:71], v[20:23]
  ds_read_b64_tr_b16 v[98:99], v12 offset:33024
  s_waitcnt lgkmcnt(6)
  v_mfma_f32_16x16x32_bf16 v[24:27], v[84:87], a[64:67], v[24:27]
  s_add_u32 m0, s39, 49152
  s_add_u32 s42, s37, 3538944
  buffer_load_dwordx4 v4, s[28:31], s42 offen lds
  ds_read_b64_tr_b16 v[100:101], v13 offset:32768
  v_mfma_f32_16x16x32_bf16 v[28:31], v[84:87], a[68:71], v[28:31]
  ds_read_b64_tr_b16 v[102:103], v13 offset:33024
  s_waitcnt lgkmcnt(6)
  v_mfma_f32_16x16x32_bf16 v[32:35], v[88:91], a[64:67], v[32:35]
  ds_read_b64_tr_b16 v[104:105], v12 offset:33792
  v_mfma_f32_16x16x32_bf16 v[36:39], v[88:91], a[68:71], v[36:39]
  ds_read_b64_tr_b16 v[106:107], v12 offset:34048
  s_waitcnt lgkmcnt(6)
  v_mfma_f32_16x16x32_bf16 v[40:43], v[92:95], a[64:67], v[40:43]
  s_add_u32 m0, s39, 122880
  s_add_u32 s42, s37, 3539008
  buffer_load_dwordx4 v4, s[28:31], s42 offen lds
  ds_read_b64_tr_b16 v[108:109], v13 offset:33792
  v_mfma_f32_16x16x32_bf16 v[44:47], v[92:95], a[68:71], v[44:47]
  ds_read_b64_tr_b16 v[110:111], v13 offset:34048
  s_waitcnt lgkmcnt(6)
  v_mfma_f32_16x16x32_bf16 v[48:51], v[96:99], a[64:67], v[48:51]
  ds_read_b64_tr_b16 v[80:81], v7 offset:36864
  v_mfma_f32_16x16x32_bf16 v[52:55], v[96:99], a[68:71], v[52:55]
  ds_read_b64_tr_b16 v[82:83], v7 offset:37120
  s_waitcnt lgkmcnt(6)
  v_mfma_f32_16x16x32_bf16 v[56:59], v[100:103], a[64:67], v[56:59]
  s_add_u32 s45, s45, 4096
  buffer_load_dwordx4 a[96:99], v2, s[12:15], s45 offen offset:0
  ds_read_b64_tr_b16 v[84:85], v8 offset:36864
  v_mfma_f32_16x16x32_bf16 v[60:63], v[100:103], a[68:71], v[60:63]
  ds_read_b64_tr_b16 v[86:87], v8 offset:37120
  s_waitcnt lgkmcnt(6)
  v_mfma_f32_16x16x32_bf16 v[64:67], v[104:107], a[64:67], v[64:67]
  ds_read_b64_tr_b16 v[88:89], v7 offset:37888
  v_mfma_f32_16x16x32_bf16 v[68:71], v[104:107], a[68:71], v[68:71]
  ds_read_b64_tr_b16 v[90:91], v7 offset:38144
  s_waitcnt lgkmcnt(6)
  v_mfma_f32_16x16x32_bf16 v[72:75], v[108:111], a[64:67], v[72:75]
  buffer_load_dwordx4 a[100:103], v2, s[12:15], s45 offen offset:1024
  ds_read_b64_tr_b16 v[92:93], v8 offset:37888
  v_mfma_f32_16x16x32_bf16 v[76:79], v[108:111], a[68:71], v[76:79]
  ds_read_b64_tr_b16 v[94:95], v8 offset:38144
  s_waitcnt lgkmcnt(6)
  v_mfma_f32_16x16x32_bf16 v[16:19], v[80:83], a[72:75], v[16:19]
  ds_read_b64_tr_b16 v[96:97], v12 offset:36864
  v_mfma_f32_16x16x32_bf16 v[20:23], v[80:83], a[76:79], v[20:23]
  ds_read_b64_tr_b16 v[98:99], v12 offset:37120
  s_waitcnt lgkmcnt(6)
  v_mfma_f32_16x16x32_bf16 v[24:27], v[84:87], a[72:75], v[24:27]
  buffer_load_dwordx4 a[104:107], v2, s[12:15], s45 offen offset:2048
  ds_read_b64_tr_b16 v[100:101], v13 offset:36864
  v_mfma_f32_16x16x32_bf16 v[28:31], v[84:87], a[76:79], v[28:31]
  ds_read_b64_tr_b16 v[102:103], v13 offset:37120
  s_waitcnt lgkmcnt(6)
  v_mfma_f32_16x16x32_bf16 v[32:35], v[88:91], a[72:75], v[32:35]
  ds_read_b64_tr_b16 v[104:105], v12 offset:37888
  v_mfma_f32_16x16x32_bf16 v[36:39], v[88:91], a[76:79], v[36:39]
  ds_read_b64_tr_b16 v[106:107], v12 offset:38144
  s_waitcnt lgkmcnt(6)
  v_mfma_f32_16x16x32_bf16 v[40:43], v[92:95], a[72:75], v[40:43]
  buffer_load_dwordx4 a[108:111], v2, s[12:15], s45 offen offset:3072
  ds_read_b64_tr_b16 v[108:109], v13 offset:37888
  v_mfma_f32_16x16x32_bf16 v[44:47], v[92:95], a[76:79], v[44:47]
  ds_read_b64_tr_b16 v[110:111], v13 offset:38144
  s_waitcnt lgkmcnt(6)
  v_mfma_f32_16x16x32_bf16 v[48:51], v[96:99], a[72:75], v[48:51]
  ds_read_b64_tr_b16 v[80:81], v7 offset:40960
  v_mfma_f32_16x16x32_bf16 v[52:55], v[96:99], a[76:79], v[52:55]
  ds_read_b64_tr_b16 v[82:83], v7 offset:41216
  s_waitcnt lgkmcnt(6)
  v_mfma_f32_16x16x32_bf16 v[56:59], v[100:103], a[72:75], v[56:59]
  ds_read_b64_tr_b16 v[84:85], v8 offset:40960
  v_mfma_f32_16x16x32_bf16 v[60:63], v[100:103], a[76:79], v[60:63]
  ds_read_b64_tr_b16 v[86:87], v8 offset:41216
  s_waitcnt lgkmcnt(6)
  v_mfma_f32_16x16x32_bf16 v[64:67], v[104:107], a[72:75], v[64:67]
  s_add_u32 m0, s39, 24576
  s_add_u32 s42, s40, 1327104
  buffer_load_dwordx4 v3, s[48:51], s42 offen lds
  ds_read_b64_tr_b16 v[88:89], v7 offset:41984
  v_mfma_f32_16x16x32_bf16 v[68:71], v[104:107], a[76:79], v[68:71]
  ds_read_b64_tr_b16 v[90:91], v7 offset:42240
  s_waitcnt lgkmcnt(6)
  v_mfma_f32_16x16x32_bf16 v[72:75], v[108:111], a[72:75], v[72:75]
  ds_read_b64_tr_b16 v[92:93], v8 offset:41984
  v_mfma_f32_16x16x32_bf16 v[76:79], v[108:111], a[76:79], v[76:79]
  ds_read_b64_tr_b16 v[94:95], v8 offset:42240
  s_waitcnt vmcnt(5)
  s_barrier
  s_waitcnt lgkmcnt(6)
  v_mfma_f32_16x16x32_bf16 v[16:19], v[80:83], a[80:83], v[16:19]
  ds_read_b64_tr_b16 v[96:97], v12 offset:40960
  v_mfma_f32_16x16x32_bf16 v[20:23], v[80:83], a[84:87], v[20:23]
  ds_read_b64_tr_b16 v[98:99], v12 offset:41216
  s_waitcnt lgkmcnt(6)
  v_mfma_f32_16x16x32_bf16 v[24:27], v[84:87], a[80:83], v[24:27]
  s_add_u32 m0, s39, 57344
  s_add_u32 s42, s37, 4128768
  buffer_load_dwordx4 v4, s[28:31], s42 offen lds
  ds_read_b64_tr_b16 v[100:101], v13 offset:40960
  v_mfma_f32_16x16x32_bf16 v[28:31], v[84:87], a[84:87], v[28:31]
  ds_read_b64_tr_b16 v[102:103], v13 offset:41216
  s_waitcnt lgkmcnt(6)
  v_mfma_f32_16x16x32_bf16 v[32:35], v[88:91], a[80:83], v[32:35]
  ds_read_b64_tr_b16 v[104:105], v12 offset:41984
  v_mfma_f32_16x16x32_bf16 v[36:39], v[88:91], a[84:87], v[36:39]
  ds_read_b64_tr_b16 v[106:107], v12 offset:42240
  s_waitcnt lgkmcnt(6)
  v_mfma_f32_16x16x32_bf16 v[40:43], v[92:95], a[80:83], v[40:43]
  s_add_u32 m0, s39, 131072
  s_add_u32 s42, s37, 4128832
  buffer_load_dwordx4 v4, s[28:31], s42 offen lds
  ds_read_b64_tr_b16 v[108:109], v13 offset:41984
  v_mfma_f32_16x16x32_bf16 v[44:47], v[92:95], a[84:87], v[44:47]
  ds_read_b64_tr_b16 v[110:111], v13 offset:42240
  s_waitcnt lgkmcnt(6)
  v_mfma_f32_16x16x32_bf16 v[48:51], v[96:99], a[80:83], v[48:51]
  ds_read_b64_tr_b16 v[80:81], v7 offset:45056
  v_mfma_f32_16x16x32_bf16 v[52:55], v[96:99], a[84:87], v[52:55]
  ds_read_b64_tr_b16 v[82:83], v7 offset:45312
  s_waitcnt lgkmcnt(6)
  v_mfma_f32_16x16x32_bf16 v[56:59], v[100:103], a[80:83], v[56:59]
  s_add_u32 s45, s45, 4096
  buffer_load_dwordx4 a[112:115], v2, s[12:15], s45 offen offset:0
  ds_read_b64_tr_b16 v[84:85], v8 offset:45056
  v_mfma_f32_16x16x32_bf16 v[60:63], v[100:103], a[84:87], v[60:63]
  ds_read_b64_tr_b16 v[86:87], v8 offset:45312
  s_waitcnt lgkmcnt(6)
  v_mfma_f32_16x16x32_bf16 v[64:67], v[104:107], a[80:83], v[64:67]
  ds_read_b64_tr_b16 v[88:89], v7 offset:46080
  v_mfma_f32_16x16x32_bf16 v[68:71], v[104:107], a[84:87], v[68:71]
  ds_read_b64_tr_b16 v[90:91], v7 offset:46336
  s_waitcnt lgkmcnt(6)
  v_mfma_f32_16x16x32_bf16 v[72:75], v[108:111], a[80:83], v[72:75]
  buffer_load_dwordx4 a[116:119], v2, s[12:15], s45 offen offset:1024
  ds_read_b64_tr_b16 v[92:93], v8 offset:46080
  v_mfma_f32_16x16x32_bf16 v[76:79], v[108:111], a[84:87], v[76:79]
  ds_read_b64_tr_b16 v[94:95], v8 offset:46336
  s_waitcnt lgkmcnt(6)
  v_mfma_f32_16x16x32_bf16 v[16:19], v[80:83], a[88:91], v[16:19]
  ds_read_b64_tr_b16 v[96:97], v12 offset:45056
  v_mfma_f32_16x16x32_bf16 v[20:23], v[80:83], a[92:95], v[20:23]
  ds_read_b64_tr_b16 v[98:99], v12 offset:45312
  s_waitcnt lgkmcnt(6)
  v_mfma_f32_16x16x32_bf16 v[24:27], v[84:87], a[88:91], v[24:27]
  buffer_load_dwordx4 a[120:123], v2, s[12:15], s45 offen offset:2048
  ds_read_b64_tr_b16 v[100:101], v13 offset:45056
  v_mfma_f32_16x16x32_bf16 v[28:31], v[84:87], a[92:95], v[28:31]
  ds_read_b64_tr_b16 v[102:103], v13 offset:45312
  s_waitcnt lgkmcnt(6)
  v_mfma_f32_16x16x32_bf16 v[32:35], v[88:91], a[88:91], v[32:35]
  ds_read_b64_tr_b16 v[104:105], v12 offset:46080
  v_mfma_f32_16x16x32_bf16 v[36:39], v[88:91], a[92:95], v[36:39]
  ds_read_b64_tr_b16 v[106:107], v12 offset:46336
  s_waitcnt lgkmcnt(6)
  v_mfma_f32_16x16x32_bf16 v[40:43], v[92:95], a[88:91], v[40:43]
  buffer_load_dwordx4 a[124:127], v2, s[12:15], s45 offen offset:3072
  ds_read_b64_tr_b16 v[108:109], v13 offset:46080
  v_mfma_f32_16x16x32_bf16 v[44:47], v[92:95], a[92:95], v[44:47]
  ds_read_b64_tr_b16 v[110:111], v13 offset:46336
  s_waitcnt lgkmcnt(6)
  v_mfma_f32_16x16x32_bf16 v[48:51], v[96:99], a[88:91], v[48:51]
  ds_read_b64_tr_b16 v[80:81], v7 offset:49152
  v_mfma_f32_16x16x32_bf16 v[52:55], v[96:99], a[92:95], v[52:55]
  ds_read_b64_tr_b16 v[82:83], v7 offset:49408
  s_waitcnt lgkmcnt(6)
  v_mfma_f32_16x16x32_bf16 v[56:59], v[100:103], a[88:91], v[56:59]
  ds_read_b64_tr_b16 v[84:85], v8 offset:49152
  v_mfma_f32_16x16x32_bf16 v[60:63], v[100:103], a[92:95], v[60:63]
  ds_read_b64_tr_b16 v[86:87], v8 offset:49408
  s_waitcnt lgkmcnt(6)
  v_mfma_f32_16x16x32_bf16 v[64:67], v[104:107], a[88:91], v[64:67]
  s_add_u32 m0, s39, 32768
  s_add_u32 s42, s40, 1769472
  buffer_load_dwordx4 v3, s[48:51], s42 offen lds
  ds_read_b64_tr_b16 v[88:89], v7 offset:50176
  v_mfma_f32_16x16x32_bf16 v[68:71], v[104:107], a[92:95], v[68:71]
  ds_read_b64_tr_b16 v[90:91], v7 offset:50432
  s_waitcnt lgkmcnt(6)
  v_mfma_f32_16x16x32_bf16 v[72:75], v[108:111], a[88:91], v[72:75]
  ds_read_b64_tr_b16 v[92:93], v8 offset:50176
  v_mfma_f32_16x16x32_bf16 v[76:79], v[108:111], a[92:95], v[76:79]
  ds_read_b64_tr_b16 v[94:95], v8 offset:50432
  s_waitcnt vmcnt(5)
  s_barrier
  s_waitcnt lgkmcnt(6)
  v_mfma_f32_16x16x32_bf16 v[16:19], v[80:83], a[96:99], v[16:19]
  ds_read_b64_tr_b16 v[96:97], v12 offset:49152
  v_mfma_f32_16x16x32_bf16 v[20:23], v[80:83], a[100:103], v[20:23]
  ds_read_b64_tr_b16 v[98:99], v12 offset:49408
  s_waitcnt lgkmcnt(6)
  v_mfma_f32_16x16x32_bf16 v[24:27], v[84:87], a[96:99], v[24:27]
  s_add_u32 m0, s39, 65536
  s_add_u32 s42, s37, 4718592
  buffer_load_dwordx4 v4, s[28:31], s42 offen lds
  ds_read_b64_tr_b16 v[100:101], v13 offset:49152
  v_mfma_f32_16x16x32_bf16 v[28:31], v[84:87], a[100:103], v[28:31]
  ds_read_b64_tr_b16 v[102:103], v13 offset:49408
  s_waitcnt lgkmcnt(6)
  v_mfma_f32_16x16x32_bf16 v[32:35], v[88:91], a[96:99], v[32:35]
  ds_read_b64_tr_b16 v[104:105], v12 offset:50176
  v_mfma_f32_16x16x32_bf16 v[36:39], v[88:91], a[100:103], v[36:39]
  ds_read_b64_tr_b16 v[106:107], v12 offset:50432
  s_waitcnt lgkmcnt(6)
  v_mfma_f32_16x16x32_bf16 v[40:43], v[92:95], a[96:99], v[40:43]
  s_add_u32 m0, s39, 139264
  s_add_u32 s42, s37, 4718656
  buffer_load_dwordx4 v4, s[28:31], s42 offen lds
  ds_read_b64_tr_b16 v[108:109], v13 offset:50176
  v_mfma_f32_16x16x32_bf16 v[44:47], v[92:95], a[100:103], v[44:47]
  ds_read_b64_tr_b16 v[110:111], v13 offset:50432
  s_waitcnt lgkmcnt(6)
  v_mfma_f32_16x16x32_bf16 v[48:51], v[96:99], a[96:99], v[48:51]
  ds_read_b64_tr_b16 v[80:81], v7 offset:53248
  v_mfma_f32_16x16x32_bf16 v[52:55], v[96:99], a[100:103], v[52:55]
  ds_read_b64_tr_b16 v[82:83], v7 offset:53504
  s_waitcnt lgkmcnt(6)
  v_mfma_f32_16x16x32_bf16 v[56:59], v[100:103], a[96:99], v[56:59]
  s_add_u32 s45, s45, 4096
  buffer_load_dwordx4 a[128:131], v2, s[12:15], s45 offen offset:0
  ds_read_b64_tr_b16 v[84:85], v8 offset:53248
  v_mfma_f32_16x16x32_bf16 v[60:63], v[100:103], a[100:103], v[60:63]
  ds_read_b64_tr_b16 v[86:87], v8 offset:53504
  s_waitcnt lgkmcnt(6)
  v_mfma_f32_16x16x32_bf16 v[64:67], v[104:107], a[96:99], v[64:67]
  ds_read_b64_tr_b16 v[88:89], v7 offset:54272
  v_mfma_f32_16x16x32_bf16 v[68:71], v[104:107], a[100:103], v[68:71]
  ds_read_b64_tr_b16 v[90:91], v7 offset:54528
  s_waitcnt lgkmcnt(6)
  v_mfma_f32_16x16x32_bf16 v[72:75], v[108:111], a[96:99], v[72:75]
  buffer_load_dwordx4 a[132:135], v2, s[12:15], s45 offen offset:1024
  ds_read_b64_tr_b16 v[92:93], v8 offset:54272
  v_mfma_f32_16x16x32_bf16 v[76:79], v[108:111], a[100:103], v[76:79]
  ds_read_b64_tr_b16 v[94:95], v8 offset:54528
  s_waitcnt lgkmcnt(6)
  v_mfma_f32_16x16x32_bf16 v[16:19], v[80:83], a[104:107], v[16:19]
  ds_read_b64_tr_b16 v[96:97], v12 offset:53248
  v_mfma_f32_16x16x32_bf16 v[20:23], v[80:83], a[108:111], v[20:23]
  ds_read_b64_tr_b16 v[98:99], v12 offset:53504
  s_waitcnt lgkmcnt(6)
  v_mfma_f32_16x16x32_bf16 v[24:27], v[84:87], a[104:107], v[24:27]
  buffer_load_dwordx4 a[136:139], v2, s[12:15], s45 offen offset:2048
  ds_read_b64_tr_b16 v[100:101], v13 offset:53248
  v_mfma_f32_16x16x32_bf16 v[28:31], v[84:87], a[108:111], v[28:31]
  ds_read_b64_tr_b16 v[102:103], v13 offset:53504
  s_waitcnt lgkmcnt(6)
  v_mfma_f32_16x16x32_bf16 v[32:35], v[88:91], a[104:107], v[32:35]
  ds_read_b64_tr_b16 v[104:105], v12 offset:54272
  v_mfma_f32_16x16x32_bf16 v[36:39], v[88:91], a[108:111], v[36:39]
  ds_read_b64_tr_b16 v[106:107], v12 offset:54528
  s_waitcnt lgkmcnt(6)
  v_mfma_f32_16x16x32_bf16 v[40:43], v[92:95], a[104:107], v[40:43]
  buffer_load_dwordx4 a[140:143], v2, s[12:15], s45 offen offset:3072
  ds_read_b64_tr_b16 v[108:109], v13 offset:54272
  v_mfma_f32_16x16x32_bf16 v[44:47], v[92:95], a[108:111], v[44:47]
  ds_read_b64_tr_b16 v[110:111], v13 offset:54528
  s_waitcnt lgkmcnt(6)
  v_mfma_f32_16x16x32_bf16 v[48:51], v[96:99], a[104:107], v[48:51]
  ds_read_b64_tr_b16 v[80:81], v7 offset:57344
  v_mfma_f32_16x16x32_bf16 v[52:55], v[96:99], a[108:111], v[52:55]
  ds_read_b64_tr_b16 v[82:83], v7 offset:57600
  s_waitcnt lgkmcnt(6)
  v_mfma_f32_16x16x32_bf16 v[56:59], v[100:103], a[104:107], v[56:59]
  ds_read_b64_tr_b16 v[84:85], v8 offset:57344
  v_mfma_f32_16x16x32_bf16 v[60:63], v[100:103], a[108:111], v[60:63]
  ds_read_b64_tr_b16 v[86:87], v8 offset:57600
  s_waitcnt lgkmcnt(6)
  v_mfma_f32_16x16x32_bf16 v[64:67], v[104:107], a[104:107], v[64:67]
  ds_read_b64_tr_b16 v[88:89], v7 offset:58368
  v_mfma_f32_16x16x32_bf16 v[68:71], v[104:107], a[108:111], v[68:71]
  ds_read_b64_tr_b16 v[90:91], v7 offset:58624
  s_waitcnt lgkmcnt(6)
  v_mfma_f32_16x16x32_bf16 v[72:75], v[108:111], a[104:107], v[72:75]
  ds_read_b64_tr_b16 v[92:93], v8 offset:58368
  v_mfma_f32_16x16x32_bf16 v[76:79], v[108:111], a[108:111], v[76:79]
  ds_read_b64_tr_b16 v[94:95], v8 offset:58624
  s_waitcnt vmcnt(4)
  s_barrier
  s_waitcnt lgkmcnt(6)
  v_mfma_f32_16x16x32_bf16 v[16:19], v[80:83], a[112:115], v[16:19]
  ds_read_b64_tr_b16 v[96:97], v12 offset:57344
  v_mfma_f32_16x16x32_bf16 v[20:23], v[80:83], a[116:119], v[20:23]
  ds_read_b64_tr_b16 v[98:99], v12 offset:57600
  s_waitcnt lgkmcnt(6)
  v_mfma_f32_16x16x32_bf16 v[24:27], v[84:87], a[112:115], v[24:27]
  ds_read_b64_tr_b16 v[100:101], v13 offset:57344
  v_mfma_f32_16x16x32_bf16 v[28:31], v[84:87], a[116:119], v[28:31]
  ds_read_b64_tr_b16 v[102:103], v13 offset:57600
  s_waitcnt lgkmcnt(6)
  v_mfma_f32_16x16x32_bf16 v[32:35], v[88:91], a[112:115], v[32:35]
  ds_read_b64_tr_b16 v[104:105], v12 offset:58368
  v_mfma_f32_16x16x32_bf16 v[36:39], v[88:91], a[116:119], v[36:39]
  ds_read_b64_tr_b16 v[106:107], v12 offset:58624
  s_waitcnt lgkmcnt(6)
  v_mfma_f32_16x16x32_bf16 v[40:43], v[92:95], a[112:115], v[40:43]
  s_mul_i32 s42, s46, 589824
  s_add_u32 s42, s42, s37
  s_add_u32 s42, s42, s52
  s_mov_b32 m0, 147456
  s_nop 0
  buffer_load_dwordx4 v4, s[28:31], s42 offen lds
  ds_read_b64_tr_b16 v[108:109], v13 offset:58368
  v_mfma_f32_16x16x32_bf16 v[44:47], v[92:95], a[116:119], v[44:47]
  ds_read_b64_tr_b16 v[110:111], v13 offset:58624
  s_waitcnt lgkmcnt(6)
  v_mfma_f32_16x16x32_bf16 v[48:51], v[96:99], a[112:115], v[48:51]
  ds_read_b64_tr_b16 v[80:81], v7 offset:61440
  v_mfma_f32_16x16x32_bf16 v[52:55], v[96:99], a[116:119], v[52:55]
  ds_read_b64_tr_b16 v[82:83], v7 offset:61696
  s_waitcnt lgkmcnt(6)
  v_mfma_f32_16x16x32_bf16 v[56:59], v[100:103], a[112:115], v[56:59]
  ds_read_b64_tr_b16 v[84:85], v8 offset:61440
  v_mfma_f32_16x16x32_bf16 v[60:63], v[100:103], a[116:119], v[60:63]
  ds_read_b64_tr_b16 v[86:87], v8 offset:61696
  s_waitcnt lgkmcnt(6)
  v_mfma_f32_16x16x32_bf16 v[64:67], v[104:107], a[112:115], v[64:67]
  ds_read_b64_tr_b16 v[88:89], v7 offset:62464
  v_mfma_f32_16x16x32_bf16 v[68:71], v[104:107], a[116:119], v[68:71]
  ds_read_b64_tr_b16 v[90:91], v7 offset:62720
  s_waitcnt lgkmcnt(6)
  v_mfma_f32_16x16x32_bf16 v[72:75], v[108:111], a[112:115], v[72:75]
  s_mul_i32 s42, s46, 589824
  s_add_u32 s42, s42, s37
  s_add_u32 s42, s42, s53
  s_mov_b32 m0, 147456
  s_nop 0
  buffer_load_dwordx4 v4, s[28:31], s42 offen lds
  ds_read_b64_tr_b16 v[92:93], v8 offset:62464
  v_mfma_f32_16x16x32_bf16 v[76:79], v[108:111], a[116:119], v[76:79]
  ds_read_b64_tr_b16 v[94:95], v8 offset:62720
  s_waitcnt lgkmcnt(6)
  v_mfma_f32_16x16x32_bf16 v[16:19], v[80:83], a[120:123], v[16:19]
  ds_read_b64_tr_b16 v[96:97], v12 offset:61440
  v_mfma_f32_16x16x32_bf16 v[20:23], v[80:83], a[124:127], v[20:23]
  ds_read_b64_tr_b16 v[98:99], v12 offset:61696
  s_waitcnt lgkmcnt(6)
  v_mfma_f32_16x16x32_bf16 v[24:27], v[84:87], a[120:123], v[24:27]
  ds_read_b64_tr_b16 v[100:101], v13 offset:61440
  v_mfma_f32_16x16x32_bf16 v[28:31], v[84:87], a[124:127], v[28:31]
  ds_read_b64_tr_b16 v[102:103], v13 offset:61696
  s_waitcnt lgkmcnt(6)
  v_mfma_f32_16x16x32_bf16 v[32:35], v[88:91], a[120:123], v[32:35]
  ds_read_b64_tr_b16 v[104:105], v12 offset:62464
  v_mfma_f32_16x16x32_bf16 v[36:39], v[88:91], a[124:127], v[36:39]
  ds_read_b64_tr_b16 v[106:107], v12 offset:62720
  s_waitcnt lgkmcnt(6)
  v_mfma_f32_16x16x32_bf16 v[40:43], v[92:95], a[120:123], v[40:43]
  s_mul_i32 s42, s46, 589824
  s_add_u32 s42, s42, s37
  s_add_u32 s42, s42, s54
  s_cmp_lt_u32 s47, 16
  s_cselect_b32 s42, s42, 0x7f000000
  s_mov_b32 m0, 147456
  s_nop 0
  buffer_load_dwordx4 v4, s[28:31], s42 offen lds
  ds_read_b64_tr_b16 v[108:109], v13 offset:62464
  v_mfma_f32_16x16x32_bf16 v[44:47], v[92:95], a[124:127], v[44:47]
  ds_read_b64_tr_b16 v[110:111], v13 offset:62720
  s_waitcnt lgkmcnt(6)
  v_mfma_f32_16x16x32_bf16 v[48:51], v[96:99], a[120:123], v[48:51]
  ds_read_b64_tr_b16 v[80:81], v9 offset:0
  v_mfma_f32_16x16x32_bf16 v[52:55], v[96:99], a[124:127], v[52:55]
  ds_read_b64_tr_b16 v[82:83], v9 offset:256
  s_waitcnt lgkmcnt(6)
  v_mfma_f32_16x16x32_bf16 v[56:59], v[100:103], a[120:123], v[56:59]
  ds_read_b64_tr_b16 v[84:85], v10 offset:0
  v_mfma_f32_16x16x32_bf16 v[60:63], v[100:103], a[124:127], v[60:63]
  ds_read_b64_tr_b16 v[86:87], v10 offset:256
  s_waitcnt lgkmcnt(6)
  v_mfma_f32_16x16x32_bf16 v[64:67], v[104:107], a[120:123], v[64:67]
  ds_read_b64_tr_b16 v[88:89], v9 offset:1024
  v_mfma_f32_16x16x32_bf16 v[68:71], v[104:107], a[124:127], v[68:71]
  ds_read_b64_tr_b16 v[90:91], v9 offset:1280
  s_waitcnt lgkmcnt(6)
  v_mfma_f32_16x16x32_bf16 v[72:75], v[108:111], a[120:123], v[72:75]
  s_mul_i32 s42, s46, 442368
  s_add_u32 s42, s42, s40
  s_add_u32 s42, s42, 1024
  s_sub_u32 s43, s47, 16
  s_cmp_lt_u32 s43, 16
  s_cselect_b32 s42, s42, 0x7f000000
  s_mov_b32 m0, 147456
  s_nop 0
  buffer_load_dwordx4 v3, s[48:51], s42 offen lds
  ds_read_b64_tr_b16 v[92:93], v10 offset:1024
  v_mfma_f32_16x16x32_bf16 v[76:79], v[108:111], a[124:127], v[76:79]
  ds_read_b64_tr_b16 v[94:95], v10 offset:1280
  s_waitcnt vmcnt(7)
  s_waitcnt vmcnt(6)
  s_waitcnt lgkmcnt(6)
  v_mfma_f32_16x16x32_bf16 v[16:19], v[80:83], a[128:131], v[16:19]
  ds_read_b64_tr_b16 v[96:97], v14 offset:0
  v_mfma_f32_16x16x32_bf16 v[20:23], v[80:83], a[132:135], v[20:23]
  ds_read_b64_tr_b16 v[98:99], v14 offset:256
  s_waitcnt lgkmcnt(6)
  v_mfma_f32_16x16x32_bf16 v[24:27], v[84:87], a[128:131], v[24:27]
  ds_read_b64_tr_b16 v[100:101], v15 offset:0
  v_mfma_f32_16x16x32_bf16 v[28:31], v[84:87], a[132:135], v[28:31]
  ds_read_b64_tr_b16 v[102:103], v15 offset:256
  s_waitcnt lgkmcnt(6)
  v_mfma_f32_16x16x32_bf16 v[32:35], v[88:91], a[128:131], v[32:35]
  ds_read_b64_tr_b16 v[104:105], v14 offset:1024
  v_mfma_f32_16x16x32_bf16 v[36:39], v[88:91], a[132:135], v[36:39]
  ds_read_b64_tr_b16 v[106:107], v14 offset:1280
  s_waitcnt lgkmcnt(6)
  v_mfma_f32_16x16x32_bf16 v[40:43], v[92:95], a[128:131], v[40:43]
  s_mul_i32 s42, s46, 442368
  s_add_u32 s42, s42, s40
  s_add_u32 s42, s42, 2048
  s_sub_u32 s43, s47, 16
  s_cmp_lt_u32 s43, 6
  s_cselect_b32 s42, s42, 0x7f000000
  s_mov_b32 m0, 147456
  s_nop 0
  buffer_load_dwordx4 v3, s[48:51], s42 offen lds
  ds_read_b64_tr_b16 v[108:109], v15 offset:1024
  v_mfma_f32_16x16x32_bf16 v[44:47], v[92:95], a[132:135], v[44:47]
  ds_read_b64_tr_b16 v[110:111], v15 offset:1280
  s_waitcnt lgkmcnt(6)
  v_mfma_f32_16x16x32_bf16 v[48:51], v[96:99], a[128:131], v[48:51]
  ds_read_b64_tr_b16 v[80:81], v9 offset:4096
  v_mfma_f32_16x16x32_bf16 v[52:55], v[96:99], a[132:135], v[52:55]
  ds_read_b64_tr_b16 v[82:83], v9 offset:4352
  s_waitcnt lgkmcnt(6)
  v_mfma_f32_16x16x32_bf16 v[56:59], v[100:103], a[128:131], v[56:59]
  ds_read_b64_tr_b16 v[84:85], v10 offset:4096
  v_mfma_f32_16x16x32_bf16 v[60:63], v[100:103], a[132:135], v[60:63]
  ds_read_b64_tr_b16 v[86:87], v10 offset:4352
  s_waitcnt lgkmcnt(6)
  v_mfma_f32_16x16x32_bf16 v[64:67], v[104:107], a[128:131], v[64:67]
  ds_read_b64_tr_b16 v[88:89], v9 offset:5120
  v_mfma_f32_16x16x32_bf16 v[68:71], v[104:107], a[132:135], v[68:71]
  ds_read_b64_tr_b16 v[90:91], v9 offset:5376
  s_waitcnt lgkmcnt(6)
  v_mfma_f32_16x16x32_bf16 v[72:75], v[108:111], a[128:131], v[72:75]
  ds_read_b64_tr_b16 v[92:93], v10 offset:5120
  v_mfma_f32_16x16x32_bf16 v[76:79], v[108:111], a[132:135], v[76:79]
  ds_read_b64_tr_b16 v[94:95], v10 offset:5376
  s_waitcnt vmcnt(6)
  s_waitcnt vmcnt(5)
  s_waitcnt lgkmcnt(6)
  v_mfma_f32_16x16x32_bf16 v[16:19], v[80:83], a[136:139], v[16:19]
  ds_read_b64_tr_b16 v[96:97], v14 offset:4096
  v_mfma_f32_16x16x32_bf16 v[20:23], v[80:83], a[140:143], v[20:23]
  ds_read_b64_tr_b16 v[98:99], v14 offset:4352
  s_waitcnt lgkmcnt(6)
  v_mfma_f32_16x16x32_bf16 v[24:27], v[84:87], a[136:139], v[24:27]
  ds_read_b64_tr_b16 v[100:101], v15 offset:4096
  v_mfma_f32_16x16x32_bf16 v[28:31], v[84:87], a[140:143], v[28:31]
  ds_read_b64_tr_b16 v[102:103], v15 offset:4352
  s_waitcnt lgkmcnt(6)
  v_mfma_f32_16x16x32_bf16 v[32:35], v[88:91], a[136:139], v[32:35]
  ds_read_b64_tr_b16 v[104:105], v14 offset:5120
  v_mfma_f32_16x16x32_bf16 v[36:39], v[88:91], a[140:143], v[36:39]
  ds_read_b64_tr_b16 v[106:107], v14 offset:5376
  s_waitcnt lgkmcnt(6)
  v_mfma_f32_16x16x32_bf16 v[40:43], v[92:95], a[136:139], v[40:43]
  ds_read_b64_tr_b16 v[108:109], v15 offset:5120
  v_mfma_f32_16x16x32_bf16 v[44:47], v[92:95], a[140:143], v[44:47]
  ds_read_b64_tr_b16 v[110:111], v15 offset:5376
  s_waitcnt lgkmcnt(6)
  v_mfma_f32_16x16x32_bf16 v[48:51], v[96:99], a[136:139], v[48:51]
  v_mfma_f32_16x16x32_bf16 v[52:55], v[96:99], a[140:143], v[52:55]
  s_waitcnt lgkmcnt(4)
  v_mfma_f32_16x16x32_bf16 v[56:59], v[100:103], a[136:139], v[56:59]
  v_mfma_f32_16x16x32_bf16 v[60:63], v[100:103], a[140:143], v[60:63]
  s_waitcnt lgkmcnt(0)
  s_barrier
  v_lshrrev_b32 v7, 5, v0
  v_lshlrev_b32 v7, 10, v7
  v_add_u32 v7, v7, v11
  v_add_u32 v7, 0, v7
  v_xor_b32 v8, 32, v7
  v_add_u32 v9, 0x10000, v7
  v_add_u32 v10, 0x10000, v8
  v_mfma_f32_16x16x32_bf16 v[64:67], v[104:107], a[136:139], v[64:67]
  ds_read_b64_tr_b16 v[80:81], v7 offset:0
  ds_read_b64_tr_b16 v[82:83], v7 offset:256
  v_mfma_f32_16x16x32_bf16 v[68:71], v[104:107], a[140:143], v[68:71]
  ds_read_b64_tr_b16 v[84:85], v8 offset:0
  ds_read_b64_tr_b16 v[86:87], v8 offset:256
  v_mfma_f32_16x16x32_bf16 v[72:75], v[108:111], a[136:139], v[72:75]
  ds_read_b64_tr_b16 v[88:89], v7 offset:2048
  v_mfma_f32_16x16x32_bf16 v[76:79], v[108:111], a[140:143], v[76:79]
  ds_read_b64_tr_b16 v[90:91], v7 offset:2304
  s_mov_b32 s16, s28
  s_mov_b32 s17, s29
  s_mov_b32 s18, 5308416
  s_add_u32 s40, s37, s52
  s_mov_b32 s41, 589824
  v_mov_b32 v5, v4
  s_waitcnt lgkmcnt(4)
  v_mfma_f32_16x16x32_bf16 v[96:99], v[80:83], a[0:3], 0
  ds_read_b64_tr_b16 v[92:93], v8 offset:2048
  v_mfma_f32_16x16x32_bf16 v[100:103], v[80:83], a[4:7], 0
  ds_read_b64_tr_b16 v[94:95], v8 offset:2304
  s_waitcnt lgkmcnt(4)
  v_mfma_f32_16x16x32_bf16 v[104:107], v[84:87], a[0:3], 0
  s_add_u32 m0, s39, 73728
  s_nop 0
  buffer_load_dwordx4 v5, s[16:19], s40 offen lds
  s_add_u32 s40, s40, s41
  ds_read_b64_tr_b16 v[80:81], v7 offset:4096
  v_mfma_f32_16x16x32_bf16 v[108:111], v[84:87], a[4:7], 0
  ds_read_b64_tr_b16 v[82:83], v7 offset:4352
  s_waitcnt lgkmcnt(4)
  v_mfma_f32_16x16x32_bf16 v[96:99], v[88:91], a[8:11], v[96:99]
  ds_read_b64_tr_b16 v[84:85], v8 offset:4096
  v_mfma_f32_16x16x32_bf16 v[100:103], v[88:91], a[12:15], v[100:103]
  ds_read_b64_tr_b16 v[86:87], v8 offset:4352
  s_waitcnt lgkmcnt(4)
  v_mfma_f32_16x16x32_bf16 v[104:107], v[92:95], a[8:11], v[104:107]
  v_mul_f32 v12, v16, v16
  v_mul_f32 v13, v17, v17
  s_add_u32 m0, s39, 81920
  s_nop 0
  buffer_load_dwordx4 v5, s[16:19], s40 offen lds
  s_add_u32 s40, s40, s41
  ds_read_b64_tr_b16 v[88:89], v7 offset:6144
  v_mfma_f32_16x16x32_bf16 v[108:111], v[92:95], a[12:15], v[108:111]
  v_mul_f32 v14, v18, v18
  v_mul_f32 v15, v19, v19
  ds_read_b64_tr_b16 v[90:91], v7 offset:6400
  s_waitcnt lgkmcnt(4)
  v_mfma_f32_16x16x32_bf16 v[96:99], v[80:83], a[16:19], v[96:99]
  v_fmaak_f32 v12, v12, v6, 0xc0135761
  v_fmaak_f32 v13, v13, v6, 0xc0135761
  ds_read_b64_tr_b16 v[92:93], v8 offset:6144
  v_mfma_f32_16x16x32_bf16 v[100:103], v[80:83], a[20:23], v[100:103]
  v_fmaak_f32 v14, v14, v6, 0xc0135761
  v_fmaak_f32 v15, v15, v6, 0xc0135761
  v_mul_f32 v12, v12, v16
  ds_read_b64_tr_b16 v[94:95], v8 offset:6400
  s_waitcnt lgkmcnt(4)
  v_mfma_f32_16x16x32_bf16 v[104:107], v[84:87], a[16:19], v[104:107]
  v_mul_f32 v13, v13, v17
  v_mul_f32 v14, v14, v18
  s_add_u32 m0, s39, 90112
  s_nop 0
  buffer_load_dwordx4 v5, s[16:19], s40 offen lds
  s_add_u32 s40, s40, s41
  ds_read_b64_tr_b16 v[80:81], v7 offset:8192
  v_mfma_f32_16x16x32_bf16 v[108:111], v[84:87], a[20:23], v[108:111]
  v_mul_f32 v15, v15, v19
  v_exp_f32 v12, v12
  ds_read_b64_tr_b16 v[82:83], v7 offset:8448
  s_waitcnt lgkmcnt(4)
  v_mfma_f32_16x16x32_bf16 v[96:99], v[88:91], a[24:27], v[96:99]
  v_exp_f32 v13, v13
  v_exp_f32 v14, v14
  ds_read_b64_tr_b16 v[84:85], v8 offset:8192
  v_mfma_f32_16x16x32_bf16 v[100:103], v[88:91], a[28:31], v[100:103]
  v_exp_f32 v15, v15
  v_mul_f32 v16, v16, v32
  v_mul_f32 v17, v17, v33
  ds_read_b64_tr_b16 v[86:87], v8 offset:8448
  s_waitcnt lgkmcnt(4)
  v_mfma_f32_16x16x32_bf16 v[104:107], v[92:95], a[24:27], v[104:107]
  v_mul_f32 v18, v18, v34
  v_mul_f32 v19, v19, v35
  s_add_u32 m0, s39, 98304
  s_nop 0
  buffer_load_dwordx4 v5, s[16:19], s40 offen lds
  s_add_u32 s40, s40, s41
  ds_read_b64_tr_b16 v[88:89], v7 offset:10240
  v_mfma_f32_16x16x32_bf16 v[108:111], v[92:95], a[28:31], v[108:111]
  v_add_f32 v12, 1.0, v12
  v_add_f32 v13, 1.0, v13
  ds_read_b64_tr_b16 v[90:91], v7 offset:10496
  s_waitcnt lgkmcnt(4)
  v_mfma_f32_16x16x32_bf16 v[96:99], v[80:83], a[32:35], v[96:99]
  v_add_f32 v14, 1.0, v14
  v_add_f32 v15, 1.0, v15
  v_rcp_f32 v12, v12
  ds_read_b64_tr_b16 v[92:93], v8 offset:10240
  v_mfma_f32_16x16x32_bf16 v[100:103], v[80:83], a[36:39], v[100:103]
  v_rcp_f32 v13, v13
  v_rcp_f32 v14, v14
  ds_read_b64_tr_b16 v[94:95], v8 offset:10496
  s_waitcnt lgkmcnt(4)
  v_mfma_f32_16x16x32_bf16 v[104:107], v[84:87], a[32:35], v[104:107]
  v_rcp_f32 v15, v15
  v_mul_f32 v16, v16, v12
  s_add_u32 m0, s39, 106496
  s_nop 0
  buffer_load_dwordx4 v5, s[16:19], s40 offen lds
  s_add_u32 s40, s40, s41
  ds_read_b64_tr_b16 v[80:81], v7 offset:12288
  v_mfma_f32_16x16x32_bf16 v[108:111], v[84:87], a[36:39], v[108:111]
  v_mul_f32 v17, v17, v13
  v_mul_f32 v18, v18, v14
  ds_read_b64_tr_b16 v[82:83], v7 offset:12544
  s_waitcnt lgkmcnt(4)
  v_mfma_f32_16x16x32_bf16 v[96:99], v[88:91], a[40:43], v[96:99]
  v_mul_f32 v19, v19, v15
  v_cvt_pk_bf16_f32 v32, v16, v17
  v_cvt_pk_bf16_f32 v33, v18, v19
  ds_read_b64_tr_b16 v[84:85], v8 offset:12288
  v_mfma_f32_16x16x32_bf16 v[100:103], v[88:91], a[44:47], v[100:103]
  buffer_store_dwordx2 v[32:33], v1, s[20:23], s38 offen offset:0 sc1
  v_mul_f32 v12, v20, v20
  ds_read_b64_tr_b16 v[86:87], v8 offset:12544
  s_waitcnt lgkmcnt(4)
  v_mfma_f32_16x16x32_bf16 v[104:107], v[92:95], a[40:43], v[104:107]
  v_mul_f32 v13, v21, v21
  v_mul_f32 v14, v22, v22
  s_add_u32 m0, s39, 114688
  s_nop 0
  buffer_load_dwordx4 v5, s[16:19], s40 offen lds
  s_add_u32 s40, s40, s41
  ds_read_b64_tr_b16 v[88:89], v7 offset:14336
  v_mfma_f32_16x16x32_bf16 v[108:111], v[92:95], a[44:47], v[108:111]
  v_mul_f32 v15, v23, v23
  v_fmaak_f32 v12, v12, v6, 0xc0135761
  ds_read_b64_tr_b16 v[90:91], v7 offset:14592
  s_waitcnt lgkmcnt(4)
  v_mfma_f32_16x16x32_bf16 v[96:99], v[80:83], a[48:51], v[96:99]
  v_fmaak_f32 v13, v13, v6, 0xc0135761
  v_fmaak_f32 v14, v14, v6, 0xc0135761
  v_fmaak_f32 v15, v15, v6, 0xc0135761
  ds_read_b64_tr_b16 v[92:93], v8 offset:14336
  v_mfma_f32_16x16x32_bf16 v[100:103], v[80:83], a[52:55], v[100:103]
  v_mul_f32 v12, v12, v20
  v_mul_f32 v13, v13, v21
  ds_read_b64_tr_b16 v[94:95], v8 offset:14592
  s_waitcnt lgkmcnt(4)
  v_mfma_f32_16x16x32_bf16 v[104:107], v[84:87], a[48:51], v[104:107]
  v_mul_f32 v14, v14, v22
  v_mul_f32 v15, v15, v23
  s_add_u32 m0, s39, 122880
  s_nop 0
  buffer_load_dwordx4 v5, s[16:19], s40 offen lds
  s_add_u32 s40, s40, s41
  ds_read_b64_tr_b16 v[80:81], v7 offset:16384
  v_mfma_f32_16x16x32_bf16 v[108:111], v[84:87], a[52:55], v[108:111]
  v_exp_f32 v12, v12
  v_exp_f32 v13, v13
  v_exp_f32 v14, v14
  ds_read_b64_tr_b16 v[82:83], v7 offset:16640
  s_waitcnt lgkmcnt(4)
  v_mfma_f32_16x16x32_bf16 v[96:99], v[88:91], a[56:59], v[96:99]
  v_exp_f32 v15, v15
  v_mul_f32 v20, v20, v36
  ds_read_b64_tr_b16 v[84:85], v8 offset:16384
  v_mfma_f32_16x16x32_bf16 v[100:103], v[88:91], a[60:63], v[100:103]
  v_mul_f32 v21, v21, v37
  v_mul_f32 v22, v22, v38
  ds_read_b64_tr_b16 v[86:87], v8 offset:16640
  s_waitcnt lgkmcnt(4)
  v_mfma_f32_16x16x32_bf16 v[104:107], v[92:95], a[56:59], v[104:107]
  v_mul_f32 v23, v23, v39
  v_add_f32 v12, 1.0, v12
  s_add_u32 m0, s39, 131072
  s_nop 0
  buffer_load_dwordx4 v5, s[16:19], s40 offen lds
  s_add_u32 s40, s40, s41
  ds_read_b64_tr_b16 v[88:89], v7 offset:18432
  v_mfma_f32_16x16x32_bf16 v[108:111], v[92:95], a[60:63], v[108:111]
  v_add_f32 v13, 1.0, v13
  v_add_f32 v14, 1.0, v14
  v_add_f32 v15, 1.0, v15
  ds_read_b64_tr_b16 v[90:91], v7 offset:18688
  s_waitcnt lgkmcnt(4)
  v_mfma_f32_16x16x32_bf16 v[96:99], v[80:83], a[64:67], v[96:99]
  v_rcp_f32 v12, v12
  v_rcp_f32 v13, v13
  ds_read_b64_tr_b16 v[92:93], v8 offset:18432
  v_mfma_f32_16x16x32_bf16 v[100:103], v[80:83], a[68:71], v[100:103]
  v_rcp_f32 v14, v14
  v_rcp_f32 v15, v15
  ds_read_b64_tr_b16 v[94:95], v8 offset:18688
  s_waitcnt lgkmcnt(4)
  v_mfma_f32_16x16x32_bf16 v[104:107], v[84:87], a[64:67], v[104:107]
  v_mul_f32 v20, v20, v12
  v_mul_f32 v21, v21, v13
  s_add_u32 m0, s39, 139264
  s_nop 0
  buffer_load_dwordx4 v5, s[16:19], s40 offen lds
  s_add_u32 s40, s40, s41
  ds_read_b64_tr_b16 v[80:81], v7 offset:20480
  v_mfma_f32_16x16x32_bf16 v[108:111], v[84:87], a[68:71], v[108:111]
  v_mul_f32 v22, v22, v14
  v_mul_f32 v23, v23, v15
  v_cvt_pk_bf16_f32 v34, v20, v21
  ds_read_b64_tr_b16 v[82:83], v7 offset:20736
  s_waitcnt lgkmcnt(4)
  v_mfma_f32_16x16x32_bf16 v[96:99], v[88:91], a[72:75], v[96:99]
  v_cvt_pk_bf16_f32 v35, v22, v23
  buffer_store_dwordx2 v[34:35], v1, s[20:23], s38 offen offset:256 sc1
  ds_read_b64_tr_b16 v[84:85], v8 offset:20480
  v_mfma_f32_16x16x32_bf16 v[100:103], v[88:91], a[76:79], v[100:103]
  v_mul_f32 v12, v24, v24
  v_mul_f32 v13, v25, v25
  ds_read_b64_tr_b16 v[86:87], v8 offset:20736
  s_waitcnt lgkmcnt(4)
  v_mfma_f32_16x16x32_bf16 v[104:107], v[92:95], a[72:75], v[104:107]
  v_mul_f32 v14, v26, v26
  v_mul_f32 v15, v27, v27
  v_fmaak_f32 v12, v12, v6, 0xc0135761
  ds_read_b64_tr_b16 v[88:89], v7 offset:22528
  v_mfma_f32_16x16x32_bf16 v[108:111], v[92:95], a[76:79], v[108:111]
  v_fmaak_f32 v13, v13, v6, 0xc0135761
  v_fmaak_f32 v14, v14, v6, 0xc0135761
  ds_read_b64_tr_b16 v[90:91], v7 offset:22784
  s_waitcnt lgkmcnt(4)
  v_mfma_f32_16x16x32_bf16 v[96:99], v[80:83], a[80:83], v[96:99]
  v_fmaak_f32 v15, v15, v6, 0xc0135761
  v_mul_f32 v12, v12, v24
  ds_read_b64_tr_b16 v[92:93], v8 offset:22528
  v_mfma_f32_16x16x32_bf16 v[100:103], v[80:83], a[84:87], v[100:103]
  v_mul_f32 v13, v13, v25
  v_mul_f32 v14, v14, v26
  ds_read_b64_tr_b16 v[94:95], v8 offset:22784
  s_waitcnt lgkmcnt(4)
  v_mfma_f32_16x16x32_bf16 v[104:107], v[84:87], a[80:83], v[104:107]
  v_mul_f32 v15, v15, v27
  v_exp_f32 v12, v12
  v_exp_f32 v13, v13
  ds_read_b64_tr_b16 v[80:81], v7 offset:24576
  v_mfma_f32_16x16x32_bf16 v[108:111], v[84:87], a[84:87], v[108:111]
  v_exp_f32 v14, v14
  v_exp_f32 v15, v15
  ds_read_b64_tr_b16 v[82:83], v7 offset:24832
  s_waitcnt lgkmcnt(4)
  v_mfma_f32_16x16x32_bf16 v[96:99], v[88:91], a[88:91], v[96:99]
  v_mul_f32 v24, v24, v40
  v_mul_f32 v25, v25, v41
  ds_read_b64_tr_b16 v[84:85], v8 offset:24576
  v_mfma_f32_16x16x32_bf16 v[100:103], v[88:91], a[92:95], v[100:103]
  v_mul_f32 v26, v26, v42
  v_mul_f32 v27, v27, v43
  ds_read_b64_tr_b16 v[86:87], v8 offset:24832
  s_waitcnt lgkmcnt(4)
  v_mfma_f32_16x16x32_bf16 v[104:107], v[92:95], a[88:91], v[104:107]
  v_add_f32 v12, 1.0, v12
  v_add_f32 v13, 1.0, v13
  v_add_f32 v14, 1.0, v14
  ds_read_b64_tr_b16 v[88:89], v7 offset:26624
  v_mfma_f32_16x16x32_bf16 v[108:111], v[92:95], a[92:95], v[108:111]
  v_add_f32 v15, 1.0, v15
  v_rcp_f32 v12, v12
  ds_read_b64_tr_b16 v[90:91], v7 offset:26880
  s_waitcnt lgkmcnt(4)
  v_mfma_f32_16x16x32_bf16 v[96:99], v[80:83], a[96:99], v[96:99]
  v_rcp_f32 v13, v13
  v_rcp_f32 v14, v14
  ds_read_b64_tr_b16 v[92:93], v8 offset:26624
  v_mfma_f32_16x16x32_bf16 v[100:103], v[80:83], a[100:103], v[100:103]
  v_rcp_f32 v15, v15
  v_mul_f32 v24, v24, v12
  v_mul_f32 v25, v25, v13
  ds_read_b64_tr_b16 v[94:95], v8 offset:26880
  s_waitcnt lgkmcnt(4)
  v_mfma_f32_16x16x32_bf16 v[104:107], v[84:87], a[96:99], v[104:107]
  v_mul_f32 v26, v26, v14
  v_mul_f32 v27, v27, v15
  ds_read_b64_tr_b16 v[80:81], v7 offset:28672
  v_mfma_f32_16x16x32_bf16 v[108:111], v[84:87], a[100:103], v[108:111]
  v_cvt_pk_bf16_f32 v36, v24, v25
  v_cvt_pk_bf16_f32 v37, v26, v27
  ds_read_b64_tr_b16 v[82:83], v7 offset:28928
  s_waitcnt lgkmcnt(4)
  v_mfma_f32_16x16x32_bf16 v[96:99], v[88:91], a[104:107], v[96:99]
  buffer_store_dwordx2 v[36:37], v1, s[20:23], s38 offen offset:1024 sc1
  v_mul_f32 v12, v28, v28
  ds_read_b64_tr_b16 v[84:85], v8 offset:28672
  v_mfma_f32_16x16x32_bf16 v[100:103], v[88:91], a[108:111], v[100:103]
  v_mul_f32 v13, v29, v29
  v_mul_f32 v14, v30, v30
  v_mul_f32 v15, v31, v31
  ds_read_b64_tr_b16 v[86:87], v8 offset:28928
  s_waitcnt lgkmcnt(4)
  v_mfma_f32_16x16x32_bf16 v[104:107], v[92:95], a[104:107], v[104:107]
  v_fmaak_f32 v12, v12, v6, 0xc0135761
  v_fmaak_f32 v13, v13, v6, 0xc0135761
  ds_read_b64_tr_b16 v[88:89], v7 offset:30720
  v_mfma_f32_16x16x32_bf16 v[108:111], v[92:95], a[108:111], v[108:111]
  v_fmaak_f32 v14, v14, v6, 0xc0135761
  v_fmaak_f32 v15, v15, v6, 0xc0135761
  ds_read_b64_tr_b16 v[90:91], v7 offset:30976
  s_waitcnt lgkmcnt(4)
  v_mfma_f32_16x16x32_bf16 v[96:99], v[80:83], a[112:115], v[96:99]
  v_mul_f32 v12, v12, v28
  v_mul_f32 v13, v13, v29
  ds_read_b64_tr_b16 v[92:93], v8 offset:30720
  v_mfma_f32_16x16x32_bf16 v[100:103], v[80:83], a[116:119], v[100:103]
  v_mul_f32 v14, v14, v30
  v_mul_f32 v15, v15, v31
  v_exp_f32 v12, v12
  ds_read_b64_tr_b16 v[94:95], v8 offset:30976
  s_waitcnt lgkmcnt(4)
  v_mfma_f32_16x16x32_bf16 v[104:107], v[84:87], a[112:115], v[104:107]
  v_exp_f32 v13, v13
  v_exp_f32 v14, v14
  ds_read_b64_tr_b16 v[80:81], v7 offset:32768
  v_mfma_f32_16x16x32_bf16 v[108:111], v[84:87], a[116:119], v[108:111]
  v_exp_f32 v15, v15
  v_mul_f32 v28, v28, v44
  ds_read_b64_tr_b16 v[82:83], v7 offset:33024
  s_waitcnt lgkmcnt(4)
  v_mfma_f32_16x16x32_bf16 v[96:99], v[88:91], a[120:123], v[96:99]
  v_mul_f32 v29, v29, v45
  v_mul_f32 v30, v30, v46
  v_mul_f32 v31, v31, v47
  ds_read_b64_tr_b16 v[84:85], v8 offset:32768
  v_mfma_f32_16x16x32_bf16 v[100:103], v[88:91], a[124:127], v[100:103]
  v_add_f32 v12, 1.0, v12
  v_add_f32 v13, 1.0, v13
  ds_read_b64_tr_b16 v[86:87], v8 offset:33024
  s_waitcnt lgkmcnt(4)
  v_mfma_f32_16x16x32_bf16 v[104:107], v[92:95], a[120:123], v[104:107]
  v_add_f32 v14, 1.0, v14
  v_add_f32 v15, 1.0, v15
  ds_read_b64_tr_b16 v[88:89], v7 offset:34816
  v_mfma_f32_16x16x32_bf16 v[108:111], v[92:95], a[124:127], v[108:111]
  v_rcp_f32 v12, v12
  v_rcp_f32 v13, v13
  ds_read_b64_tr_b16 v[90:91], v7 offset:35072
  s_waitcnt lgkmcnt(4)
  v_mfma_f32_16x16x32_bf16 v[96:99], v[80:83], a[128:131], v[96:99]
  v_rcp_f32 v14, v14
  v_rcp_f32 v15, v15
  v_mul_f32 v28, v28, v12
  ds_read_b64_tr_b16 v[92:93], v8 offset:34816
  v_mfma_f32_16x16x32_bf16 v[100:103], v[80:83], a[132:135], v[100:103]
  v_mul_f32 v29, v29, v13
  v_mul_f32 v30, v30, v14
  ds_read_b64_tr_b16 v[94:95], v8 offset:35072
  s_waitcnt lgkmcnt(4)
  v_mfma_f32_16x16x32_bf16 v[104:107], v[84:87], a[128:131], v[104:107]
  v_mul_f32 v31, v31, v15
  v_cvt_pk_bf16_f32 v38, v28, v29
  v_mfma_f32_16x16x32_bf16 v[108:111], v[84:87], a[132:135], v[108:111]
  v_cvt_pk_bf16_f32 v39, v30, v31
  buffer_store_dwordx2 v[38:39], v1, s[20:23], s38 offen offset:1280 sc1
  s_add_u32 s38, s38, 2048
  s_waitcnt lgkmcnt(2)
  v_mfma_f32_16x16x32_bf16 v[96:99], v[88:91], a[136:139], v[96:99]
  v_mfma_f32_16x16x32_bf16 v[100:103], v[88:91], a[140:143], v[100:103]
  s_waitcnt vmcnt(3)
  s_waitcnt lgkmcnt(0)
  s_barrier
  v_lshrrev_b32 v7, 5, v0
  v_lshlrev_b32 v7, 11, v7
  v_add_u32 v7, v7, v11
  v_add_u32 v7, 73728, v7
  v_xor_b32 v8, 32, v7
  v_add_u32 v9, 0x10000, v7
  v_add_u32 v10, 0x10000, v8
  v_mfma_f32_16x16x32_bf16 v[104:107], v[92:95], a[136:139], v[104:107]
  ds_read_b64_tr_b16 v[80:81], v7 offset:0
  ds_read_b64_tr_b16 v[82:83], v7 offset:256
  ds_read_b64_tr_b16 v[84:85], v8 offset:0
  v_mfma_f32_16x16x32_bf16 v[108:111], v[92:95], a[140:143], v[108:111]
  ds_read_b64_tr_b16 v[86:87], v8 offset:256
  ds_read_b64_tr_b16 v[88:89], v7 offset:1024
  ds_read_b64_tr_b16 v[90:91], v7 offset:1280
  ds_read_b64_tr_b16 v[92:93], v8 offset:1024
  ds_read_b64_tr_b16 v[94:95], v8 offset:1280
  s_cmp_ge_u32 s36, 18
  s_cselect_b32 s42, 2322432, 0
  s_cselect_b32 s44, 1.0, 0x3eae1a93
  s_lshl_b32 s43, s36, 11
  s_add_u32 s42, s42, s43
  v_lshrrev_b32 v12, 5, v0
  v_lshlrev_b32 v12, 9, v12
  v_bfe_u32 v13, v0, 4, 1
  v_lshl_add_u32 v12, v13, 8, v12
  v_and_b32 v13, 15, v0
  v_lshl_add_u32 v12, v13, 3, v12
  s_mul_i32 s43, s33, 36864
  s_add_u32 s42, s42, s43
  v_mul_f32 v96, s44, v96
  v_mul_f32 v97, s44, v97
  v_mul_f32 v98, s44, v98
  v_mul_f32 v99, s44, v99
  v_mul_f32 v100, s44, v100
  v_mul_f32 v101, s44, v101
  v_mul_f32 v102, s44, v102
  v_mul_f32 v103, s44, v103
  v_mul_f32 v104, s44, v104
  v_mul_f32 v105, s44, v105
  v_mul_f32 v106, s44, v106
  v_mul_f32 v107, s44, v107
  v_mul_f32 v108, s44, v108
  v_mul_f32 v109, s44, v109
  v_mul_f32 v110, s44, v110
  v_mul_f32 v111, s44, v111
  v_cvt_pk_bf16_f32 v96, v96, v97
  v_cvt_pk_bf16_f32 v97, v98, v99
  v_cvt_pk_bf16_f32 v98, v100, v101
  v_cvt_pk_bf16_f32 v99, v102, v103
  v_cvt_pk_bf16_f32 v100, v104, v105
  v_cvt_pk_bf16_f32 v101, v106, v107
  v_cvt_pk_bf16_f32 v102, v108, v109
  v_cvt_pk_bf16_f32 v103, v110, v111
  buffer_store_dwordx2 v[96:97], v12, s[24:27], s42 offen offset:0 sc1
  buffer_store_dwordx2 v[98:99], v12, s[24:27], s42 offen offset:128 sc1
  buffer_store_dwordx2 v[100:101], v12, s[24:27], s42 offen offset:1024 sc1
  buffer_store_dwordx2 v[102:103], v12, s[24:27], s42 offen offset:1152 sc1
  s_add_u32 s36, s36, 16
  s_nop 0
  s_mov_b32 s16, s28
  s_mov_b32 s17, s29
  s_mov_b32 s18, 5308416
  s_add_u32 s40, s37, s53
  s_mov_b32 s41, 589824
  v_mov_b32 v5, v4
L_k1_p0:
  s_waitcnt lgkmcnt(6)
  v_mfma_f32_16x16x32_bf16 v[16:19], v[80:83], a[0:3], 0
  ds_read_b64_tr_b16 v[96:97], v7 offset:4096
  v_mfma_f32_16x16x32_bf16 v[20:23], v[80:83], a[4:7], 0
  ds_read_b64_tr_b16 v[98:99], v7 offset:4352
  s_waitcnt lgkmcnt(6)
  v_mfma_f32_16x16x32_bf16 v[24:27], v[84:87], a[0:3], 0
  s_add_u32 m0, s39, 0
  s_nop 0
  buffer_load_dwordx4 v5, s[16:19], s40 offen lds
  s_add_u32 s40, s40, s41
  ds_read_b64_tr_b16 v[100:101], v8 offset:4096
  v_mfma_f32_16x16x32_bf16 v[28:31], v[84:87], a[4:7], 0
  ds_read_b64_tr_b16 v[102:103], v8 offset:4352
  s_waitcnt lgkmcnt(6)
  v_mfma_f32_16x16x32_bf16 v[32:35], v[88:91], a[0:3], 0
  ds_read_b64_tr_b16 v[80:81], v7 offset:5120
  v_mfma_f32_16x16x32_bf16 v[36:39], v[88:91], a[4:7], 0
  ds_read_b64_tr_b16 v[82:83], v7 offset:5376
  s_waitcnt lgkmcnt(6)
  v_mfma_f32_16x16x32_bf16 v[40:43], v[92:95], a[0:3], 0
  v_mul_f32 v12, v48, v48
  ds_read_b64_tr_b16 v[84:85], v8 offset:5120
  v_mfma_f32_16x16x32_bf16 v[44:47], v[92:95], a[4:7], 0
  v_mul_f32 v13, v49, v49
  ds_read_b64_tr_b16 v[86:87], v8 offset:5376
  s_waitcnt lgkmcnt(6)
  v_mfma_f32_16x16x32_bf16 v[16:19], v[96:99], a[8:11], v[16:19]
  v_mul_f32 v14, v50, v50
  ds_read_b64_tr_b16 v[88:89], v7 offset:8192
  v_mfma_f32_16x16x32_bf16 v[20:23], v[96:99], a[12:15], v[20:23]
  v_mul_f32 v15, v51, v51
  ds_read_b64_tr_b16 v[90:91], v7 offset:8448
  s_waitcnt lgkmcnt(6)
  v_mfma_f32_16x16x32_bf16 v[24:27], v[100:103], a[8:11], v[24:27]
  v_fmaak_f32 v12, v12, v6, 0xc0135761
  s_add_u32 m0, s39, 8192
  s_nop 0
  buffer_load_dwordx4 v5, s[16:19], s40 offen lds
  s_add_u32 s40, s40, s41
  ds_read_b64_tr_b16 v[92:93], v8 offset:8192
  v_mfma_f32_16x16x32_bf16 v[28:31], v[100:103], a[12:15], v[28:31]
  v_fmaak_f32 v13, v13, v6, 0xc0135761
  ds_read_b64_tr_b16 v[94:95], v8 offset:8448
  s_waitcnt lgkmcnt(6)
  v_mfma_f32_16x16x32_bf16 v[32:35], v[80:83], a[8:11], v[32:35]
  v_fmaak_f32 v14, v14, v6, 0xc0135761
  ds_read_b64_tr_b16 v[96:97], v7 offset:9216
  v_mfma_f32_16x16x32_bf16 v[36:39], v[80:83], a[12:15], v[36:39]
  v_fmaak_f32 v15, v15, v6, 0xc0135761
  ds_read_b64_tr_b16 v[98:99], v7 offset:9472
  s_waitcnt lgkmcnt(6)
  v_mfma_f32_16x16x32_bf16 v[40:43], v[84:87], a[8:11], v[40:43]
  v_mul_f32 v12, v12, v48
  v_mul_f32 v13, v13, v49
  ds_read_b64_tr_b16 v[100:101], v8 offset:9216
  v_mfma_f32_16x16x32_bf16 v[44:47], v[84:87], a[12:15], v[44:47]
  v_mul_f32 v14, v14, v50
  ds_read_b64_tr_b16 v[102:103], v8 offset:9472
  s_waitcnt lgkmcnt(6)
  v_mfma_f32_16x16x32_bf16 v[16:19], v[88:91], a[16:19], v[16:19]
  v_mul_f32 v15, v15, v51
  ds_read_b64_tr_b16 v[80:81], v7 offset:12288
  v_mfma_f32_16x16x32_bf16 v[20:23], v[88:91], a[20:23], v[20:23]
  v_exp_f32 v12, v12
  ds_read_b64_tr_b16 v[82:83], v7 offset:12544
  s_waitcnt lgkmcnt(6)
  v_mfma_f32_16x16x32_bf16 v[24:27], v[92:95], a[16:19], v[24:27]
  v_exp_f32 v13, v13
  s_add_u32 m0, s39, 16384
  s_nop 0
  buffer_load_dwordx4 v5, s[16:19], s40 offen lds
  s_add_u32 s40, s40, s41
  ds_read_b64_tr_b16 v[84:85], v8 offset:12288
  v_mfma_f32_16x16x32_bf16 v[28:31], v[92:95], a[20:23], v[28:31]
  v_exp_f32 v14, v14
  ds_read_b64_tr_b16 v[86:87], v8 offset:12544
  s_waitcnt lgkmcnt(6)
  v_mfma_f32_16x16x32_bf16 v[32:35], v[96:99], a[16:19], v[32:35]
  v_exp_f32 v15, v15
  ds_read_b64_tr_b16 v[88:89], v7 offset:13312
  v_mfma_f32_16x16x32_bf16 v[36:39], v[96:99], a[20:23], v[36:39]
  v_mul_f32 v48, v48, v64
  ds_read_b64_tr_b16 v[90:91], v7 offset:13568
  s_waitcnt lgkmcnt(6)
  v_mfma_f32_16x16x32_bf16 v[40:43], v[100:103], a[16:19], v[40:43]
  v_mul_f32 v49, v49, v65
  v_mul_f32 v50, v50, v66
  ds_read_b64_tr_b16 v[92:93], v8 offset:13312
  v_mfma_f32_16x16x32_bf16 v[44:47], v[100:103], a[20:23], v[44:47]
  v_mul_f32 v51, v51, v67
  ds_read_b64_tr_b16 v[94:95], v8 offset:13568
  s_waitcnt lgkmcnt(6)
  v_mfma_f32_16x16x32_bf16 v[16:19], v[80:83], a[24:27], v[16:19]
  v_add_f32 v12, 1.0, v12
  ds_read_b64_tr_b16 v[96:97], v7 offset:16384
  v_mfma_f32_16x16x32_bf16 v[20:23], v[80:83], a[28:31], v[20:23]
  v_add_f32 v13, 1.0, v13
  ds_read_b64_tr_b16 v[98:99], v7 offset:16640
  s_waitcnt lgkmcnt(6)
  v_mfma_f32_16x16x32_bf16 v[24:27], v[84:87], a[24:27], v[24:27]
  v_add_f32 v14, 1.0, v14
  s_add_u32 m0, s39, 24576
  s_nop 0
  buffer_load_dwordx4 v5, s[16:19], s40 offen lds
  s_add_u32 s40, s40, s41
  ds_read_b64_tr_b16 v[100:101], v8 offset:16384
  v_mfma_f32_16x16x32_bf16 v[28:31], v[84:87], a[28:31], v[28:31]
  v_add_f32 v15, 1.0, v15
  ds_read_b64_tr_b16 v[102:103], v8 offset:16640
  s_waitcnt lgkmcnt(6)
  v_mfma_f32_16x16x32_bf16 v[32:35], v[88:91], a[24:27], v[32:35]
  v_rcp_f32 v12, v12
  ds_read_b64_tr_b16 v[80:81], v7 offset:17408
  v_mfma_f32_16x16x32_bf16 v[36:39], v[88:91], a[28:31], v[36:39]
  v_rcp_f32 v13, v13
  ds_read_b64_tr_b16 v[82:83], v7 offset:17664
  s_waitcnt lgkmcnt(6)
  v_mfma_f32_16x16x32_bf16 v[40:43], v[92:95], a[24:27], v[40:43]
  v_rcp_f32 v14, v14
  ds_read_b64_tr_b16 v[84:85], v8 offset:17408
  v_mfma_f32_16x16x32_bf16 v[44:47], v[92:95], a[28:31], v[44:47]
  v_rcp_f32 v15, v15
  v_mul_f32 v48, v48, v12
  ds_read_b64_tr_b16 v[86:87], v8 offset:17664
  s_waitcnt lgkmcnt(6)
  v_mfma_f32_16x16x32_bf16 v[16:19], v[96:99], a[32:35], v[16:19]
  v_mul_f32 v49, v49, v13
  ds_read_b64_tr_b16 v[88:89], v7 offset:20480
  v_mfma_f32_16x16x32_bf16 v[20:23], v[96:99], a[36:39], v[20:23]
  v_mul_f32 v50, v50, v14
  ds_read_b64_tr_b16 v[90:91], v7 offset:20736
  s_waitcnt lgkmcnt(6)
  v_mfma_f32_16x16x32_bf16 v[24:27], v[100:103], a[32:35], v[24:27]
  v_mul_f32 v51, v51, v15
  s_add_u32 m0, s39, 32768
  s_nop 0
  buffer_load_dwordx4 v5, s[16:19], s40 offen lds
  s_add_u32 s40, s40, s41
  ds_read_b64_tr_b16 v[92:93], v8 offset:20480
  v_mfma_f32_16x16x32_bf16 v[28:31], v[100:103], a[36:39], v[28:31]
  v_cvt_pk_bf16_f32 v64, v48, v49
  ds_read_b64_tr_b16 v[94:95], v8 offset:20736
  s_waitcnt lgkmcnt(6)
  v_mfma_f32_16x16x32_bf16 v[32:35], v[80:83], a[32:35], v[32:35]
  v_cvt_pk_bf16_f32 v65, v50, v51
  ds_read_b64_tr_b16 v[96:97], v7 offset:21504
  v_mfma_f32_16x16x32_bf16 v[36:39], v[80:83], a[36:39], v[36:39]
  buffer_store_dwordx2 v[64:65], v1, s[20:23], s38 offen offset:0 sc1
  ds_read_b64_tr_b16 v[98:99], v7 offset:21760
  s_waitcnt lgkmcnt(6)
  v_mfma_f32_16x16x32_bf16 v[40:43], v[84:87], a[32:35], v[40:43]
  v_mul_f32 v12, v52, v52
  ds_read_b64_tr_b16 v[100:101], v8 offset:21504
  v_mfma_f32_16x16x32_bf16 v[44:47], v[84:87], a[36:39], v[44:47]
  v_mul_f32 v13, v53, v53
  v_mul_f32 v14, v54, v54
  ds_read_b64_tr_b16 v[102:103], v8 offset:21760
  s_waitcnt lgkmcnt(6)
  v_mfma_f32_16x16x32_bf16 v[16:19], v[88:91], a[40:43], v[16:19]
  v_mul_f32 v15, v55, v55
  ds_read_b64_tr_b16 v[80:81], v7 offset:24576
  v_mfma_f32_16x16x32_bf16 v[20:23], v[88:91], a[44:47], v[20:23]
  v_fmaak_f32 v12, v12, v6, 0xc0135761
  ds_read_b64_tr_b16 v[82:83], v7 offset:24832
  s_waitcnt lgkmcnt(6)
  v_mfma_f32_16x16x32_bf16 v[24:27], v[92:95], a[40:43], v[24:27]
  v_fmaak_f32 v13, v13, v6, 0xc0135761
  s_add_u32 m0, s39, 40960
  s_nop 0
  buffer_load_dwordx4 v5, s[16:19], s40 offen lds
  s_add_u32 s40, s40, s41
  ds_read_b64_tr_b16 v[84:85], v8 offset:24576
  v_mfma_f32_16x16x32_bf16 v[28:31], v[92:95], a[44:47], v[28:31]
  v_fmaak_f32 v14, v14, v6, 0xc0135761
  ds_read_b64_tr_b16 v[86:87], v8 offset:24832
  s_waitcnt lgkmcnt(6)
  v_mfma_f32_16x16x32_bf16 v[32:35], v[96:99], a[40:43], v[32:35]
  v_fmaak_f32 v15, v15, v6, 0xc0135761
  ds_read_b64_tr_b16 v[88:89], v7 offset:25600
  v_mfma_f32_16x16x32_bf16 v[36:39], v[96:99], a[44:47], v[36:39]
  v_mul_f32 v12, v12, v52
  ds_read_b64_tr_b16 v[90:91], v7 offset:25856
  s_waitcnt lgkmcnt(6)
  v_mfma_f32_16x16x32_bf16 v[40:43], v[100:103], a[40:43], v[40:43]
  v_mul_f32 v13, v13, v53
  ds_read_b64_tr_b16 v[92:93], v8 offset:25600
  v_mfma_f32_16x16x32_bf16 v[44:47], v[100:103], a[44:47], v[44:47]
  v_mul_f32 v14, v14, v54
  v_mul_f32 v15, v15, v55
  ds_read_b64_tr_b16 v[94:95], v8 offset:25856
  s_waitcnt lgkmcnt(6)
  v_mfma_f32_16x16x32_bf16 v[16:19], v[80:83], a[48:51], v[16:19]
  v_exp_f32 v12, v12
  ds_read_b64_tr_b16 v[96:97], v7 offset:28672
  v_mfma_f32_16x16x32_bf16 v[20:23], v[80:83], a[52:55], v[20:23]
  v_exp_f32 v13, v13
  ds_read_b64_tr_b16 v[98:99], v7 offset:28928
  s_waitcnt lgkmcnt(6)
  v_mfma_f32_16x16x32_bf16 v[24:27], v[84:87], a[48:51], v[24:27]
  v_exp_f32 v14, v14
  s_add_u32 m0, s39, 49152
  s_nop 0
  buffer_load_dwordx4 v5, s[16:19], s40 offen lds
  s_add_u32 s40, s40, s41
  ds_read_b64_tr_b16 v[100:101], v8 offset:28672
  v_mfma_f32_16x16x32_bf16 v[28:31], v[84:87], a[52:55], v[28:31]
  v_exp_f32 v15, v15
  ds_read_b64_tr_b16 v[102:103], v8 offset:28928
  s_waitcnt lgkmcnt(6)
  v_mfma_f32_16x16x32_bf16 v[32:35], v[88:91], a[48:51], v[32:35]
  v_mul_f32 v52, v52, v68
  ds_read_b64_tr_b16 v[80:81], v7 offset:29696
  v_mfma_f32_16x16x32_bf16 v[36:39], v[88:91], a[52:55], v[36:39]
  v_mul_f32 v53, v53, v69
  ds_read_b64_tr_b16 v[82:83], v7 offset:29952
  s_waitcnt lgkmcnt(6)
  v_mfma_f32_16x16x32_bf16 v[40:43], v[92:95], a[48:51], v[40:43]
  v_mul_f32 v54, v54, v70
  ds_read_b64_tr_b16 v[84:85], v8 offset:29696
  v_mfma_f32_16x16x32_bf16 v[44:47], v[92:95], a[52:55], v[44:47]
  v_mul_f32 v55, v55, v71
  ds_read_b64_tr_b16 v[86:87], v8 offset:29952
  s_waitcnt lgkmcnt(6)
  v_mfma_f32_16x16x32_bf16 v[16:19], v[96:99], a[56:59], v[16:19]
  v_add_f32 v12, 1.0, v12
  v_add_f32 v13, 1.0, v13
  ds_read_b64_tr_b16 v[88:89], v7 offset:32768
  v_mfma_f32_16x16x32_bf16 v[20:23], v[96:99], a[60:63], v[20:23]
  v_add_f32 v14, 1.0, v14
  ds_read_b64_tr_b16 v[90:91], v7 offset:33024
  s_waitcnt lgkmcnt(6)
  v_mfma_f32_16x16x32_bf16 v[24:27], v[100:103], a[56:59], v[24:27]
  v_add_f32 v15, 1.0, v15
  s_add_u32 m0, s39, 57344
  s_nop 0
  buffer_load_dwordx4 v5, s[16:19], s40 offen lds
  s_add_u32 s40, s40, s41
  ds_read_b64_tr_b16 v[92:93], v8 offset:32768
  v_mfma_f32_16x16x32_bf16 v[28:31], v[100:103], a[60:63], v[28:31]
  v_rcp_f32 v12, v12
  ds_read_b64_tr_b16 v[94:95], v8 offset:33024
  s_waitcnt lgkmcnt(6)
  v_mfma_f32_16x16x32_bf16 v[32:35], v[80:83], a[56:59], v[32:35]
  v_rcp_f32 v13, v13
  ds_read_b64_tr_b16 v[96:97], v7 offset:33792
  v_mfma_f32_16x16x32_bf16 v[36:39], v[80:83], a[60:63], v[36:39]
  v_rcp_f32 v14, v14
  ds_read_b64_tr_b16 v[98:99], v7 offset:34048
  s_waitcnt lgkmcnt(6)
  v_mfma_f32_16x16x32_bf16 v[40:43], v[84:87], a[56:59], v[40:43]
  v_rcp_f32 v15, v15
  ds_read_b64_tr_b16 v[100:101], v8 offset:33792
  v_mfma_f32_16x16x32_bf16 v[44:47], v[84:87], a[60:63], v[44:47]
  v_mul_f32 v52, v52, v12
  ds_read_b64_tr_b16 v[102:103], v8 offset:34048
  s_waitcnt lgkmcnt(6)
  v_mfma_f32_16x16x32_bf16 v[16:19], v[88:91], a[64:67], v[16:19]
  v_mul_f32 v53, v53, v13
  v_mul_f32 v54, v54, v14
  ds_read_b64_tr_b16 v[80:81], v7 offset:36864
  v_mfma_f32_16x16x32_bf16 v[20:23], v[88:91], a[68:71], v[20:23]
  v_mul_f32 v55, v55, v15
  ds_read_b64_tr_b16 v[82:83], v7 offset:37120
  s_waitcnt lgkmcnt(6)
  v_mfma_f32_16x16x32_bf16 v[24:27], v[92:95], a[64:67], v[24:27]
  v_cvt_pk_bf16_f32 v66, v52, v53
  s_add_u32 m0, s39, 65536
  s_nop 0
  buffer_load_dwordx4 v5, s[16:19], s40 offen lds
  s_add_u32 s40, s40, s41
  ds_read_b64_tr_b16 v[84:85], v8 offset:36864
  v_mfma_f32_16x16x32_bf16 v[28:31], v[92:95], a[68:71], v[28:31]
  v_cvt_pk_bf16_f32 v67, v54, v55
  ds_read_b64_tr_b16 v[86:87], v8 offset:37120
  s_waitcnt lgkmcnt(6)
  v_mfma_f32_16x16x32_bf16 v[32:35], v[96:99], a[64:67], v[32:35]
  buffer_store_dwordx2 v[66:67], v1, s[20:23], s38 offen offset:256 sc1
  ds_read_b64_tr_b16 v[88:89], v7 offset:37888
  v_mfma_f32_16x16x32_bf16 v[36:39], v[96:99], a[68:71], v[36:39]
  v_mul_f32 v12, v56, v56
  ds_read_b64_tr_b16 v[90:91], v7 offset:38144
  s_waitcnt lgkmcnt(6)
  v_mfma_f32_16x16x32_bf16 v[40:43], v[100:103], a[64:67], v[40:43]
  v_mul_f32 v13, v57, v57
  ds_read_b64_tr_b16 v[92:93], v8 offset:37888
  v_mfma_f32_16x16x32_bf16 v[44:47], v[100:103], a[68:71], v[44:47]
  v_mul_f32 v14, v58, v58
  ds_read_b64_tr_b16 v[94:95], v8 offset:38144
  s_waitcnt lgkmcnt(6)
  v_mfma_f32_16x16x32_bf16 v[16:19], v[80:83], a[72:75], v[16:19]
  v_mul_f32 v15, v59, v59
  ds_read_b64_tr_b16 v[96:97], v7 offset:40960
  v_mfma_f32_16x16x32_bf16 v[20:23], v[80:83], a[76:79], v[20:23]
  v_fmaak_f32 v12, v12, v6, 0xc0135761
  v_fmaak_f32 v13, v13, v6, 0xc0135761
  ds_read_b64_tr_b16 v[98:99], v7 offset:41216
  s_waitcnt lgkmcnt(6)
  v_mfma_f32_16x16x32_bf16 v[24:27], v[84:87], a[72:75], v[24:27]
  v_fmaak_f32 v14, v14, v6, 0xc0135761
  ds_read_b64_tr_b16 v[100:101], v8 offset:40960
  v_mfma_f32_16x16x32_bf16 v[28:31], v[84:87], a[76:79], v[28:31]
  v_fmaak_f32 v15, v15, v6, 0xc0135761
  ds_read_b64_tr_b16 v[102:103], v8 offset:41216
  s_waitcnt lgkmcnt(6)
  v_mfma_f32_16x16x32_bf16 v[32:35], v[88:91], a[72:75], v[32:35]
  v_mul_f32 v12, v12, v56
  ds_read_b64_tr_b16 v[80:81], v7 offset:41984
  v_mfma_f32_16x16x32_bf16 v[36:39], v[88:91], a[76:79], v[36:39]
  v_mul_f32 v13, v13, v57
  ds_read_b64_tr_b16 v[82:83], v7 offset:42240
  s_waitcnt lgkmcnt(6)
  v_mfma_f32_16x16x32_bf16 v[40:43], v[92:95], a[72:75], v[40:43]
  v_mul_f32 v14, v14, v58
  ds_read_b64_tr_b16 v[84:85], v8 offset:41984
  v_mfma_f32_16x16x32_bf16 v[44:47], v[92:95], a[76:79], v[44:47]
  v_mul_f32 v15, v15, v59
  ds_read_b64_tr_b16 v[86:87], v8 offset:42240
  s_waitcnt lgkmcnt(6)
  v_mfma_f32_16x16x32_bf16 v[16:19], v[96:99], a[80:83], v[16:19]
  v_exp_f32 v12, v12
  ds_read_b64_tr_b16 v[88:89], v7 offset:45056
  v_mfma_f32_16x16x32_bf16 v[20:23], v[96:99], a[84:87], v[20:23]
  v_exp_f32 v13, v13
  v_exp_f32 v14, v14
  ds_read_b64_tr_b16 v[90:91], v7 offset:45312
  s_waitcnt lgkmcnt(6)
  v_mfma_f32_16x16x32_bf16 v[24:27], v[100:103], a[80:83], v[24:27]
  v_exp_f32 v15, v15
  ds_read_b64_tr_b16 v[92:93], v8 offset:45056
  v_mfma_f32_16x16x32_bf16 v[28:31], v[100:103], a[84:87], v[28:31]
  v_mul_f32 v56, v56, v72
  ds_read_b64_tr_b16 v[94:95], v8 offset:45312
  s_waitcnt lgkmcnt(6)
  v_mfma_f32_16x16x32_bf16 v[32:35], v[80:83], a[80:83], v[32:35]
  v_mul_f32 v57, v57, v73
  ds_read_b64_tr_b16 v[96:97], v7 offset:46080
  v_mfma_f32_16x16x32_bf16 v[36:39], v[80:83], a[84:87], v[36:39]
  v_mul_f32 v58, v58, v74
  ds_read_b64_tr_b16 v[98:99], v7 offset:46336
  s_waitcnt lgkmcnt(6)
  v_mfma_f32_16x16x32_bf16 v[40:43], v[84:87], a[80:83], v[40:43]
  v_mul_f32 v59, v59, v75
  ds_read_b64_tr_b16 v[100:101], v8 offset:46080
  v_mfma_f32_16x16x32_bf16 v[44:47], v[84:87], a[84:87], v[44:47]
  v_add_f32 v12, 1.0, v12
  ds_read_b64_tr_b16 v[102:103], v8 offset:46336
  s_waitcnt lgkmcnt(6)
  v_mfma_f32_16x16x32_bf16 v[16:19], v[88:91], a[88:91], v[16:19]
  v_add_f32 v13, 1.0, v13
  ds_read_b64_tr_b16 v[80:81], v7 offset:49152
  v_mfma_f32_16x16x32_bf16 v[20:23], v[88:91], a[92:95], v[20:23]
  v_add_f32 v14, 1.0, v14
  v_add_f32 v15, 1.0, v15
  ds_read_b64_tr_b16 v[82:83], v7 offset:49408
  s_waitcnt lgkmcnt(6)
  v_mfma_f32_16x16x32_bf16 v[24:27], v[92:95], a[88:91], v[24:27]
  v_rcp_f32 v12, v12
  ds_read_b64_tr_b16 v[84:85], v8 offset:49152
  v_mfma_f32_16x16x32_bf16 v[28:31], v[92:95], a[92:95], v[28:31]
  v_rcp_f32 v13, v13
  ds_read_b64_tr_b16 v[86:87], v8 offset:49408
  s_waitcnt lgkmcnt(6)
  v_mfma_f32_16x16x32_bf16 v[32:35], v[96:99], a[88:91], v[32:35]
  v_rcp_f32 v14, v14
  ds_read_b64_tr_b16 v[88:89], v7 offset:50176
  v_mfma_f32_16x16x32_bf16 v[36:39], v[96:99], a[92:95], v[36:39]
  v_rcp_f32 v15, v15
  ds_read_b64_tr_b16 v[90:91], v7 offset:50432
  s_waitcnt lgkmcnt(6)
  v_mfma_f32_16x16x32_bf16 v[40:43], v[100:103], a[88:91], v[40:43]
  v_mul_f32 v56, v56, v12
  ds_read_b64_tr_b16 v[92:93], v8 offset:50176
  v_mfma_f32_16x16x32_bf16 v[44:47], v[100:103], a[92:95], v[44:47]
  v_mul_f32 v57, v57, v13
  ds_read_b64_tr_b16 v[94:95], v8 offset:50432
  s_waitcnt lgkmcnt(6)
  v_mfma_f32_16x16x32_bf16 v[16:19], v[80:83], a[96:99], v[16:19]
  v_mul_f32 v58, v58, v14
  ds_read_b64_tr_b16 v[96:97], v7 offset:53248
  v_mfma_f32_16x16x32_bf16 v[20:23], v[80:83], a[100:103], v[20:23]
  v_mul_f32 v59, v59, v15
  ds_read_b64_tr_b16 v[98:99], v7 offset:53504
  s_waitcnt lgkmcnt(6)
  v_mfma_f32_16x16x32_bf16 v[24:27], v[84:87], a[96:99], v[24:27]
  v_cvt_pk_bf16_f32 v68, v56, v57
  v_cvt_pk_bf16_f32 v69, v58, v59
  ds_read_b64_tr_b16 v[100:101], v8 offset:53248
  v_mfma_f32_16x16x32_bf16 v[28:31], v[84:87], a[100:103], v[28:31]
  buffer_store_dwordx2 v[68:69], v1, s[20:23], s38 offen offset:1024 sc1
  ds_read_b64_tr_b16 v[102:103], v8 offset:53504
  s_waitcnt lgkmcnt(6)
  v_mfma_f32_16x16x32_bf16 v[32:35], v[88:91], a[96:99], v[32:35]
  v_mul_f32 v12, v60, v60
  ds_read_b64_tr_b16 v[80:81], v7 offset:54272
  v_mfma_f32_16x16x32_bf16 v[36:39], v[88:91], a[100:103], v[36:39]
  v_mul_f32 v13, v61, v61
  ds_read_b64_tr_b16 v[82:83], v7 offset:54528
  s_waitcnt lgkmcnt(6)
  v_mfma_f32_16x16x32_bf16 v[40:43], v[92:95], a[96:99], v[40:43]
  v_mul_f32 v14, v62, v62
  ds_read_b64_tr_b16 v[84:85], v8 offset:54272
  v_mfma_f32_16x16x32_bf16 v[44:47], v[92:95], a[100:103], v[44:47]
  v_mul_f32 v15, v63, v63
  ds_read_b64_tr_b16 v[86:87], v8 offset:54528
  s_waitcnt lgkmcnt(6)
  v_mfma_f32_16x16x32_bf16 v[16:19], v[96:99], a[104:107], v[16:19]
  v_fmaak_f32 v12, v12, v6, 0xc0135761
  ds_read_b64_tr_b16 v[88:89], v7 offset:57344
  v_mfma_f32_16x16x32_bf16 v[20:23], v[96:99], a[108:111], v[20:23]
  v_fmaak_f32 v13, v13, v6, 0xc0135761
  ds_read_b64_tr_b16 v[90:91], v7 offset:57600
  s_waitcnt lgkmcnt(6)
  v_mfma_f32_16x16x32_bf16 v[24:27], v[100:103], a[104:107], v[24:27]
  v_fmaak_f32 v14, v14, v6, 0xc0135761
  v_fmaak_f32 v15, v15, v6, 0xc0135761
  ds_read_b64_tr_b16 v[92:93], v8 offset:57344
  v_mfma_f32_16x16x32_bf16 v[28:31], v[100:103], a[108:111], v[28:31]
  v_mul_f32 v12, v12, v60
  ds_read_b64_tr_b16 v[94:95], v8 offset:57600
  s_waitcnt lgkmcnt(6)
  v_mfma_f32_16x16x32_bf16 v[32:35], v[80:83], a[104:107], v[32:35]
  v_mul_f32 v13, v13, v61
  ds_read_b64_tr_b16 v[96:97], v7 offset:58368
  v_mfma_f32_16x16x32_bf16 v[36:39], v[80:83], a[108:111], v[36:39]
  v_mul_f32 v14, v14, v62
  ds_read_b64_tr_b16 v[98:99], v7 offset:58624
  s_waitcnt lgkmcnt(6)
  v_mfma_f32_16x16x32_bf16 v[40:43], v[84:87], a[104:107], v[40:43]
  v_mul_f32 v15, v15, v63
  ds_read_b64_tr_b16 v[100:101], v8 offset:58368
  v_mfma_f32_16x16x32_bf16 v[44:47], v[84:87], a[108:111], v[44:47]
  v_exp_f32 v12, v12
  ds_read_b64_tr_b16 v[102:103], v8 offset:58624
  s_waitcnt lgkmcnt(6)
  v_mfma_f32_16x16x32_bf16 v[16:19], v[88:91], a[112:115], v[16:19]
  v_exp_f32 v13, v13
  ds_read_b64_tr_b16 v[80:81], v7 offset:61440
  v_mfma_f32_16x16x32_bf16 v[20:23], v[88:91], a[116:119], v[20:23]
  v_exp_f32 v14, v14
  ds_read_b64_tr_b16 v[82:83], v7 offset:61696
  s_waitcnt lgkmcnt(6)
  v_mfma_f32_16x16x32_bf16 v[24:27], v[92:95], a[112:115], v[24:27]
  v_exp_f32 v15, v15
  ds_read_b64_tr_b16 v[84:85], v8 offset:61440
  v_mfma_f32_16x16x32_bf16 v[28:31], v[92:95], a[116:119], v[28:31]
  v_mul_f32 v60, v60, v76
  v_mul_f32 v61, v61, v77
  ds_read_b64_tr_b16 v[86:87], v8 offset:61696
  s_waitcnt lgkmcnt(6)
  v_mfma_f32_16x16x32_bf16 v[32:35], v[96:99], a[112:115], v[32:35]
  v_mul_f32 v62, v62, v78
  ds_read_b64_tr_b16 v[88:89], v7 offset:62464
  v_mfma_f32_16x16x32_bf16 v[36:39], v[96:99], a[116:119], v[36:39]
  v_mul_f32 v63, v63, v79
  ds_read_b64_tr_b16 v[90:91], v7 offset:62720
  s_waitcnt lgkmcnt(6)
  v_mfma_f32_16x16x32_bf16 v[40:43], v[100:103], a[112:115], v[40:43]
  v_add_f32 v12, 1.0, v12
  ds_read_b64_tr_b16 v[92:93], v8 offset:62464
  v_mfma_f32_16x16x32_bf16 v[44:47], v[100:103], a[116:119], v[44:47]
  v_add_f32 v13, 1.0, v13
  ds_read_b64_tr_b16 v[94:95], v8 offset:62720
  s_waitcnt lgkmcnt(6)
  v_mfma_f32_16x16x32_bf16 v[16:19], v[80:83], a[120:123], v[16:19]
  v_add_f32 v14, 1.0, v14
  ds_read_b64_tr_b16 v[96:97], v9 offset:0
  v_mfma_f32_16x16x32_bf16 v[20:23], v[80:83], a[124:127], v[20:23]
  v_add_f32 v15, 1.0, v15
  ds_read_b64_tr_b16 v[98:99], v9 offset:256
  s_waitcnt lgkmcnt(6)
  v_mfma_f32_16x16x32_bf16 v[24:27], v[84:87], a[120:123], v[24:27]
  v_rcp_f32 v12, v12
  ds_read_b64_tr_b16 v[100:101], v10 offset:0
  v_mfma_f32_16x16x32_bf16 v[28:31], v[84:87], a[124:127], v[28:31]
  v_rcp_f32 v13, v13
  v_rcp_f32 v14, v14
  ds_read_b64_tr_b16 v[102:103], v10 offset:256
  s_waitcnt lgkmcnt(6)
  v_mfma_f32_16x16x32_bf16 v[32:35], v[88:91], a[120:123], v[32:35]
  v_rcp_f32 v15, v15
  ds_read_b64_tr_b16 v[80:81], v9 offset:1024
  v_mfma_f32_16x16x32_bf16 v[36:39], v[88:91], a[124:127], v[36:39]
  v_mul_f32 v60, v60, v12
  ds_read_b64_tr_b16 v[82:83], v9 offset:1280
  s_waitcnt lgkmcnt(6)
  v_mfma_f32_16x16x32_bf16 v[40:43], v[92:95], a[120:123], v[40:43]
  v_mul_f32 v61, v61, v13
  ds_read_b64_tr_b16 v[84:85], v10 offset:1024
  v_mfma_f32_16x16x32_bf16 v[44:47], v[92:95], a[124:127], v[44:47]
  v_mul_f32 v62, v62, v14
  ds_read_b64_tr_b16 v[86:87], v10 offset:1280
  s_waitcnt lgkmcnt(6)
  v_mfma_f32_16x16x32_bf16 v[16:19], v[96:99], a[128:131], v[16:19]
  v_mul_f32 v63, v63, v15
  ds_read_b64_tr_b16 v[88:89], v9 offset:4096
  v_mfma_f32_16x16x32_bf16 v[20:23], v[96:99], a[132:135], v[20:23]
  v_cvt_pk_bf16_f32 v70, v60, v61
  ds_read_b64_tr_b16 v[90:91], v9 offset:4352
  s_waitcnt lgkmcnt(6)
  v_mfma_f32_16x16x32_bf16 v[24:27], v[100:103], a[128:131], v[24:27]
  v_cvt_pk_bf16_f32 v71, v62, v63
  ds_read_b64_tr_b16 v[92:93], v10 offset:4096
  v_mfma_f32_16x16x32_bf16 v[28:31], v[100:103], a[132:135], v[28:31]
  buffer_store_dwordx2 v[70:71], v1, s[20:23], s38 offen offset:1280 sc1
  s_add_u32 s38, s38, s55
  ds_read_b64_tr_b16 v[94:95], v10 offset:4352
  s_waitcnt lgkmcnt(6)
  v_mfma_f32_16x16x32_bf16 v[32:35], v[80:83], a[128:131], v[32:35]
  ds_read_b64_tr_b16 v[96:97], v9 offset:5120
  v_mfma_f32_16x16x32_bf16 v[36:39], v[80:83], a[132:135], v[36:39]
  ds_read_b64_tr_b16 v[98:99], v9 offset:5376
  s_waitcnt lgkmcnt(6)
  v_mfma_f32_16x16x32_bf16 v[40:43], v[84:87], a[128:131], v[40:43]
  ds_read_b64_tr_b16 v[100:101], v10 offset:5120
  v_mfma_f32_16x16x32_bf16 v[44:47], v[84:87], a[132:135], v[44:47]
  ds_read_b64_tr_b16 v[102:103], v10 offset:5376
  s_waitcnt lgkmcnt(6)
  v_mfma_f32_16x16x32_bf16 v[16:19], v[88:91], a[136:139], v[16:19]
  v_mfma_f32_16x16x32_bf16 v[20:23], v[88:91], a[140:143], v[20:23]
  s_waitcnt lgkmcnt(4)
  v_mfma_f32_16x16x32_bf16 v[24:27], v[92:95], a[136:139], v[24:27]
  v_mfma_f32_16x16x32_bf16 v[28:31], v[92:95], a[140:143], v[28:31]
  s_waitcnt vmcnt(3)
  s_waitcnt lgkmcnt(0)
  s_barrier
  v_lshrrev_b32 v7, 5, v0
  v_lshlrev_b32 v7, 11, v7
  v_add_u32 v7, v7, v11
  v_add_u32 v7, 0, v7
  v_xor_b32 v8, 32, v7
  v_add_u32 v9, 0x10000, v7
  v_add_u32 v10, 0x10000, v8
  v_mfma_f32_16x16x32_bf16 v[32:35], v[96:99], a[136:139], v[32:35]
  ds_read_b64_tr_b16 v[80:81], v7 offset:0
  ds_read_b64_tr_b16 v[82:83], v7 offset:256
  v_mfma_f32_16x16x32_bf16 v[36:39], v[96:99], a[140:143], v[36:39]
  ds_read_b64_tr_b16 v[84:85], v8 offset:0
  ds_read_b64_tr_b16 v[86:87], v8 offset:256
  v_mfma_f32_16x16x32_bf16 v[40:43], v[100:103], a[136:139], v[40:43]
  ds_read_b64_tr_b16 v[88:89], v7 offset:1024
  ds_read_b64_tr_b16 v[90:91], v7 offset:1280
  v_mfma_f32_16x16x32_bf16 v[44:47], v[100:103], a[140:143], v[44:47]
  ds_read_b64_tr_b16 v[92:93], v8 offset:1024
  ds_read_b64_tr_b16 v[94:95], v8 offset:1280
  s_cmp_eq_u32 s35, 1
  s_cbranch_scc1 L_k1_drain
  s_cmp_lt_u32 s47, 16
  s_cbranch_scc0 L_k1_B
  s_mov_b32 s12, s58
  s_mov_b32 s13, s59
  s_mov_b32 s14, 5308416
  s_mov_b32 s15, 0x20000
  s_mov_b32 s16, s28
  s_mov_b32 s17, s29
  s_mov_b32 s18, 5308416
  s_add_u32 s40, s37, s54
  s_mov_b32 s41, 589824
  v_mov_b32 v5, v4
  s_waitcnt lgkmcnt(6)
  v_mfma_f32_16x16x32_bf16 v[48:51], v[80:83], a[0:3], 0
  ds_read_b64_tr_b16 v[96:97], v7 offset:4096
  v_mfma_f32_16x16x32_bf16 v[52:55], v[80:83], a[4:7], 0
  ds_read_b64_tr_b16 v[98:99], v7 offset:4352
  s_waitcnt lgkmcnt(6)
  v_mfma_f32_16x16x32_bf16 v[56:59], v[84:87], a[0:3], 0
  s_add_u32 m0, s39, 73728
  s_nop 0
  buffer_load_dwordx4 v5, s[16:19], s40 offen lds
  s_add_u32 s40, s40, s41
  ds_read_b64_tr_b16 v[100:101], v8 offset:4096
  v_mfma_f32_16x16x32_bf16 v[60:63], v[84:87], a[4:7], 0
  ds_read_b64_tr_b16 v[102:103], v8 offset:4352
  s_waitcnt lgkmcnt(6)
  v_mfma_f32_16x16x32_bf16 v[64:67], v[88:91], a[0:3], 0
  ds_read_b64_tr_b16 v[80:81], v7 offset:5120
  v_mfma_f32_16x16x32_bf16 v[68:71], v[88:91], a[4:7], 0
  ds_read_b64_tr_b16 v[82:83], v7 offset:5376
  s_waitcnt lgkmcnt(6)
  v_mfma_f32_16x16x32_bf16 v[72:75], v[92:95], a[0:3], 0
  v_mul_f32 v12, v16, v16
  ds_read_b64_tr_b16 v[84:85], v8 offset:5120
  v_mfma_f32_16x16x32_bf16 v[76:79], v[92:95], a[4:7], 0
  v_mul_f32 v13, v17, v17
  ds_read_b64_tr_b16 v[86:87], v8 offset:5376
  s_waitcnt lgkmcnt(6)
  v_mfma_f32_16x16x32_bf16 v[48:51], v[96:99], a[8:11], v[48:51]
  v_mul_f32 v14, v18, v18
  ds_read_b64_tr_b16 v[88:89], v7 offset:8192
  v_mfma_f32_16x16x32_bf16 v[52:55], v[96:99], a[12:15], v[52:55]
  v_mul_f32 v15, v19, v19
  ds_read_b64_tr_b16 v[90:91], v7 offset:8448
  s_waitcnt lgkmcnt(6)
  v_mfma_f32_16x16x32_bf16 v[56:59], v[100:103], a[8:11], v[56:59]
  v_fmaak_f32 v12, v12, v6, 0xc0135761
  s_add_u32 m0, s39, 81920
  s_nop 0
  buffer_load_dwordx4 v5, s[16:19], s40 offen lds
  s_add_u32 s40, s40, s41
  ds_read_b64_tr_b16 v[92:93], v8 offset:8192
  v_mfma_f32_16x16x32_bf16 v[60:63], v[100:103], a[12:15], v[60:63]
  v_fmaak_f32 v13, v13, v6, 0xc0135761
  ds_read_b64_tr_b16 v[94:95], v8 offset:8448
  s_waitcnt lgkmcnt(6)
  v_mfma_f32_16x16x32_bf16 v[64:67], v[80:83], a[8:11], v[64:67]
  v_fmaak_f32 v14, v14, v6, 0xc0135761
  ds_read_b64_tr_b16 v[96:97], v7 offset:9216
  v_mfma_f32_16x16x32_bf16 v[68:71], v[80:83], a[12:15], v[68:71]
  v_fmaak_f32 v15, v15, v6, 0xc0135761
  ds_read_b64_tr_b16 v[98:99], v7 offset:9472
  s_waitcnt lgkmcnt(6)
  v_mfma_f32_16x16x32_bf16 v[72:75], v[84:87], a[8:11], v[72:75]
  v_mul_f32 v12, v12, v16
  v_mul_f32 v13, v13, v17
  ds_read_b64_tr_b16 v[100:101], v8 offset:9216
  v_mfma_f32_16x16x32_bf16 v[76:79], v[84:87], a[12:15], v[76:79]
  v_mul_f32 v14, v14, v18
  ds_read_b64_tr_b16 v[102:103], v8 offset:9472
  s_waitcnt lgkmcnt(6)
  v_mfma_f32_16x16x32_bf16 v[48:51], v[88:91], a[16:19], v[48:51]
  v_mul_f32 v15, v15, v19
  ds_read_b64_tr_b16 v[80:81], v7 offset:12288
  v_mfma_f32_16x16x32_bf16 v[52:55], v[88:91], a[20:23], v[52:55]
  v_exp_f32 v12, v12
  ds_read_b64_tr_b16 v[82:83], v7 offset:12544
  s_waitcnt lgkmcnt(6)
  v_mfma_f32_16x16x32_bf16 v[56:59], v[92:95], a[16:19], v[56:59]
  v_exp_f32 v13, v13
  s_add_u32 m0, s39, 90112
  s_nop 0
  buffer_load_dwordx4 v5, s[16:19], s40 offen lds
  s_add_u32 s40, s40, s41
  ds_read_b64_tr_b16 v[84:85], v8 offset:12288
  v_mfma_f32_16x16x32_bf16 v[60:63], v[92:95], a[20:23], v[60:63]
  v_exp_f32 v14, v14
  ds_read_b64_tr_b16 v[86:87], v8 offset:12544
  s_waitcnt lgkmcnt(6)
  v_mfma_f32_16x16x32_bf16 v[64:67], v[96:99], a[16:19], v[64:67]
  v_exp_f32 v15, v15
  ds_read_b64_tr_b16 v[88:89], v7 offset:13312
  v_mfma_f32_16x16x32_bf16 v[68:71], v[96:99], a[20:23], v[68:71]
  v_mul_f32 v16, v16, v32
  ds_read_b64_tr_b16 v[90:91], v7 offset:13568
  s_waitcnt lgkmcnt(6)
  v_mfma_f32_16x16x32_bf16 v[72:75], v[100:103], a[16:19], v[72:75]
  v_mul_f32 v17, v17, v33
  v_mul_f32 v18, v18, v34
  ds_read_b64_tr_b16 v[92:93], v8 offset:13312
  v_mfma_f32_16x16x32_bf16 v[76:79], v[100:103], a[20:23], v[76:79]
  v_mul_f32 v19, v19, v35
  ds_read_b64_tr_b16 v[94:95], v8 offset:13568
  s_waitcnt lgkmcnt(6)
  v_mfma_f32_16x16x32_bf16 v[48:51], v[80:83], a[24:27], v[48:51]
  v_add_f32 v12, 1.0, v12
  ds_read_b64_tr_b16 v[96:97], v7 offset:16384
  v_mfma_f32_16x16x32_bf16 v[52:55], v[80:83], a[28:31], v[52:55]
  v_add_f32 v13, 1.0, v13
  ds_read_b64_tr_b16 v[98:99], v7 offset:16640
  s_waitcnt lgkmcnt(6)
  v_mfma_f32_16x16x32_bf16 v[56:59], v[84:87], a[24:27], v[56:59]
  v_add_f32 v14, 1.0, v14
  s_add_u32 m0, s39, 98304
  s_nop 0
  buffer_load_dwordx4 v5, s[16:19], s40 offen lds
  s_add_u32 s40, s40, s41
  ds_read_b64_tr_b16 v[100:101], v8 offset:16384
  v_mfma_f32_16x16x32_bf16 v[60:63], v[84:87], a[28:31], v[60:63]
  v_add_f32 v15, 1.0, v15
  ds_read_b64_tr_b16 v[102:103], v8 offset:16640
  s_waitcnt lgkmcnt(6)
  v_mfma_f32_16x16x32_bf16 v[64:67], v[88:91], a[24:27], v[64:67]
  v_rcp_f32 v12, v12
  ds_read_b64_tr_b16 v[80:81], v7 offset:17408
  v_mfma_f32_16x16x32_bf16 v[68:71], v[88:91], a[28:31], v[68:71]
  v_rcp_f32 v13, v13
  ds_read_b64_tr_b16 v[82:83], v7 offset:17664
  s_waitcnt lgkmcnt(6)
  v_mfma_f32_16x16x32_bf16 v[72:75], v[92:95], a[24:27], v[72:75]
  v_rcp_f32 v14, v14
  ds_read_b64_tr_b16 v[84:85], v8 offset:17408
  v_mfma_f32_16x16x32_bf16 v[76:79], v[92:95], a[28:31], v[76:79]
  v_rcp_f32 v15, v15
  v_mul_f32 v16, v16, v12
  ds_read_b64_tr_b16 v[86:87], v8 offset:17664
  s_waitcnt lgkmcnt(6)
  v_mfma_f32_16x16x32_bf16 v[48:51], v[96:99], a[32:35], v[48:51]
  v_mul_f32 v17, v17, v13
  ds_read_b64_tr_b16 v[88:89], v7 offset:20480
  v_mfma_f32_16x16x32_bf16 v[52:55], v[96:99], a[36:39], v[52:55]
  v_mul_f32 v18, v18, v14
  ds_read_b64_tr_b16 v[90:91], v7 offset:20736
  s_waitcnt lgkmcnt(6)
  v_mfma_f32_16x16x32_bf16 v[56:59], v[100:103], a[32:35], v[56:59]
  v_mul_f32 v19, v19, v15
  s_add_u32 m0, s39, 106496
  s_nop 0
  buffer_load_dwordx4 v5, s[16:19], s40 offen lds
  s_add_u32 s40, s40, s41
  ds_read_b64_tr_b16 v[92:93], v8 offset:20480
  v_mfma_f32_16x16x32_bf16 v[60:63], v[100:103], a[36:39], v[60:63]
  v_cvt_pk_bf16_f32 v32, v16, v17
  ds_read_b64_tr_b16 v[94:95], v8 offset:20736
  s_waitcnt lgkmcnt(6)
  v_mfma_f32_16x16x32_bf16 v[64:67], v[80:83], a[32:35], v[64:67]
  v_cvt_pk_bf16_f32 v33, v18, v19
  ds_read_b64_tr_b16 v[96:97], v7 offset:21504
  v_mfma_f32_16x16x32_bf16 v[68:71], v[80:83], a[36:39], v[68:71]
  buffer_store_dwordx2 v[32:33], v1, s[20:23], s38 offen offset:0 sc1
  ds_read_b64_tr_b16 v[98:99], v7 offset:21760
  s_waitcnt lgkmcnt(6)
  v_mfma_f32_16x16x32_bf16 v[72:75], v[84:87], a[32:35], v[72:75]
  v_mul_f32 v12, v20, v20
  ds_read_b64_tr_b16 v[100:101], v8 offset:21504
  v_mfma_f32_16x16x32_bf16 v[76:79], v[84:87], a[36:39], v[76:79]
  v_mul_f32 v13, v21, v21
  v_mul_f32 v14, v22, v22
  ds_read_b64_tr_b16 v[102:103], v8 offset:21760
  s_waitcnt lgkmcnt(6)
  v_mfma_f32_16x16x32_bf16 v[48:51], v[88:91], a[40:43], v[48:51]
  v_mul_f32 v15, v23, v23
  ds_read_b64_tr_b16 v[80:81], v7 offset:24576
  v_mfma_f32_16x16x32_bf16 v[52:55], v[88:91], a[44:47], v[52:55]
  v_fmaak_f32 v12, v12, v6, 0xc0135761
  ds_read_b64_tr_b16 v[82:83], v7 offset:24832
  s_waitcnt lgkmcnt(6)
  v_mfma_f32_16x16x32_bf16 v[56:59], v[92:95], a[40:43], v[56:59]
  v_fmaak_f32 v13, v13, v6, 0xc0135761
  s_add_u32 m0, s39, 114688
  s_nop 0
  buffer_load_dwordx4 v5, s[16:19], s40 offen lds
  s_add_u32 s40, s40, s41
  ds_read_b64_tr_b16 v[84:85], v8 offset:24576
  v_mfma_f32_16x16x32_bf16 v[60:63], v[92:95], a[44:47], v[60:63]
  v_fmaak_f32 v14, v14, v6, 0xc0135761
  ds_read_b64_tr_b16 v[86:87], v8 offset:24832
  s_waitcnt lgkmcnt(6)
  v_mfma_f32_16x16x32_bf16 v[64:67], v[96:99], a[40:43], v[64:67]
  v_fmaak_f32 v15, v15, v6, 0xc0135761
  ds_read_b64_tr_b16 v[88:89], v7 offset:25600
  v_mfma_f32_16x16x32_bf16 v[68:71], v[96:99], a[44:47], v[68:71]
  v_mul_f32 v12, v12, v20
  ds_read_b64_tr_b16 v[90:91], v7 offset:25856
  s_waitcnt lgkmcnt(6)
  v_mfma_f32_16x16x32_bf16 v[72:75], v[100:103], a[40:43], v[72:75]
  v_mul_f32 v13, v13, v21
  ds_read_b64_tr_b16 v[92:93], v8 offset:25600
  v_mfma_f32_16x16x32_bf16 v[76:79], v[100:103], a[44:47], v[76:79]
  v_mul_f32 v14, v14, v22
  v_mul_f32 v15, v15, v23
  ds_read_b64_tr_b16 v[94:95], v8 offset:25856
  s_waitcnt lgkmcnt(6)
  v_mfma_f32_16x16x32_bf16 v[48:51], v[80:83], a[48:51], v[48:51]
  v_exp_f32 v12, v12
  ds_read_b64_tr_b16 v[96:97], v7 offset:28672
  v_mfma_f32_16x16x32_bf16 v[52:55], v[80:83], a[52:55], v[52:55]
  v_exp_f32 v13, v13
  ds_read_b64_tr_b16 v[98:99], v7 offset:28928
  s_waitcnt lgkmcnt(6)
  v_mfma_f32_16x16x32_bf16 v[56:59], v[84:87], a[48:51], v[56:59]
  v_exp_f32 v14, v14
  s_add_u32 m0, s39, 122880
  s_nop 0
  buffer_load_dwordx4 v5, s[16:19], s40 offen lds
  s_add_u32 s40, s40, s41
  ds_read_b64_tr_b16 v[100:101], v8 offset:28672
  v_mfma_f32_16x16x32_bf16 v[60:63], v[84:87], a[52:55], v[60:63]
  v_exp_f32 v15, v15
  ds_read_b64_tr_b16 v[102:103], v8 offset:28928
  s_waitcnt lgkmcnt(6)
  v_mfma_f32_16x16x32_bf16 v[64:67], v[88:91], a[48:51], v[64:67]
  v_mul_f32 v20, v20, v36
  ds_read_b64_tr_b16 v[80:81], v7 offset:29696
  v_mfma_f32_16x16x32_bf16 v[68:71], v[88:91], a[52:55], v[68:71]
  v_mul_f32 v21, v21, v37
  ds_read_b64_tr_b16 v[82:83], v7 offset:29952
  s_waitcnt lgkmcnt(6)
  v_mfma_f32_16x16x32_bf16 v[72:75], v[92:95], a[48:51], v[72:75]
  v_mul_f32 v22, v22, v38
  ds_read_b64_tr_b16 v[84:85], v8 offset:29696
  v_mfma_f32_16x16x32_bf16 v[76:79], v[92:95], a[52:55], v[76:79]
  v_mul_f32 v23, v23, v39
  ds_read_b64_tr_b16 v[86:87], v8 offset:29952
  s_waitcnt lgkmcnt(6)
  v_mfma_f32_16x16x32_bf16 v[48:51], v[96:99], a[56:59], v[48:51]
  v_add_f32 v12, 1.0, v12
  v_add_f32 v13, 1.0, v13
  ds_read_b64_tr_b16 v[88:89], v7 offset:32768
  v_mfma_f32_16x16x32_bf16 v[52:55], v[96:99], a[60:63], v[52:55]
  v_add_f32 v14, 1.0, v14
  ds_read_b64_tr_b16 v[90:91], v7 offset:33024
  s_waitcnt lgkmcnt(6)
  v_mfma_f32_16x16x32_bf16 v[56:59], v[100:103], a[56:59], v[56:59]
  v_add_f32 v15, 1.0, v15
  s_add_u32 m0, s39, 131072
  s_nop 0
  buffer_load_dwordx4 v5, s[16:19], s40 offen lds
  s_add_u32 s40, s40, s41
  ds_read_b64_tr_b16 v[92:93], v8 offset:32768
  v_mfma_f32_16x16x32_bf16 v[60:63], v[100:103], a[60:63], v[60:63]
  v_rcp_f32 v12, v12
  ds_read_b64_tr_b16 v[94:95], v8 offset:33024
  s_waitcnt lgkmcnt(6)
  v_mfma_f32_16x16x32_bf16 v[64:67], v[80:83], a[56:59], v[64:67]
  v_rcp_f32 v13, v13
  ds_read_b64_tr_b16 v[96:97], v7 offset:33792
  v_mfma_f32_16x16x32_bf16 v[68:71], v[80:83], a[60:63], v[68:71]
  v_rcp_f32 v14, v14
  ds_read_b64_tr_b16 v[98:99], v7 offset:34048
  s_waitcnt lgkmcnt(6)
  v_mfma_f32_16x16x32_bf16 v[72:75], v[84:87], a[56:59], v[72:75]
  v_rcp_f32 v15, v15
  ds_read_b64_tr_b16 v[100:101], v8 offset:33792
  v_mfma_f32_16x16x32_bf16 v[76:79], v[84:87], a[60:63], v[76:79]
  v_mul_f32 v20, v20, v12
  ds_read_b64_tr_b16 v[102:103], v8 offset:34048
  s_waitcnt lgkmcnt(6)
  v_mfma_f32_16x16x32_bf16 v[48:51], v[88:91], a[64:67], v[48:51]
  v_mul_f32 v21, v21, v13
  v_mul_f32 v22, v22, v14
  ds_read_b64_tr_b16 v[80:81], v7 offset:36864
  v_mfma_f32_16x16x32_bf16 v[52:55], v[88:91], a[68:71], v[52:55]
  v_mul_f32 v23, v23, v15
  ds_read_b64_tr_b16 v[82:83], v7 offset:37120
  s_waitcnt lgkmcnt(6)
  v_mfma_f32_16x16x32_bf16 v[56:59], v[92:95], a[64:67], v[56:59]
  v_cvt_pk_bf16_f32 v34, v20, v21
  s_add_u32 m0, s39, 139264
  s_nop 0
  buffer_load_dwordx4 v5, s[16:19], s40 offen lds
  s_add_u32 s40, s40, s41
  ds_read_b64_tr_b16 v[84:85], v8 offset:36864
  v_mfma_f32_16x16x32_bf16 v[60:63], v[92:95], a[68:71], v[60:63]
  v_cvt_pk_bf16_f32 v35, v22, v23
  ds_read_b64_tr_b16 v[86:87], v8 offset:37120
  s_waitcnt lgkmcnt(6)
  v_mfma_f32_16x16x32_bf16 v[64:67], v[96:99], a[64:67], v[64:67]
  buffer_store_dwordx2 v[34:35], v1, s[20:23], s38 offen offset:256 sc1
  ds_read_b64_tr_b16 v[88:89], v7 offset:37888
  v_mfma_f32_16x16x32_bf16 v[68:71], v[96:99], a[68:71], v[68:71]
  v_mul_f32 v12, v24, v24
  ds_read_b64_tr_b16 v[90:91], v7 offset:38144
  s_waitcnt lgkmcnt(6)
  v_mfma_f32_16x16x32_bf16 v[72:75], v[100:103], a[64:67], v[72:75]
  v_mul_f32 v13, v25, v25
  ds_read_b64_tr_b16 v[92:93], v8 offset:37888
  v_mfma_f32_16x16x32_bf16 v[76:79], v[100:103], a[68:71], v[76:79]
  v_mul_f32 v14, v26, v26
  ds_read_b64_tr_b16 v[94:95], v8 offset:38144
  s_waitcnt lgkmcnt(6)
  v_mfma_f32_16x16x32_bf16 v[48:51], v[80:83], a[72:75], v[48:51]
  v_mul_f32 v15, v27, v27
  ds_read_b64_tr_b16 v[96:97], v7 offset:40960
  v_mfma_f32_16x16x32_bf16 v[52:55], v[80:83], a[76:79], v[52:55]
  v_fmaak_f32 v12, v12, v6, 0xc0135761
  v_fmaak_f32 v13, v13, v6, 0xc0135761
  ds_read_b64_tr_b16 v[98:99], v7 offset:41216
  s_waitcnt lgkmcnt(6)
  v_mfma_f32_16x16x32_bf16 v[56:59], v[84:87], a[72:75], v[56:59]
  v_fmaak_f32 v14, v14, v6, 0xc0135761
  ds_read_b64_tr_b16 v[100:101], v8 offset:40960
  v_mfma_f32_16x16x32_bf16 v[60:63], v[84:87], a[76:79], v[60:63]
  v_fmaak_f32 v15, v15, v6, 0xc0135761
  ds_read_b64_tr_b16 v[102:103], v8 offset:41216
  s_waitcnt lgkmcnt(6)
  v_mfma_f32_16x16x32_bf16 v[64:67], v[88:91], a[72:75], v[64:67]
  v_mul_f32 v12, v12, v24
  ds_read_b64_tr_b16 v[80:81], v7 offset:41984
  v_mfma_f32_16x16x32_bf16 v[68:71], v[88:91], a[76:79], v[68:71]
  v_mul_f32 v13, v13, v25
  ds_read_b64_tr_b16 v[82:83], v7 offset:42240
  s_waitcnt lgkmcnt(6)
  v_mfma_f32_16x16x32_bf16 v[72:75], v[92:95], a[72:75], v[72:75]
  v_mul_f32 v14, v14, v26
  s_lshr_b32 s42, s2, 3
  s_lshl_b32 s42, s42, 3
  s_add_u32 s42, s42, s32
  s_add_u32 s42, s42, 0
  s_lshl_b32 s42, s42, 10
  s_cmp_lt_u32 s42, 663552
  s_cselect_b32 s42, s42, 0x7f000000
  s_and_b32 s43, s2, 7
  s_mul_i32 s43, s43, 663552
  s_add_u32 s42, s42, s43
  s_mov_b32 m0, 147456
  s_nop 0
  buffer_load_dwordx4 v2, s[12:15], s42 offen lds
  ds_read_b64_tr_b16 v[84:85], v8 offset:41984
  v_mfma_f32_16x16x32_bf16 v[76:79], v[92:95], a[76:79], v[76:79]
  v_mul_f32 v15, v15, v27
  ds_read_b64_tr_b16 v[86:87], v8 offset:42240
  s_waitcnt lgkmcnt(6)
  v_mfma_f32_16x16x32_bf16 v[48:51], v[96:99], a[80:83], v[48:51]
  v_exp_f32 v12, v12
  ds_read_b64_tr_b16 v[88:89], v7 offset:45056
  v_mfma_f32_16x16x32_bf16 v[52:55], v[96:99], a[84:87], v[52:55]
  v_exp_f32 v13, v13
  v_exp_f32 v14, v14
  ds_read_b64_tr_b16 v[90:91], v7 offset:45312
  s_waitcnt lgkmcnt(6)
  v_mfma_f32_16x16x32_bf16 v[56:59], v[100:103], a[80:83], v[56:59]
  v_exp_f32 v15, v15
  ds_read_b64_tr_b16 v[92:93], v8 offset:45056
  v_mfma_f32_16x16x32_bf16 v[60:63], v[100:103], a[84:87], v[60:63]
  v_mul_f32 v24, v24, v40
  ds_read_b64_tr_b16 v[94:95], v8 offset:45312
  s_waitcnt lgkmcnt(6)
  v_mfma_f32_16x16x32_bf16 v[64:67], v[80:83], a[80:83], v[64:67]
  v_mul_f32 v25, v25, v41
  ds_read_b64_tr_b16 v[96:97], v7 offset:46080
  v_mfma_f32_16x16x32_bf16 v[68:71], v[80:83], a[84:87], v[68:71]
  v_mul_f32 v26, v26, v42
  ds_read_b64_tr_b16 v[98:99], v7 offset:46336
  s_waitcnt lgkmcnt(6)
  v_mfma_f32_16x16x32_bf16 v[72:75], v[84:87], a[80:83], v[72:75]
  v_mul_f32 v27, v27, v43
  s_lshr_b32 s42, s2, 3
  s_lshl_b32 s42, s42, 3
  s_add_u32 s42, s42, s32
  s_add_u32 s42, s42, 256
  s_lshl_b32 s42, s42, 10
  s_cmp_lt_u32 s42, 663552
  s_cselect_b32 s42, s42, 0x7f000000
  s_and_b32 s43, s2, 7
  s_mul_i32 s43, s43, 663552
  s_add_u32 s42, s42, s43
  s_mov_b32 m0, 147456
  s_nop 0
  buffer_load_dwordx4 v2, s[12:15], s42 offen lds
  ds_read_b64_tr_b16 v[100:101], v8 offset:46080
  v_mfma_f32_16x16x32_bf16 v[76:79], v[84:87], a[84:87], v[76:79]
  v_add_f32 v12, 1.0, v12
  ds_read_b64_tr_b16 v[102:103], v8 offset:46336
  s_waitcnt lgkmcnt(6)
  v_mfma_f32_16x16x32_bf16 v[48:51], v[88:91], a[88:91], v[48:51]
  v_add_f32 v13, 1.0, v13
  ds_read_b64_tr_b16 v[80:81], v7 offset:49152
  v_mfma_f32_16x16x32_bf16 v[52:55], v[88:91], a[92:95], v[52:55]
  v_add_f32 v14, 1.0, v14
  v_add_f32 v15, 1.0, v15
  ds_read_b64_tr_b16 v[82:83], v7 offset:49408
  s_waitcnt lgkmcnt(6)
  v_mfma_f32_16x16x32_bf16 v[56:59], v[92:95], a[88:91], v[56:59]
  v_rcp_f32 v12, v12
  ds_read_b64_tr_b16 v[84:85], v8 offset:49152
  v_mfma_f32_16x16x32_bf16 v[60:63], v[92:95], a[92:95], v[60:63]
  v_rcp_f32 v13, v13
  ds_read_b64_tr_b16 v[86:87], v8 offset:49408
  s_waitcnt lgkmcnt(6)
  v_mfma_f32_16x16x32_bf16 v[64:67], v[96:99], a[88:91], v[64:67]
  v_rcp_f32 v14, v14
  ds_read_b64_tr_b16 v[88:89], v7 offset:50176
  v_mfma_f32_16x16x32_bf16 v[68:71], v[96:99], a[92:95], v[68:71]
  v_rcp_f32 v15, v15
  ds_read_b64_tr_b16 v[90:91], v7 offset:50432
  s_waitcnt lgkmcnt(6)
  v_mfma_f32_16x16x32_bf16 v[72:75], v[100:103], a[88:91], v[72:75]
  v_mul_f32 v24, v24, v12
  s_lshr_b32 s42, s2, 3
  s_lshl_b32 s42, s42, 3
  s_add_u32 s42, s42, s32
  s_add_u32 s42, s42, 512
  s_lshl_b32 s42, s42, 10
  s_cmp_lt_u32 s42, 663552
  s_cselect_b32 s42, s42, 0x7f000000
  s_and_b32 s43, s2, 7
  s_mul_i32 s43, s43, 663552
  s_add_u32 s42, s42, s43
  s_mov_b32 m0, 147456
  s_nop 0
  buffer_load_dwordx4 v2, s[12:15], s42 offen lds
  ds_read_b64_tr_b16 v[92:93], v8 offset:50176
  v_mfma_f32_16x16x32_bf16 v[76:79], v[100:103], a[92:95], v[76:79]
  v_mul_f32 v25, v25, v13
  ds_read_b64_tr_b16 v[94:95], v8 offset:50432
  s_waitcnt lgkmcnt(6)
  v_mfma_f32_16x16x32_bf16 v[48:51], v[80:83], a[96:99], v[48:51]
  v_mul_f32 v26, v26, v14
  ds_read_b64_tr_b16 v[96:97], v7 offset:53248
  v_mfma_f32_16x16x32_bf16 v[52:55], v[80:83], a[100:103], v[52:55]
  v_mul_f32 v27, v27, v15
  ds_read_b64_tr_b16 v[98:99], v7 offset:53504
  s_waitcnt lgkmcnt(6)
  v_mfma_f32_16x16x32_bf16 v[56:59], v[84:87], a[96:99], v[56:59]
  v_cvt_pk_bf16_f32 v36, v24, v25
  v_cvt_pk_bf16_f32 v37, v26, v27
  ds_read_b64_tr_b16 v[100:101], v8 offset:53248
  v_mfma_f32_16x16x32_bf16 v[60:63], v[84:87], a[100:103], v[60:63]
  buffer_store_dwordx2 v[36:37], v1, s[20:23], s38 offen offset:1024 sc1
  ds_read_b64_tr_b16 v[102:103], v8 offset:53504
  s_waitcnt lgkmcnt(6)
  v_mfma_f32_16x16x32_bf16 v[64:67], v[88:91], a[96:99], v[64:67]
  v_mul_f32 v12, v28, v28
  ds_read_b64_tr_b16 v[80:81], v7 offset:54272
  v_mfma_f32_16x16x32_bf16 v[68:71], v[88:91], a[100:103], v[68:71]
  v_mul_f32 v13, v29, v29
  ds_read_b64_tr_b16 v[82:83], v7 offset:54528
  s_waitcnt lgkmcnt(6)
  v_mfma_f32_16x16x32_bf16 v[72:75], v[92:95], a[96:99], v[72:75]
  v_mul_f32 v14, v30, v30
  ds_read_b64_tr_b16 v[84:85], v8 offset:54272
  v_mfma_f32_16x16x32_bf16 v[76:79], v[92:95], a[100:103], v[76:79]
  v_mul_f32 v15, v31, v31
  ds_read_b64_tr_b16 v[86:87], v8 offset:54528
  s_waitcnt lgkmcnt(6)
  v_mfma_f32_16x16x32_bf16 v[48:51], v[96:99], a[104:107], v[48:51]
  v_fmaak_f32 v12, v12, v6, 0xc0135761
  ds_read_b64_tr_b16 v[88:89], v7 offset:57344
  v_mfma_f32_16x16x32_bf16 v[52:55], v[96:99], a[108:111], v[52:55]
  v_fmaak_f32 v13, v13, v6, 0xc0135761
  ds_read_b64_tr_b16 v[90:91], v7 offset:57600
  s_waitcnt lgkmcnt(6)
  v_mfma_f32_16x16x32_bf16 v[56:59], v[100:103], a[104:107], v[56:59]
  v_fmaak_f32 v14, v14, v6, 0xc0135761
  v_fmaak_f32 v15, v15, v6, 0xc0135761
  ds_read_b64_tr_b16 v[92:93], v8 offset:57344
  v_mfma_f32_16x16x32_bf16 v[60:63], v[100:103], a[108:111], v[60:63]
  v_mul_f32 v12, v12, v28
  ds_read_b64_tr_b16 v[94:95], v8 offset:57600
  s_waitcnt lgkmcnt(6)
  v_mfma_f32_16x16x32_bf16 v[64:67], v[80:83], a[104:107], v[64:67]
  v_mul_f32 v13, v13, v29
  ds_read_b64_tr_b16 v[96:97], v7 offset:58368
  v_mfma_f32_16x16x32_bf16 v[68:71], v[80:83], a[108:111], v[68:71]
  v_mul_f32 v14, v14, v30
  ds_read_b64_tr_b16 v[98:99], v7 offset:58624
  s_waitcnt lgkmcnt(6)
  v_mfma_f32_16x16x32_bf16 v[72:75], v[84:87], a[104:107], v[72:75]
  v_mul_f32 v15, v15, v31
  ds_read_b64_tr_b16 v[100:101], v8 offset:58368
  v_mfma_f32_16x16x32_bf16 v[76:79], v[84:87], a[108:111], v[76:79]
  v_exp_f32 v12, v12
  ds_read_b64_tr_b16 v[102:103], v8 offset:58624
  s_waitcnt lgkmcnt(6)
  v_mfma_f32_16x16x32_bf16 v[48:51], v[88:91], a[112:115], v[48:51]
  v_exp_f32 v13, v13
  ds_read_b64_tr_b16 v[80:81], v7 offset:61440
  v_mfma_f32_16x16x32_bf16 v[52:55], v[88:91], a[116:119], v[52:55]
  v_exp_f32 v14, v14
  ds_read_b64_tr_b16 v[82:83], v7 offset:61696
  s_waitcnt lgkmcnt(6)
  v_mfma_f32_16x16x32_bf16 v[56:59], v[92:95], a[112:115], v[56:59]
  v_exp_f32 v15, v15
  ds_read_b64_tr_b16 v[84:85], v8 offset:61440
  v_mfma_f32_16x16x32_bf16 v[60:63], v[92:95], a[116:119], v[60:63]
  v_mul_f32 v28, v28, v44
  v_mul_f32 v29, v29, v45
  ds_read_b64_tr_b16 v[86:87], v8 offset:61696
  s_waitcnt lgkmcnt(6)
  v_mfma_f32_16x16x32_bf16 v[64:67], v[96:99], a[112:115], v[64:67]
  v_mul_f32 v30, v30, v46
  ds_read_b64_tr_b16 v[88:89], v7 offset:62464
  v_mfma_f32_16x16x32_bf16 v[68:71], v[96:99], a[116:119], v[68:71]
  v_mul_f32 v31, v31, v47
  ds_read_b64_tr_b16 v[90:91], v7 offset:62720
  s_waitcnt lgkmcnt(6)
  v_mfma_f32_16x16x32_bf16 v[72:75], v[100:103], a[112:115], v[72:75]
  v_add_f32 v12, 1.0, v12
  ds_read_b64_tr_b16 v[92:93], v8 offset:62464
  v_mfma_f32_16x16x32_bf16 v[76:79], v[100:103], a[116:119], v[76:79]
  v_add_f32 v13, 1.0, v13
  ds_read_b64_tr_b16 v[94:95], v8 offset:62720
  s_waitcnt lgkmcnt(6)
  v_mfma_f32_16x16x32_bf16 v[48:51], v[80:83], a[120:123], v[48:51]
  v_add_f32 v14, 1.0, v14
  ds_read_b64_tr_b16 v[96:97], v9 offset:0
  v_mfma_f32_16x16x32_bf16 v[52:55], v[80:83], a[124:127], v[52:55]
  v_add_f32 v15, 1.0, v15
  ds_read_b64_tr_b16 v[98:99], v9 offset:256
  s_waitcnt lgkmcnt(6)
  v_mfma_f32_16x16x32_bf16 v[56:59], v[84:87], a[120:123], v[56:59]
  v_rcp_f32 v12, v12
  ds_read_b64_tr_b16 v[100:101], v10 offset:0
  v_mfma_f32_16x16x32_bf16 v[60:63], v[84:87], a[124:127], v[60:63]
  v_rcp_f32 v13, v13
  v_rcp_f32 v14, v14
  ds_read_b64_tr_b16 v[102:103], v10 offset:256
  s_waitcnt lgkmcnt(6)
  v_mfma_f32_16x16x32_bf16 v[64:67], v[88:91], a[120:123], v[64:67]
  v_rcp_f32 v15, v15
  ds_read_b64_tr_b16 v[80:81], v9 offset:1024
  v_mfma_f32_16x16x32_bf16 v[68:71], v[88:91], a[124:127], v[68:71]
  v_mul_f32 v28, v28, v12
  ds_read_b64_tr_b16 v[82:83], v9 offset:1280
  s_waitcnt lgkmcnt(6)
  v_mfma_f32_16x16x32_bf16 v[72:75], v[92:95], a[120:123], v[72:75]
  v_mul_f32 v29, v29, v13
  ds_read_b64_tr_b16 v[84:85], v10 offset:1024
  v_mfma_f32_16x16x32_bf16 v[76:79], v[92:95], a[124:127], v[76:79]
  v_mul_f32 v30, v30, v14
  ds_read_b64_tr_b16 v[86:87], v10 offset:1280
  s_waitcnt lgkmcnt(6)
  v_mfma_f32_16x16x32_bf16 v[48:51], v[96:99], a[128:131], v[48:51]
  v_mul_f32 v31, v31, v15
  ds_read_b64_tr_b16 v[88:89], v9 offset:4096
  v_mfma_f32_16x16x32_bf16 v[52:55], v[96:99], a[132:135], v[52:55]
  v_cvt_pk_bf16_f32 v38, v28, v29
  ds_read_b64_tr_b16 v[90:91], v9 offset:4352
  s_waitcnt lgkmcnt(6)
  v_mfma_f32_16x16x32_bf16 v[56:59], v[100:103], a[128:131], v[56:59]
  v_cvt_pk_bf16_f32 v39, v30, v31
  ds_read_b64_tr_b16 v[92:93], v10 offset:4096
  v_mfma_f32_16x16x32_bf16 v[60:63], v[100:103], a[132:135], v[60:63]
  buffer_store_dwordx2 v[38:39], v1, s[20:23], s38 offen offset:1280 sc1
  s_add_u32 s38, s38, s56
  ds_read_b64_tr_b16 v[94:95], v10 offset:4352
  s_waitcnt lgkmcnt(6)
  v_mfma_f32_16x16x32_bf16 v[64:67], v[80:83], a[128:131], v[64:67]
  ds_read_b64_tr_b16 v[96:97], v9 offset:5120
  v_mfma_f32_16x16x32_bf16 v[68:71], v[80:83], a[132:135], v[68:71]
  ds_read_b64_tr_b16 v[98:99], v9 offset:5376
  s_waitcnt lgkmcnt(6)
  v_mfma_f32_16x16x32_bf16 v[72:75], v[84:87], a[128:131], v[72:75]
  ds_read_b64_tr_b16 v[100:101], v10 offset:5120
  v_mfma_f32_16x16x32_bf16 v[76:79], v[84:87], a[132:135], v[76:79]
  ds_read_b64_tr_b16 v[102:103], v10 offset:5376
  s_waitcnt lgkmcnt(6)
  v_mfma_f32_16x16x32_bf16 v[48:51], v[88:91], a[136:139], v[48:51]
  v_mfma_f32_16x16x32_bf16 v[52:55], v[88:91], a[140:143], v[52:55]
  s_waitcnt lgkmcnt(4)
  v_mfma_f32_16x16x32_bf16 v[56:59], v[92:95], a[136:139], v[56:59]
  v_mfma_f32_16x16x32_bf16 v[60:63], v[92:95], a[140:143], v[60:63]
  s_waitcnt vmcnt(6)
  s_waitcnt lgkmcnt(0)
  s_barrier
  v_lshrrev_b32 v7, 5, v0
  v_lshlrev_b32 v7, 11, v7
  v_add_u32 v7, v7, v11
  v_add_u32 v7, 73728, v7
  v_xor_b32 v8, 32, v7
  v_add_u32 v9, 0x10000, v7
  v_add_u32 v10, 0x10000, v8
  v_mfma_f32_16x16x32_bf16 v[64:67], v[96:99], a[136:139], v[64:67]
  ds_read_b64_tr_b16 v[80:81], v7 offset:0
  ds_read_b64_tr_b16 v[82:83], v7 offset:256
  v_mfma_f32_16x16x32_bf16 v[68:71], v[96:99], a[140:143], v[68:71]
  ds_read_b64_tr_b16 v[84:85], v8 offset:0
  ds_read_b64_tr_b16 v[86:87], v8 offset:256
  v_mfma_f32_16x16x32_bf16 v[72:75], v[100:103], a[136:139], v[72:75]
  ds_read_b64_tr_b16 v[88:89], v7 offset:1024
  ds_read_b64_tr_b16 v[90:91], v7 offset:1280
  v_mfma_f32_16x16x32_bf16 v[76:79], v[100:103], a[140:143], v[76:79]
  ds_read_b64_tr_b16 v[92:93], v8 offset:1024
  ds_read_b64_tr_b16 v[94:95], v8 offset:1280
  s_mov_b32 s18, 0
  s_mov_b32 s35, 1
  s_movk_i32 s55, 2048
  s_branch L_k1_p0
L_k1_B:
  s_mov_b32 s12, s58
  s_mov_b32 s13, s59
  s_mov_b32 s14, 5308416
  s_mov_b32 s15, 0x20000
  s_mov_b32 s16, s48
  s_mov_b32 s17, s49
  s_mov_b32 s18, 1990656
  s_add_u32 s40, s36, 0
  s_lshl_b32 s40, s40, 6
  s_mul_i32 s42, s32, 55296
  s_add_u32 s40, s40, s42
  s_mov_b32 s41, 442368
  v_mov_b32 v5, v3
  s_waitcnt lgkmcnt(6)
  v_mfma_f32_16x16x32_bf16 v[48:51], v[80:83], a[0:3], 0
  ds_read_b64_tr_b16 v[96:97], v7 offset:4096
  v_mfma_f32_16x16x32_bf16 v[52:55], v[80:83], a[4:7], 0
  ds_read_b64_tr_b16 v[98:99], v7 offset:4352
  s_waitcnt lgkmcnt(6)
  v_mfma_f32_16x16x32_bf16 v[56:59], v[84:87], a[0:3], 0
  s_add_u32 m0, s39, 73728
  s_nop 0
  buffer_load_dwordx4 v5, s[16:19], s40 offen lds
  s_add_u32 s40, s40, s41
  ds_read_b64_tr_b16 v[100:101], v8 offset:4096
  v_mfma_f32_16x16x32_bf16 v[60:63], v[84:87], a[4:7], 0
  ds_read_b64_tr_b16 v[102:103], v8 offset:4352
  s_waitcnt lgkmcnt(6)
  v_mfma_f32_16x16x32_bf16 v[64:67], v[88:91], a[0:3], 0
  ds_read_b64_tr_b16 v[80:81], v7 offset:5120
  v_mfma_f32_16x16x32_bf16 v[68:71], v[88:91], a[4:7], 0
  ds_read_b64_tr_b16 v[82:83], v7 offset:5376
  s_waitcnt lgkmcnt(6)
  v_mfma_f32_16x16x32_bf16 v[72:75], v[92:95], a[0:3], 0
  v_mul_f32 v12, v16, v16
  ds_read_b64_tr_b16 v[84:85], v8 offset:5120
  v_mfma_f32_16x16x32_bf16 v[76:79], v[92:95], a[4:7], 0
  v_mul_f32 v13, v17, v17
  ds_read_b64_tr_b16 v[86:87], v8 offset:5376
  s_waitcnt lgkmcnt(6)
  v_mfma_f32_16x16x32_bf16 v[48:51], v[96:99], a[8:11], v[48:51]
  v_mul_f32 v14, v18, v18
  ds_read_b64_tr_b16 v[88:89], v7 offset:8192
  v_mfma_f32_16x16x32_bf16 v[52:55], v[96:99], a[12:15], v[52:55]
  v_mul_f32 v15, v19, v19
  ds_read_b64_tr_b16 v[90:91], v7 offset:8448
  s_waitcnt lgkmcnt(6)
  v_mfma_f32_16x16x32_bf16 v[56:59], v[100:103], a[8:11], v[56:59]
  v_fmaak_f32 v12, v12, v6, 0xc0135761
  s_add_u32 m0, s39, 81920
  s_nop 0
  buffer_load_dwordx4 v5, s[16:19], s40 offen lds
  s_add_u32 s40, s40, s41
  ds_read_b64_tr_b16 v[92:93], v8 offset:8192
  v_mfma_f32_16x16x32_bf16 v[60:63], v[100:103], a[12:15], v[60:63]
  v_fmaak_f32 v13, v13, v6, 0xc0135761
  ds_read_b64_tr_b16 v[94:95], v8 offset:8448
  s_waitcnt lgkmcnt(6)
  v_mfma_f32_16x16x32_bf16 v[64:67], v[80:83], a[8:11], v[64:67]
  v_fmaak_f32 v14, v14, v6, 0xc0135761
  ds_read_b64_tr_b16 v[96:97], v7 offset:9216
  v_mfma_f32_16x16x32_bf16 v[68:71], v[80:83], a[12:15], v[68:71]
  v_fmaak_f32 v15, v15, v6, 0xc0135761
  ds_read_b64_tr_b16 v[98:99], v7 offset:9472
  s_waitcnt lgkmcnt(6)
  v_mfma_f32_16x16x32_bf16 v[72:75], v[84:87], a[8:11], v[72:75]
  v_mul_f32 v12, v12, v16
  v_mul_f32 v13, v13, v17
  ds_read_b64_tr_b16 v[100:101], v8 offset:9216
  v_mfma_f32_16x16x32_bf16 v[76:79], v[84:87], a[12:15], v[76:79]
  v_mul_f32 v14, v14, v18
  ds_read_b64_tr_b16 v[102:103], v8 offset:9472
  s_waitcnt lgkmcnt(6)
  v_mfma_f32_16x16x32_bf16 v[48:51], v[88:91], a[16:19], v[48:51]
  v_mul_f32 v15, v15, v19
  ds_read_b64_tr_b16 v[80:81], v7 offset:12288
  v_mfma_f32_16x16x32_bf16 v[52:55], v[88:91], a[20:23], v[52:55]
  v_exp_f32 v12, v12
  ds_read_b64_tr_b16 v[82:83], v7 offset:12544
  s_waitcnt lgkmcnt(6)
  v_mfma_f32_16x16x32_bf16 v[56:59], v[92:95], a[16:19], v[56:59]
  v_exp_f32 v13, v13
  s_add_u32 m0, s39, 90112
  s_nop 0
  buffer_load_dwordx4 v5, s[16:19], s40 offen lds
  s_add_u32 s40, s40, s41
  ds_read_b64_tr_b16 v[84:85], v8 offset:12288
  v_mfma_f32_16x16x32_bf16 v[60:63], v[92:95], a[20:23], v[60:63]
  v_exp_f32 v14, v14
  ds_read_b64_tr_b16 v[86:87], v8 offset:12544
  s_waitcnt lgkmcnt(6)
  v_mfma_f32_16x16x32_bf16 v[64:67], v[96:99], a[16:19], v[64:67]
  v_exp_f32 v15, v15
  ds_read_b64_tr_b16 v[88:89], v7 offset:13312
  v_mfma_f32_16x16x32_bf16 v[68:71], v[96:99], a[20:23], v[68:71]
  v_mul_f32 v16, v16, v32
  ds_read_b64_tr_b16 v[90:91], v7 offset:13568
  s_waitcnt lgkmcnt(6)
  v_mfma_f32_16x16x32_bf16 v[72:75], v[100:103], a[16:19], v[72:75]
  v_mul_f32 v17, v17, v33
  v_mul_f32 v18, v18, v34
  ds_read_b64_tr_b16 v[92:93], v8 offset:13312
  v_mfma_f32_16x16x32_bf16 v[76:79], v[100:103], a[20:23], v[76:79]
  v_mul_f32 v19, v19, v35
  ds_read_b64_tr_b16 v[94:95], v8 offset:13568
  s_waitcnt lgkmcnt(6)
  v_mfma_f32_16x16x32_bf16 v[48:51], v[80:83], a[24:27], v[48:51]
  v_add_f32 v12, 1.0, v12
  ds_read_b64_tr_b16 v[96:97], v7 offset:16384
  v_mfma_f32_16x16x32_bf16 v[52:55], v[80:83], a[28:31], v[52:55]
  v_add_f32 v13, 1.0, v13
  ds_read_b64_tr_b16 v[98:99], v7 offset:16640
  s_waitcnt lgkmcnt(6)
  v_mfma_f32_16x16x32_bf16 v[56:59], v[84:87], a[24:27], v[56:59]
  v_add_f32 v14, 1.0, v14
  s_add_u32 m0, s39, 98304
  s_nop 0
  buffer_load_dwordx4 v5, s[16:19], s40 offen lds
  s_add_u32 s40, s40, s41
  ds_read_b64_tr_b16 v[100:101], v8 offset:16384
  v_mfma_f32_16x16x32_bf16 v[60:63], v[84:87], a[28:31], v[60:63]
  v_add_f32 v15, 1.0, v15
  ds_read_b64_tr_b16 v[102:103], v8 offset:16640
  s_waitcnt lgkmcnt(6)
  v_mfma_f32_16x16x32_bf16 v[64:67], v[88:91], a[24:27], v[64:67]
  v_rcp_f32 v12, v12
  ds_read_b64_tr_b16 v[80:81], v7 offset:17408
  v_mfma_f32_16x16x32_bf16 v[68:71], v[88:91], a[28:31], v[68:71]
  v_rcp_f32 v13, v13
  ds_read_b64_tr_b16 v[82:83], v7 offset:17664
  s_waitcnt lgkmcnt(6)
  v_mfma_f32_16x16x32_bf16 v[72:75], v[92:95], a[24:27], v[72:75]
  v_rcp_f32 v14, v14
  ds_read_b64_tr_b16 v[84:85], v8 offset:17408
  v_mfma_f32_16x16x32_bf16 v[76:79], v[92:95], a[28:31], v[76:79]
  v_rcp_f32 v15, v15
  v_mul_f32 v16, v16, v12
  ds_read_b64_tr_b16 v[86:87], v8 offset:17664
  s_waitcnt lgkmcnt(6)
  v_mfma_f32_16x16x32_bf16 v[48:51], v[96:99], a[32:35], v[48:51]
  v_mul_f32 v17, v17, v13
  ds_read_b64_tr_b16 v[88:89], v7 offset:20480
  v_mfma_f32_16x16x32_bf16 v[52:55], v[96:99], a[36:39], v[52:55]
  v_mul_f32 v18, v18, v14
  ds_read_b64_tr_b16 v[90:91], v7 offset:20736
  s_waitcnt lgkmcnt(6)
  v_mfma_f32_16x16x32_bf16 v[56:59], v[100:103], a[32:35], v[56:59]
  v_mul_f32 v19, v19, v15
  s_add_u32 m0, s39, 106496
  s_nop 0
  buffer_load_dwordx4 v5, s[16:19], s40 offen lds
  s_add_u32 s40, s40, s41
  ds_read_b64_tr_b16 v[92:93], v8 offset:20480
  v_mfma_f32_16x16x32_bf16 v[60:63], v[100:103], a[36:39], v[60:63]
  v_cvt_pk_bf16_f32 v32, v16, v17
  ds_read_b64_tr_b16 v[94:95], v8 offset:20736
  s_waitcnt lgkmcnt(6)
  v_mfma_f32_16x16x32_bf16 v[64:67], v[80:83], a[32:35], v[64:67]
  v_cvt_pk_bf16_f32 v33, v18, v19
  ds_read_b64_tr_b16 v[96:97], v7 offset:21504
  v_mfma_f32_16x16x32_bf16 v[68:71], v[80:83], a[36:39], v[68:71]
  buffer_store_dwordx2 v[32:33], v1, s[20:23], s38 offen offset:0 sc1
  ds_read_b64_tr_b16 v[98:99], v7 offset:21760
  s_waitcnt lgkmcnt(6)
  v_mfma_f32_16x16x32_bf16 v[72:75], v[84:87], a[32:35], v[72:75]
  v_mul_f32 v12, v20, v20
  ds_read_b64_tr_b16 v[100:101], v8 offset:21504
  v_mfma_f32_16x16x32_bf16 v[76:79], v[84:87], a[36:39], v[76:79]
  v_mul_f32 v13, v21, v21
  v_mul_f32 v14, v22, v22
  ds_read_b64_tr_b16 v[102:103], v8 offset:21760
  s_waitcnt lgkmcnt(6)
  v_mfma_f32_16x16x32_bf16 v[48:51], v[88:91], a[40:43], v[48:51]
  v_mul_f32 v15, v23, v23
  ds_read_b64_tr_b16 v[80:81], v7 offset:24576
  v_mfma_f32_16x16x32_bf16 v[52:55], v[88:91], a[44:47], v[52:55]
  v_fmaak_f32 v12, v12, v6, 0xc0135761
  ds_read_b64_tr_b16 v[82:83], v7 offset:24832
  s_waitcnt lgkmcnt(6)
  v_mfma_f32_16x16x32_bf16 v[56:59], v[92:95], a[40:43], v[56:59]
  v_fmaak_f32 v13, v13, v6, 0xc0135761
  s_add_u32 m0, s39, 114688
  s_nop 0
  buffer_load_dwordx4 v5, s[16:19], s40 offen lds
  s_add_u32 s40, s40, s41
  ds_read_b64_tr_b16 v[84:85], v8 offset:24576
  v_mfma_f32_16x16x32_bf16 v[60:63], v[92:95], a[44:47], v[60:63]
  v_fmaak_f32 v14, v14, v6, 0xc0135761
  ds_read_b64_tr_b16 v[86:87], v8 offset:24832
  s_waitcnt lgkmcnt(6)
  v_mfma_f32_16x16x32_bf16 v[64:67], v[96:99], a[40:43], v[64:67]
  v_fmaak_f32 v15, v15, v6, 0xc0135761
  ds_read_b64_tr_b16 v[88:89], v7 offset:25600
  v_mfma_f32_16x16x32_bf16 v[68:71], v[96:99], a[44:47], v[68:71]
  v_mul_f32 v12, v12, v20
  ds_read_b64_tr_b16 v[90:91], v7 offset:25856
  s_waitcnt lgkmcnt(6)
  v_mfma_f32_16x16x32_bf16 v[72:75], v[100:103], a[40:43], v[72:75]
  v_mul_f32 v13, v13, v21
  ds_read_b64_tr_b16 v[92:93], v8 offset:25600
  v_mfma_f32_16x16x32_bf16 v[76:79], v[100:103], a[44:47], v[76:79]
  v_mul_f32 v14, v14, v22
  v_mul_f32 v15, v15, v23
  ds_read_b64_tr_b16 v[94:95], v8 offset:25856
  s_waitcnt lgkmcnt(6)
  v_mfma_f32_16x16x32_bf16 v[48:51], v[80:83], a[48:51], v[48:51]
  v_exp_f32 v12, v12
  ds_read_b64_tr_b16 v[96:97], v7 offset:28672
  v_mfma_f32_16x16x32_bf16 v[52:55], v[80:83], a[52:55], v[52:55]
  v_exp_f32 v13, v13
  ds_read_b64_tr_b16 v[98:99], v7 offset:28928
  s_waitcnt lgkmcnt(6)
  v_mfma_f32_16x16x32_bf16 v[56:59], v[84:87], a[48:51], v[56:59]
  v_exp_f32 v14, v14
  s_add_u32 m0, s39, 122880
  s_nop 0
  buffer_load_dwordx4 v5, s[16:19], s40 offen lds
  s_add_u32 s40, s40, s41
  ds_read_b64_tr_b16 v[100:101], v8 offset:28672
  v_mfma_f32_16x16x32_bf16 v[60:63], v[84:87], a[52:55], v[60:63]
  v_exp_f32 v15, v15
  ds_read_b64_tr_b16 v[102:103], v8 offset:28928
  s_waitcnt lgkmcnt(6)
  v_mfma_f32_16x16x32_bf16 v[64:67], v[88:91], a[48:51], v[64:67]
  v_mul_f32 v20, v20, v36
  ds_read_b64_tr_b16 v[80:81], v7 offset:29696
  v_mfma_f32_16x16x32_bf16 v[68:71], v[88:91], a[52:55], v[68:71]
  v_mul_f32 v21, v21, v37
  ds_read_b64_tr_b16 v[82:83], v7 offset:29952
  s_waitcnt lgkmcnt(6)
  v_mfma_f32_16x16x32_bf16 v[72:75], v[92:95], a[48:51], v[72:75]
  v_mul_f32 v22, v22, v38
  ds_read_b64_tr_b16 v[84:85], v8 offset:29696
  v_mfma_f32_16x16x32_bf16 v[76:79], v[92:95], a[52:55], v[76:79]
  v_mul_f32 v23, v23, v39
  ds_read_b64_tr_b16 v[86:87], v8 offset:29952
  s_waitcnt lgkmcnt(6)
  v_mfma_f32_16x16x32_bf16 v[48:51], v[96:99], a[56:59], v[48:51]
  v_add_f32 v12, 1.0, v12
  v_add_f32 v13, 1.0, v13
  ds_read_b64_tr_b16 v[88:89], v7 offset:32768
  v_mfma_f32_16x16x32_bf16 v[52:55], v[96:99], a[60:63], v[52:55]
  v_add_f32 v14, 1.0, v14
  ds_read_b64_tr_b16 v[90:91], v7 offset:33024
  s_waitcnt lgkmcnt(6)
  v_mfma_f32_16x16x32_bf16 v[56:59], v[100:103], a[56:59], v[56:59]
  v_add_f32 v15, 1.0, v15
  s_add_u32 m0, s39, 131072
  s_nop 0
  buffer_load_dwordx4 v5, s[16:19], s40 offen lds
  s_add_u32 s40, s40, s41
  ds_read_b64_tr_b16 v[92:93], v8 offset:32768
  v_mfma_f32_16x16x32_bf16 v[60:63], v[100:103], a[60:63], v[60:63]
  v_rcp_f32 v12, v12
  ds_read_b64_tr_b16 v[94:95], v8 offset:33024
  s_waitcnt lgkmcnt(6)
  v_mfma_f32_16x16x32_bf16 v[64:67], v[80:83], a[56:59], v[64:67]
  v_rcp_f32 v13, v13
  ds_read_b64_tr_b16 v[96:97], v7 offset:33792
  v_mfma_f32_16x16x32_bf16 v[68:71], v[80:83], a[60:63], v[68:71]
  v_rcp_f32 v14, v14
  ds_read_b64_tr_b16 v[98:99], v7 offset:34048
  s_waitcnt lgkmcnt(6)
  v_mfma_f32_16x16x32_bf16 v[72:75], v[84:87], a[56:59], v[72:75]
  v_rcp_f32 v15, v15
  ds_read_b64_tr_b16 v[100:101], v8 offset:33792
  v_mfma_f32_16x16x32_bf16 v[76:79], v[84:87], a[60:63], v[76:79]
  v_mul_f32 v20, v20, v12
  ds_read_b64_tr_b16 v[102:103], v8 offset:34048
  s_waitcnt lgkmcnt(6)
  v_mfma_f32_16x16x32_bf16 v[48:51], v[88:91], a[64:67], v[48:51]
  v_mul_f32 v21, v21, v13
  v_mul_f32 v22, v22, v14
  ds_read_b64_tr_b16 v[80:81], v7 offset:36864
  v_mfma_f32_16x16x32_bf16 v[52:55], v[88:91], a[68:71], v[52:55]
  v_mul_f32 v23, v23, v15
  ds_read_b64_tr_b16 v[82:83], v7 offset:37120
  s_waitcnt lgkmcnt(6)
  v_mfma_f32_16x16x32_bf16 v[56:59], v[92:95], a[64:67], v[56:59]
  v_cvt_pk_bf16_f32 v34, v20, v21
  s_add_u32 m0, s39, 139264
  s_nop 0
  buffer_load_dwordx4 v5, s[16:19], s40 offen lds
  s_add_u32 s40, s40, s41
  ds_read_b64_tr_b16 v[84:85], v8 offset:36864
  v_mfma_f32_16x16x32_bf16 v[60:63], v[92:95], a[68:71], v[60:63]
  v_cvt_pk_bf16_f32 v35, v22, v23
  ds_read_b64_tr_b16 v[86:87], v8 offset:37120
  s_waitcnt lgkmcnt(6)
  v_mfma_f32_16x16x32_bf16 v[64:67], v[96:99], a[64:67], v[64:67]
  buffer_store_dwordx2 v[34:35], v1, s[20:23], s38 offen offset:256 sc1
  ds_read_b64_tr_b16 v[88:89], v7 offset:37888
  v_mfma_f32_16x16x32_bf16 v[68:71], v[96:99], a[68:71], v[68:71]
  v_mul_f32 v12, v24, v24
  ds_read_b64_tr_b16 v[90:91], v7 offset:38144
  s_waitcnt lgkmcnt(6)
  v_mfma_f32_16x16x32_bf16 v[72:75], v[100:103], a[64:67], v[72:75]
  v_mul_f32 v13, v25, v25
  ds_read_b64_tr_b16 v[92:93], v8 offset:37888
  v_mfma_f32_16x16x32_bf16 v[76:79], v[100:103], a[68:71], v[76:79]
  v_mul_f32 v14, v26, v26
  ds_read_b64_tr_b16 v[94:95], v8 offset:38144
  s_waitcnt lgkmcnt(6)
  v_mfma_f32_16x16x32_bf16 v[48:51], v[80:83], a[72:75], v[48:51]
  v_mul_f32 v15, v27, v27
  ds_read_b64_tr_b16 v[96:97], v7 offset:40960
  v_mfma_f32_16x16x32_bf16 v[52:55], v[80:83], a[76:79], v[52:55]
  v_fmaak_f32 v12, v12, v6, 0xc0135761
  v_fmaak_f32 v13, v13, v6, 0xc0135761
  ds_read_b64_tr_b16 v[98:99], v7 offset:41216
  s_waitcnt lgkmcnt(6)
  v_mfma_f32_16x16x32_bf16 v[56:59], v[84:87], a[72:75], v[56:59]
  v_fmaak_f32 v14, v14, v6, 0xc0135761
  ds_read_b64_tr_b16 v[100:101], v8 offset:40960
  v_mfma_f32_16x16x32_bf16 v[60:63], v[84:87], a[76:79], v[60:63]
  v_fmaak_f32 v15, v15, v6, 0xc0135761
  ds_read_b64_tr_b16 v[102:103], v8 offset:41216
  s_waitcnt lgkmcnt(6)
  v_mfma_f32_16x16x32_bf16 v[64:67], v[88:91], a[72:75], v[64:67]
  v_mul_f32 v12, v12, v24
  ds_read_b64_tr_b16 v[80:81], v7 offset:41984
  v_mfma_f32_16x16x32_bf16 v[68:71], v[88:91], a[76:79], v[68:71]
  v_mul_f32 v13, v13, v25
  ds_read_b64_tr_b16 v[82:83], v7 offset:42240
  s_waitcnt lgkmcnt(6)
  v_mfma_f32_16x16x32_bf16 v[72:75], v[92:95], a[72:75], v[72:75]
  v_mul_f32 v14, v14, v26
  s_lshr_b32 s42, s2, 3
  s_lshl_b32 s42, s42, 3
  s_add_u32 s42, s42, s32
  s_add_u32 s42, s42, 0
  s_lshl_b32 s42, s42, 10
  s_cmp_lt_u32 s42, 663552
  s_cselect_b32 s42, s42, 0x7f000000
  s_and_b32 s43, s2, 7
  s_mul_i32 s43, s43, 663552
  s_add_u32 s42, s42, s43
  s_mov_b32 m0, 147456
  s_nop 0
  buffer_load_dwordx4 v2, s[12:15], s42 offen lds
  ds_read_b64_tr_b16 v[84:85], v8 offset:41984
  v_mfma_f32_16x16x32_bf16 v[76:79], v[92:95], a[76:79], v[76:79]
  v_mul_f32 v15, v15, v27
  ds_read_b64_tr_b16 v[86:87], v8 offset:42240
  s_waitcnt lgkmcnt(6)
  v_mfma_f32_16x16x32_bf16 v[48:51], v[96:99], a[80:83], v[48:51]
  v_exp_f32 v12, v12
  ds_read_b64_tr_b16 v[88:89], v7 offset:45056
  v_mfma_f32_16x16x32_bf16 v[52:55], v[96:99], a[84:87], v[52:55]
  v_exp_f32 v13, v13
  v_exp_f32 v14, v14
  ds_read_b64_tr_b16 v[90:91], v7 offset:45312
  s_waitcnt lgkmcnt(6)
  v_mfma_f32_16x16x32_bf16 v[56:59], v[100:103], a[80:83], v[56:59]
  v_exp_f32 v15, v15
  ds_read_b64_tr_b16 v[92:93], v8 offset:45056
  v_mfma_f32_16x16x32_bf16 v[60:63], v[100:103], a[84:87], v[60:63]
  v_mul_f32 v24, v24, v40
  ds_read_b64_tr_b16 v[94:95], v8 offset:45312
  s_waitcnt lgkmcnt(6)
  v_mfma_f32_16x16x32_bf16 v[64:67], v[80:83], a[80:83], v[64:67]
  v_mul_f32 v25, v25, v41
  ds_read_b64_tr_b16 v[96:97], v7 offset:46080
  v_mfma_f32_16x16x32_bf16 v[68:71], v[80:83], a[84:87], v[68:71]
  v_mul_f32 v26, v26, v42
  ds_read_b64_tr_b16 v[98:99], v7 offset:46336
  s_waitcnt lgkmcnt(6)
  v_mfma_f32_16x16x32_bf16 v[72:75], v[84:87], a[80:83], v[72:75]
  v_mul_f32 v27, v27, v43
  s_lshr_b32 s42, s2, 3
  s_lshl_b32 s42, s42, 3
  s_add_u32 s42, s42, s32
  s_add_u32 s42, s42, 256
  s_lshl_b32 s42, s42, 10
  s_cmp_lt_u32 s42, 663552
  s_cselect_b32 s42, s42, 0x7f000000
  s_and_b32 s43, s2, 7
  s_mul_i32 s43, s43, 663552
  s_add_u32 s42, s42, s43
  s_mov_b32 m0, 147456
  s_nop 0
  buffer_load_dwordx4 v2, s[12:15], s42 offen lds
  ds_read_b64_tr_b16 v[100:101], v8 offset:46080
  v_mfma_f32_16x16x32_bf16 v[76:79], v[84:87], a[84:87], v[76:79]
  v_add_f32 v12, 1.0, v12
  ds_read_b64_tr_b16 v[102:103], v8 offset:46336
  s_waitcnt lgkmcnt(6)
  v_mfma_f32_16x16x32_bf16 v[48:51], v[88:91], a[88:91], v[48:51]
  v_add_f32 v13, 1.0, v13
  ds_read_b64_tr_b16 v[80:81], v7 offset:49152
  v_mfma_f32_16x16x32_bf16 v[52:55], v[88:91], a[92:95], v[52:55]
  v_add_f32 v14, 1.0, v14
  v_add_f32 v15, 1.0, v15
  ds_read_b64_tr_b16 v[82:83], v7 offset:49408
  s_waitcnt lgkmcnt(6)
  v_mfma_f32_16x16x32_bf16 v[56:59], v[92:95], a[88:91], v[56:59]
  v_rcp_f32 v12, v12
  ds_read_b64_tr_b16 v[84:85], v8 offset:49152
  v_mfma_f32_16x16x32_bf16 v[60:63], v[92:95], a[92:95], v[60:63]
  v_rcp_f32 v13, v13
  ds_read_b64_tr_b16 v[86:87], v8 offset:49408
  s_waitcnt lgkmcnt(6)
  v_mfma_f32_16x16x32_bf16 v[64:67], v[96:99], a[88:91], v[64:67]
  v_rcp_f32 v14, v14
  ds_read_b64_tr_b16 v[88:89], v7 offset:50176
  v_mfma_f32_16x16x32_bf16 v[68:71], v[96:99], a[92:95], v[68:71]
  v_rcp_f32 v15, v15
  ds_read_b64_tr_b16 v[90:91], v7 offset:50432
  s_waitcnt lgkmcnt(6)
  v_mfma_f32_16x16x32_bf16 v[72:75], v[100:103], a[88:91], v[72:75]
  v_mul_f32 v24, v24, v12
  s_lshr_b32 s42, s2, 3
  s_lshl_b32 s42, s42, 3
  s_add_u32 s42, s42, s32
  s_add_u32 s42, s42, 512
  s_lshl_b32 s42, s42, 10
  s_cmp_lt_u32 s42, 663552
  s_cselect_b32 s42, s42, 0x7f000000
  s_and_b32 s43, s2, 7
  s_mul_i32 s43, s43, 663552
  s_add_u32 s42, s42, s43
  s_mov_b32 m0, 147456
  s_nop 0
  buffer_load_dwordx4 v2, s[12:15], s42 offen lds
  ds_read_b64_tr_b16 v[92:93], v8 offset:50176
  v_mfma_f32_16x16x32_bf16 v[76:79], v[100:103], a[92:95], v[76:79]
  v_mul_f32 v25, v25, v13
  ds_read_b64_tr_b16 v[94:95], v8 offset:50432
  s_waitcnt lgkmcnt(6)
  v_mfma_f32_16x16x32_bf16 v[48:51], v[80:83], a[96:99], v[48:51]
  v_mul_f32 v26, v26, v14
  ds_read_b64_tr_b16 v[96:97], v7 offset:53248
  v_mfma_f32_16x16x32_bf16 v[52:55], v[80:83], a[100:103], v[52:55]
  v_mul_f32 v27, v27, v15
  ds_read_b64_tr_b16 v[98:99], v7 offset:53504
  s_waitcnt lgkmcnt(6)
  v_mfma_f32_16x16x32_bf16 v[56:59], v[84:87], a[96:99], v[56:59]
  v_cvt_pk_bf16_f32 v36, v24, v25
  v_cvt_pk_bf16_f32 v37, v26, v27
  ds_read_b64_tr_b16 v[100:101], v8 offset:53248
  v_mfma_f32_16x16x32_bf16 v[60:63], v[84:87], a[100:103], v[60:63]
  buffer_store_dwordx2 v[36:37], v1, s[20:23], s38 offen offset:1024 sc1
  ds_read_b64_tr_b16 v[102:103], v8 offset:53504
  s_waitcnt lgkmcnt(6)
  v_mfma_f32_16x16x32_bf16 v[64:67], v[88:91], a[96:99], v[64:67]
  v_mul_f32 v12, v28, v28
  ds_read_b64_tr_b16 v[80:81], v7 offset:54272
  v_mfma_f32_16x16x32_bf16 v[68:71], v[88:91], a[100:103], v[68:71]
  v_mul_f32 v13, v29, v29
  ds_read_b64_tr_b16 v[82:83], v7 offset:54528
  s_waitcnt lgkmcnt(6)
  v_mfma_f32_16x16x32_bf16 v[72:75], v[92:95], a[96:99], v[72:75]
  v_mul_f32 v14, v30, v30
  ds_read_b64_tr_b16 v[84:85], v8 offset:54272
  v_mfma_f32_16x16x32_bf16 v[76:79], v[92:95], a[100:103], v[76:79]
  v_mul_f32 v15, v31, v31
  ds_read_b64_tr_b16 v[86:87], v8 offset:54528
  s_waitcnt lgkmcnt(6)
  v_mfma_f32_16x16x32_bf16 v[48:51], v[96:99], a[104:107], v[48:51]
  v_fmaak_f32 v12, v12, v6, 0xc0135761
  ds_read_b64_tr_b16 v[88:89], v7 offset:57344
  v_mfma_f32_16x16x32_bf16 v[52:55], v[96:99], a[108:111], v[52:55]
  v_fmaak_f32 v13, v13, v6, 0xc0135761
  ds_read_b64_tr_b16 v[90:91], v7 offset:57600
  s_waitcnt lgkmcnt(6)
  v_mfma_f32_16x16x32_bf16 v[56:59], v[100:103], a[104:107], v[56:59]
  v_fmaak_f32 v14, v14, v6, 0xc0135761
  v_fmaak_f32 v15, v15, v6, 0xc0135761
  ds_read_b64_tr_b16 v[92:93], v8 offset:57344
  v_mfma_f32_16x16x32_bf16 v[60:63], v[100:103], a[108:111], v[60:63]
  v_mul_f32 v12, v12, v28
  ds_read_b64_tr_b16 v[94:95], v8 offset:57600
  s_waitcnt lgkmcnt(6)
  v_mfma_f32_16x16x32_bf16 v[64:67], v[80:83], a[104:107], v[64:67]
  v_mul_f32 v13, v13, v29
  ds_read_b64_tr_b16 v[96:97], v7 offset:58368
  v_mfma_f32_16x16x32_bf16 v[68:71], v[80:83], a[108:111], v[68:71]
  v_mul_f32 v14, v14, v30
  ds_read_b64_tr_b16 v[98:99], v7 offset:58624
  s_waitcnt lgkmcnt(6)
  v_mfma_f32_16x16x32_bf16 v[72:75], v[84:87], a[104:107], v[72:75]
  v_mul_f32 v15, v15, v31
  ds_read_b64_tr_b16 v[100:101], v8 offset:58368
  v_mfma_f32_16x16x32_bf16 v[76:79], v[84:87], a[108:111], v[76:79]
  v_exp_f32 v12, v12
  ds_read_b64_tr_b16 v[102:103], v8 offset:58624
  s_waitcnt lgkmcnt(6)
  v_mfma_f32_16x16x32_bf16 v[48:51], v[88:91], a[112:115], v[48:51]
  v_exp_f32 v13, v13
  ds_read_b64_tr_b16 v[80:81], v7 offset:61440
  v_mfma_f32_16x16x32_bf16 v[52:55], v[88:91], a[116:119], v[52:55]
  v_exp_f32 v14, v14
  ds_read_b64_tr_b16 v[82:83], v7 offset:61696
  s_waitcnt lgkmcnt(6)
  v_mfma_f32_16x16x32_bf16 v[56:59], v[92:95], a[112:115], v[56:59]
  v_exp_f32 v15, v15
  ds_read_b64_tr_b16 v[84:85], v8 offset:61440
  v_mfma_f32_16x16x32_bf16 v[60:63], v[92:95], a[116:119], v[60:63]
  v_mul_f32 v28, v28, v44
  v_mul_f32 v29, v29, v45
  ds_read_b64_tr_b16 v[86:87], v8 offset:61696
  s_waitcnt lgkmcnt(6)
  v_mfma_f32_16x16x32_bf16 v[64:67], v[96:99], a[112:115], v[64:67]
  v_mul_f32 v30, v30, v46
  ds_read_b64_tr_b16 v[88:89], v7 offset:62464
  v_mfma_f32_16x16x32_bf16 v[68:71], v[96:99], a[116:119], v[68:71]
  v_mul_f32 v31, v31, v47
  ds_read_b64_tr_b16 v[90:91], v7 offset:62720
  s_waitcnt lgkmcnt(6)
  v_mfma_f32_16x16x32_bf16 v[72:75], v[100:103], a[112:115], v[72:75]
  v_add_f32 v12, 1.0, v12
  ds_read_b64_tr_b16 v[92:93], v8 offset:62464
  v_mfma_f32_16x16x32_bf16 v[76:79], v[100:103], a[116:119], v[76:79]
  v_add_f32 v13, 1.0, v13
  ds_read_b64_tr_b16 v[94:95], v8 offset:62720
  s_waitcnt lgkmcnt(6)
  v_mfma_f32_16x16x32_bf16 v[48:51], v[80:83], a[120:123], v[48:51]
  v_add_f32 v14, 1.0, v14
  ds_read_b64_tr_b16 v[96:97], v9 offset:0
  v_mfma_f32_16x16x32_bf16 v[52:55], v[80:83], a[124:127], v[52:55]
  v_add_f32 v15, 1.0, v15
  ds_read_b64_tr_b16 v[98:99], v9 offset:256
  s_waitcnt lgkmcnt(6)
  v_mfma_f32_16x16x32_bf16 v[56:59], v[84:87], a[120:123], v[56:59]
  v_rcp_f32 v12, v12
  ds_read_b64_tr_b16 v[100:101], v10 offset:0
  v_mfma_f32_16x16x32_bf16 v[60:63], v[84:87], a[124:127], v[60:63]
  v_rcp_f32 v13, v13
  v_rcp_f32 v14, v14
  ds_read_b64_tr_b16 v[102:103], v10 offset:256
  s_waitcnt lgkmcnt(6)
  v_mfma_f32_16x16x32_bf16 v[64:67], v[88:91], a[120:123], v[64:67]
  v_rcp_f32 v15, v15
  ds_read_b64_tr_b16 v[80:81], v9 offset:1024
  v_mfma_f32_16x16x32_bf16 v[68:71], v[88:91], a[124:127], v[68:71]
  v_mul_f32 v28, v28, v12
  ds_read_b64_tr_b16 v[82:83], v9 offset:1280
  s_waitcnt lgkmcnt(6)
  v_mfma_f32_16x16x32_bf16 v[72:75], v[92:95], a[120:123], v[72:75]
  v_mul_f32 v29, v29, v13
  ds_read_b64_tr_b16 v[84:85], v10 offset:1024
  v_mfma_f32_16x16x32_bf16 v[76:79], v[92:95], a[124:127], v[76:79]
  v_mul_f32 v30, v30, v14
  ds_read_b64_tr_b16 v[86:87], v10 offset:1280
  s_waitcnt lgkmcnt(6)
  v_mfma_f32_16x16x32_bf16 v[48:51], v[96:99], a[128:131], v[48:51]
  v_mul_f32 v31, v31, v15
  ds_read_b64_tr_b16 v[88:89], v9 offset:4096
  v_mfma_f32_16x16x32_bf16 v[52:55], v[96:99], a[132:135], v[52:55]
  v_cvt_pk_bf16_f32 v38, v28, v29
  ds_read_b64_tr_b16 v[90:91], v9 offset:4352
  s_waitcnt lgkmcnt(6)
  v_mfma_f32_16x16x32_bf16 v[56:59], v[100:103], a[128:131], v[56:59]
  v_cvt_pk_bf16_f32 v39, v30, v31
  ds_read_b64_tr_b16 v[92:93], v10 offset:4096
  v_mfma_f32_16x16x32_bf16 v[60:63], v[100:103], a[132:135], v[60:63]
  buffer_store_dwordx2 v[38:39], v1, s[20:23], s38 offen offset:1280 sc1
  s_add_u32 s38, s38, s56
  ds_read_b64_tr_b16 v[94:95], v10 offset:4352
  s_waitcnt lgkmcnt(6)
  v_mfma_f32_16x16x32_bf16 v[64:67], v[80:83], a[128:131], v[64:67]
  ds_read_b64_tr_b16 v[96:97], v9 offset:5120
  v_mfma_f32_16x16x32_bf16 v[68:71], v[80:83], a[132:135], v[68:71]
  ds_read_b64_tr_b16 v[98:99], v9 offset:5376
  s_waitcnt lgkmcnt(6)
  v_mfma_f32_16x16x32_bf16 v[72:75], v[84:87], a[128:131], v[72:75]
  ds_read_b64_tr_b16 v[100:101], v10 offset:5120
  v_mfma_f32_16x16x32_bf16 v[76:79], v[84:87], a[132:135], v[76:79]
  ds_read_b64_tr_b16 v[102:103], v10 offset:5376
  s_waitcnt lgkmcnt(6)
  v_mfma_f32_16x16x32_bf16 v[48:51], v[88:91], a[136:139], v[48:51]
  v_mfma_f32_16x16x32_bf16 v[52:55], v[88:91], a[140:143], v[52:55]
  s_waitcnt lgkmcnt(4)
  v_mfma_f32_16x16x32_bf16 v[56:59], v[92:95], a[136:139], v[56:59]
  v_mfma_f32_16x16x32_bf16 v[60:63], v[92:95], a[140:143], v[60:63]
  s_waitcnt vmcnt(6)
  s_waitcnt lgkmcnt(0)
  s_barrier
  v_lshrrev_b32 v7, 5, v0
  v_lshlrev_b32 v7, 10, v7
  v_add_u32 v7, v7, v11
  v_add_u32 v7, 73728, v7
  v_xor_b32 v8, 32, v7
  v_add_u32 v9, 0x10000, v7
  v_add_u32 v10, 0x10000, v8
  v_mfma_f32_16x16x32_bf16 v[64:67], v[96:99], a[136:139], v[64:67]
  ds_read_b64_tr_b16 v[80:81], v7 offset:0
  ds_read_b64_tr_b16 v[82:83], v7 offset:256
  v_mfma_f32_16x16x32_bf16 v[68:71], v[96:99], a[140:143], v[68:71]
  ds_read_b64_tr_b16 v[84:85], v8 offset:0
  ds_read_b64_tr_b16 v[86:87], v8 offset:256
  v_mfma_f32_16x16x32_bf16 v[72:75], v[100:103], a[136:139], v[72:75]
  ds_read_b64_tr_b16 v[88:89], v7 offset:2048
  v_mfma_f32_16x16x32_bf16 v[76:79], v[100:103], a[140:143], v[76:79]
  ds_read_b64_tr_b16 v[90:91], v7 offset:2304
  s_cmp_ge_u32 s36, 36
  s_cbranch_scc1 L_k1_sg1v
  s_mov_b32 s16, s48
  s_mov_b32 s17, s49
  s_sub_u32 s43, s47, 16
  s_cmp_lt_u32 s43, 6
  s_cselect_b32 s18, 1990656, 0
  s_add_u32 s40, s36, 16
  s_lshl_b32 s40, s40, 6
  s_mul_i32 s42, s32, 55296
  s_add_u32 s40, s40, s42
  s_mov_b32 s41, 442368
  v_mov_b32 v5, v3
  s_waitcnt lgkmcnt(4)
  v_mfma_f32_16x16x32_bf16 v[96:99], v[80:83], a[0:3], 0
  ds_read_b64_tr_b16 v[92:93], v8 offset:2048
  v_mfma_f32_16x16x32_bf16 v[100:103], v[80:83], a[4:7], 0
  ds_read_b64_tr_b16 v[94:95], v8 offset:2304
  s_waitcnt lgkmcnt(4)
  v_mfma_f32_16x16x32_bf16 v[104:107], v[84:87], a[0:3], 0
  s_add_u32 m0, s39, 0
  s_nop 0
  buffer_load_dwordx4 v5, s[16:19], s40 offen lds
  s_add_u32 s40, s40, s41
  ds_read_b64_tr_b16 v[80:81], v7 offset:4096
  v_mfma_f32_16x16x32_bf16 v[108:111], v[84:87], a[4:7], 0
  ds_read_b64_tr_b16 v[82:83], v7 offset:4352
  s_waitcnt lgkmcnt(4)
  v_mfma_f32_16x16x32_bf16 v[96:99], v[88:91], a[8:11], v[96:99]
  ds_read_b64_tr_b16 v[84:85], v8 offset:4096
  v_mfma_f32_16x16x32_bf16 v[100:103], v[88:91], a[12:15], v[100:103]
  ds_read_b64_tr_b16 v[86:87], v8 offset:4352
  s_waitcnt lgkmcnt(4)
  v_mfma_f32_16x16x32_bf16 v[104:107], v[92:95], a[8:11], v[104:107]
  v_mul_f32 v12, v48, v48
  v_mul_f32 v13, v49, v49
  s_add_u32 m0, s39, 8192
  s_nop 0
  buffer_load_dwordx4 v5, s[16:19], s40 offen lds
  s_add_u32 s40, s40, s41
  ds_read_b64_tr_b16 v[88:89], v7 offset:6144
  v_mfma_f32_16x16x32_bf16 v[108:111], v[92:95], a[12:15], v[108:111]
  v_mul_f32 v14, v50, v50
  v_mul_f32 v15, v51, v51
  ds_read_b64_tr_b16 v[90:91], v7 offset:6400
  s_waitcnt lgkmcnt(4)
  v_mfma_f32_16x16x32_bf16 v[96:99], v[80:83], a[16:19], v[96:99]
  v_fmaak_f32 v12, v12, v6, 0xc0135761
  v_fmaak_f32 v13, v13, v6, 0xc0135761
  ds_read_b64_tr_b16 v[92:93], v8 offset:6144
  v_mfma_f32_16x16x32_bf16 v[100:103], v[80:83], a[20:23], v[100:103]
  v_fmaak_f32 v14, v14, v6, 0xc0135761
  v_fmaak_f32 v15, v15, v6, 0xc0135761
  v_mul_f32 v12, v12, v48
  ds_read_b64_tr_b16 v[94:95], v8 offset:6400
  s_waitcnt lgkmcnt(4)
  v_mfma_f32_16x16x32_bf16 v[104:107], v[84:87], a[16:19], v[104:107]
  v_mul_f32 v13, v13, v49
  v_mul_f32 v14, v14, v50
  s_add_u32 m0, s39, 16384
  s_nop 0
  buffer_load_dwordx4 v5, s[16:19], s40 offen lds
  s_add_u32 s40, s40, s41
  ds_read_b64_tr_b16 v[80:81], v7 offset:8192
  v_mfma_f32_16x16x32_bf16 v[108:111], v[84:87], a[20:23], v[108:111]
  v_mul_f32 v15, v15, v51
  v_exp_f32 v12, v12
  ds_read_b64_tr_b16 v[82:83], v7 offset:8448
  s_waitcnt lgkmcnt(4)
  v_mfma_f32_16x16x32_bf16 v[96:99], v[88:91], a[24:27], v[96:99]
  v_exp_f32 v13, v13
  v_exp_f32 v14, v14
  ds_read_b64_tr_b16 v[84:85], v8 offset:8192
  v_mfma_f32_16x16x32_bf16 v[100:103], v[88:91], a[28:31], v[100:103]
  v_exp_f32 v15, v15
  v_mul_f32 v48, v48, v64
  v_mul_f32 v49, v49, v65
  ds_read_b64_tr_b16 v[86:87], v8 offset:8448
  s_waitcnt lgkmcnt(4)
  v_mfma_f32_16x16x32_bf16 v[104:107], v[92:95], a[24:27], v[104:107]
  v_mul_f32 v50, v50, v66
  v_mul_f32 v51, v51, v67
  s_add_u32 m0, s39, 24576
  s_nop 0
  buffer_load_dwordx4 v5, s[16:19], s40 offen lds
  s_add_u32 s40, s40, s41
  ds_read_b64_tr_b16 v[88:89], v7 offset:10240
  v_mfma_f32_16x16x32_bf16 v[108:111], v[92:95], a[28:31], v[108:111]
  v_add_f32 v12, 1.0, v12
  v_add_f32 v13, 1.0, v13
  ds_read_b64_tr_b16 v[90:91], v7 offset:10496
  s_waitcnt lgkmcnt(4)
  v_mfma_f32_16x16x32_bf16 v[96:99], v[80:83], a[32:35], v[96:99]
  v_add_f32 v14, 1.0, v14
  v_add_f32 v15, 1.0, v15
  v_rcp_f32 v12, v12
  ds_read_b64_tr_b16 v[92:93], v8 offset:10240
  v_mfma_f32_16x16x32_bf16 v[100:103], v[80:83], a[36:39], v[100:103]
  v_rcp_f32 v13, v13
  v_rcp_f32 v14, v14
  ds_read_b64_tr_b16 v[94:95], v8 offset:10496
  s_waitcnt lgkmcnt(4)
  v_mfma_f32_16x16x32_bf16 v[104:107], v[84:87], a[32:35], v[104:107]
  v_rcp_f32 v15, v15
  v_mul_f32 v48, v48, v12
  s_add_u32 m0, s39, 32768
  s_nop 0
  buffer_load_dwordx4 v5, s[16:19], s40 offen lds
  s_add_u32 s40, s40, s41
  ds_read_b64_tr_b16 v[80:81], v7 offset:12288
  v_mfma_f32_16x16x32_bf16 v[108:111], v[84:87], a[36:39], v[108:111]
  v_mul_f32 v49, v49, v13
  v_mul_f32 v50, v50, v14
  ds_read_b64_tr_b16 v[82:83], v7 offset:12544
  s_waitcnt lgkmcnt(4)
  v_mfma_f32_16x16x32_bf16 v[96:99], v[88:91], a[40:43], v[96:99]
  v_mul_f32 v51, v51, v15
  v_cvt_pk_bf16_f32 v64, v48, v49
  v_cvt_pk_bf16_f32 v65, v50, v51
  ds_read_b64_tr_b16 v[84:85], v8 offset:12288
  v_mfma_f32_16x16x32_bf16 v[100:103], v[88:91], a[44:47], v[100:103]
  buffer_store_dwordx2 v[64:65], v1, s[20:23], s38 offen offset:0 sc1
  v_mul_f32 v12, v52, v52
  ds_read_b64_tr_b16 v[86:87], v8 offset:12544
  s_waitcnt lgkmcnt(4)
  v_mfma_f32_16x16x32_bf16 v[104:107], v[92:95], a[40:43], v[104:107]
  v_mul_f32 v13, v53, v53
  v_mul_f32 v14, v54, v54
  ds_read_b64_tr_b16 v[88:89], v7 offset:14336
  v_mfma_f32_16x16x32_bf16 v[108:111], v[92:95], a[44:47], v[108:111]
  v_mul_f32 v15, v55, v55
  v_fmaak_f32 v12, v12, v6, 0xc0135761
  ds_read_b64_tr_b16 v[90:91], v7 offset:14592
  s_waitcnt lgkmcnt(4)
  v_mfma_f32_16x16x32_bf16 v[96:99], v[80:83], a[48:51], v[96:99]
  v_fmaak_f32 v13, v13, v6, 0xc0135761
  v_fmaak_f32 v14, v14, v6, 0xc0135761
  v_fmaak_f32 v15, v15, v6, 0xc0135761
  ds_read_b64_tr_b16 v[92:93], v8 offset:14336
  v_mfma_f32_16x16x32_bf16 v[100:103], v[80:83], a[52:55], v[100:103]
  v_mul_f32 v12, v12, v52
  v_mul_f32 v13, v13, v53
  ds_read_b64_tr_b16 v[94:95], v8 offset:14592
  s_waitcnt lgkmcnt(4)
  v_mfma_f32_16x16x32_bf16 v[104:107], v[84:87], a[48:51], v[104:107]
  v_mul_f32 v14, v14, v54
  v_mul_f32 v15, v15, v55
  ds_read_b64_tr_b16 v[80:81], v7 offset:16384
  v_mfma_f32_16x16x32_bf16 v[108:111], v[84:87], a[52:55], v[108:111]
  v_exp_f32 v12, v12
  v_exp_f32 v13, v13
  v_exp_f32 v14, v14
  ds_read_b64_tr_b16 v[82:83], v7 offset:16640
  s_waitcnt lgkmcnt(4)
  v_mfma_f32_16x16x32_bf16 v[96:99], v[88:91], a[56:59], v[96:99]
  v_exp_f32 v15, v15
  v_mul_f32 v52, v52, v68
  ds_read_b64_tr_b16 v[84:85], v8 offset:16384
  v_mfma_f32_16x16x32_bf16 v[100:103], v[88:91], a[60:63], v[100:103]
  v_mul_f32 v53, v53, v69
  v_mul_f32 v54, v54, v70
  ds_read_b64_tr_b16 v[86:87], v8 offset:16640
  s_waitcnt lgkmcnt(4)
  v_mfma_f32_16x16x32_bf16 v[104:107], v[92:95], a[56:59], v[104:107]
  v_mul_f32 v55, v55, v71
  v_add_f32 v12, 1.0, v12
  ds_read_b64_tr_b16 v[88:89], v7 offset:18432
  v_mfma_f32_16x16x32_bf16 v[108:111], v[92:95], a[60:63], v[108:111]
  v_add_f32 v13, 1.0, v13
  v_add_f32 v14, 1.0, v14
  v_add_f32 v15, 1.0, v15
  ds_read_b64_tr_b16 v[90:91], v7 offset:18688
  s_waitcnt lgkmcnt(4)
  v_mfma_f32_16x16x32_bf16 v[96:99], v[80:83], a[64:67], v[96:99]
  v_rcp_f32 v12, v12
  v_rcp_f32 v13, v13
  ds_read_b64_tr_b16 v[92:93], v8 offset:18432
  v_mfma_f32_16x16x32_bf16 v[100:103], v[80:83], a[68:71], v[100:103]
  v_rcp_f32 v14, v14
  v_rcp_f32 v15, v15
  ds_read_b64_tr_b16 v[94:95], v8 offset:18688
  s_waitcnt lgkmcnt(4)
  v_mfma_f32_16x16x32_bf16 v[104:107], v[84:87], a[64:67], v[104:107]
  v_mul_f32 v52, v52, v12
  v_mul_f32 v53, v53, v13
  ds_read_b64_tr_b16 v[80:81], v7 offset:20480
  v_mfma_f32_16x16x32_bf16 v[108:111], v[84:87], a[68:71], v[108:111]
  v_mul_f32 v54, v54, v14
  v_mul_f32 v55, v55, v15
  v_cvt_pk_bf16_f32 v66, v52, v53
  ds_read_b64_tr_b16 v[82:83], v7 offset:20736
  s_waitcnt lgkmcnt(4)
  v_mfma_f32_16x16x32_bf16 v[96:99], v[88:91], a[72:75], v[96:99]
  v_cvt_pk_bf16_f32 v67, v54, v55
  buffer_store_dwordx2 v[66:67], v1, s[20:23], s38 offen offset:256 sc1
  ds_read_b64_tr_b16 v[84:85], v8 offset:20480
  v_mfma_f32_16x16x32_bf16 v[100:103], v[88:91], a[76:79], v[100:103]
  v_mul_f32 v12, v56, v56
  v_mul_f32 v13, v57, v57
  ds_read_b64_tr_b16 v[86:87], v8 offset:20736
  s_waitcnt lgkmcnt(4)
  v_mfma_f32_16x16x32_bf16 v[104:107], v[92:95], a[72:75], v[104:107]
  v_mul_f32 v14, v58, v58
  v_mul_f32 v15, v59, v59
  v_fmaak_f32 v12, v12, v6, 0xc0135761
  ds_read_b64_tr_b16 v[88:89], v7 offset:22528
  v_mfma_f32_16x16x32_bf16 v[108:111], v[92:95], a[76:79], v[108:111]
  v_fmaak_f32 v13, v13, v6, 0xc0135761
  v_fmaak_f32 v14, v14, v6, 0xc0135761
  ds_read_b64_tr_b16 v[90:91], v7 offset:22784
  s_waitcnt lgkmcnt(4)
  v_mfma_f32_16x16x32_bf16 v[96:99], v[80:83], a[80:83], v[96:99]
  v_fmaak_f32 v15, v15, v6, 0xc0135761
  v_mul_f32 v12, v12, v56
  ds_read_b64_tr_b16 v[92:93], v8 offset:22528
  v_mfma_f32_16x16x32_bf16 v[100:103], v[80:83], a[84:87], v[100:103]
  v_mul_f32 v13, v13, v57
  v_mul_f32 v14, v14, v58
  ds_read_b64_tr_b16 v[94:95], v8 offset:22784
  s_waitcnt lgkmcnt(4)
  v_mfma_f32_16x16x32_bf16 v[104:107], v[84:87], a[80:83], v[104:107]
  v_mul_f32 v15, v15, v59
  v_exp_f32 v12, v12
  v_exp_f32 v13, v13
  ds_read_b64_tr_b16 v[80:81], v7 offset:24576
  v_mfma_f32_16x16x32_bf16 v[108:111], v[84:87], a[84:87], v[108:111]
  v_exp_f32 v14, v14
  v_exp_f32 v15, v15
  ds_read_b64_tr_b16 v[82:83], v7 offset:24832
  s_waitcnt lgkmcnt(4)
  v_mfma_f32_16x16x32_bf16 v[96:99], v[88:91], a[88:91], v[96:99]
  v_mul_f32 v56, v56, v72
  v_mul_f32 v57, v57, v73
  ds_read_b64_tr_b16 v[84:85], v8 offset:24576
  v_mfma_f32_16x16x32_bf16 v[100:103], v[88:91], a[92:95], v[100:103]
  v_mul_f32 v58, v58, v74
  v_mul_f32 v59, v59, v75
  ds_read_b64_tr_b16 v[86:87], v8 offset:24832
  s_waitcnt lgkmcnt(4)
  v_mfma_f32_16x16x32_bf16 v[104:107], v[92:95], a[88:91], v[104:107]
  v_add_f32 v12, 1.0, v12
  v_add_f32 v13, 1.0, v13
  v_add_f32 v14, 1.0, v14
  ds_read_b64_tr_b16 v[88:89], v7 offset:26624
  v_mfma_f32_16x16x32_bf16 v[108:111], v[92:95], a[92:95], v[108:111]
  v_add_f32 v15, 1.0, v15
  v_rcp_f32 v12, v12
  ds_read_b64_tr_b16 v[90:91], v7 offset:26880
  s_waitcnt lgkmcnt(4)
  v_mfma_f32_16x16x32_bf16 v[96:99], v[80:83], a[96:99], v[96:99]
  v_rcp_f32 v13, v13
  v_rcp_f32 v14, v14
  ds_read_b64_tr_b16 v[92:93], v8 offset:26624
  v_mfma_f32_16x16x32_bf16 v[100:103], v[80:83], a[100:103], v[100:103]
  v_rcp_f32 v15, v15
  v_mul_f32 v56, v56, v12
  v_mul_f32 v57, v57, v13
  ds_read_b64_tr_b16 v[94:95], v8 offset:26880
  s_waitcnt lgkmcnt(4)
  v_mfma_f32_16x16x32_bf16 v[104:107], v[84:87], a[96:99], v[104:107]
  v_mul_f32 v58, v58, v14
  v_mul_f32 v59, v59, v15
  ds_read_b64_tr_b16 v[80:81], v7 offset:28672
  v_mfma_f32_16x16x32_bf16 v[108:111], v[84:87], a[100:103], v[108:111]
  v_cvt_pk_bf16_f32 v68, v56, v57
  v_cvt_pk_bf16_f32 v69, v58, v59
  ds_read_b64_tr_b16 v[82:83], v7 offset:28928
  s_waitcnt lgkmcnt(4)
  v_mfma_f32_16x16x32_bf16 v[96:99], v[88:91], a[104:107], v[96:99]
  buffer_store_dwordx2 v[68:69], v1, s[20:23], s38 offen offset:1024 sc1
  v_mul_f32 v12, v60, v60
  ds_read_b64_tr_b16 v[84:85], v8 offset:28672
  v_mfma_f32_16x16x32_bf16 v[100:103], v[88:91], a[108:111], v[100:103]
  v_mul_f32 v13, v61, v61
  v_mul_f32 v14, v62, v62
  v_mul_f32 v15, v63, v63
  ds_read_b64_tr_b16 v[86:87], v8 offset:28928
  s_waitcnt lgkmcnt(4)
  v_mfma_f32_16x16x32_bf16 v[104:107], v[92:95], a[104:107], v[104:107]
  v_fmaak_f32 v12, v12, v6, 0xc0135761
  v_fmaak_f32 v13, v13, v6, 0xc0135761
  ds_read_b64_tr_b16 v[88:89], v7 offset:30720
  v_mfma_f32_16x16x32_bf16 v[108:111], v[92:95], a[108:111], v[108:111]
  v_fmaak_f32 v14, v14, v6, 0xc0135761
  v_fmaak_f32 v15, v15, v6, 0xc0135761
  ds_read_b64_tr_b16 v[90:91], v7 offset:30976
  s_waitcnt lgkmcnt(4)
  v_mfma_f32_16x16x32_bf16 v[96:99], v[80:83], a[112:115], v[96:99]
  v_mul_f32 v12, v12, v60
  v_mul_f32 v13, v13, v61
  ds_read_b64_tr_b16 v[92:93], v8 offset:30720
  v_mfma_f32_16x16x32_bf16 v[100:103], v[80:83], a[116:119], v[100:103]
  v_mul_f32 v14, v14, v62
  v_mul_f32 v15, v15, v63
  v_exp_f32 v12, v12
  ds_read_b64_tr_b16 v[94:95], v8 offset:30976
  s_waitcnt lgkmcnt(4)
  v_mfma_f32_16x16x32_bf16 v[104:107], v[84:87], a[112:115], v[104:107]
  v_exp_f32 v13, v13
  v_exp_f32 v14, v14
  ds_read_b64_tr_b16 v[80:81], v7 offset:32768
  v_mfma_f32_16x16x32_bf16 v[108:111], v[84:87], a[116:119], v[108:111]
  v_exp_f32 v15, v15
  v_mul_f32 v60, v60, v76
  ds_read_b64_tr_b16 v[82:83], v7 offset:33024
  s_waitcnt lgkmcnt(4)
  v_mfma_f32_16x16x32_bf16 v[96:99], v[88:91], a[120:123], v[96:99]
  v_mul_f32 v61, v61, v77
  v_mul_f32 v62, v62, v78
  v_mul_f32 v63, v63, v79
  ds_read_b64_tr_b16 v[84:85], v8 offset:32768
  v_mfma_f32_16x16x32_bf16 v[100:103], v[88:91], a[124:127], v[100:103]
  v_add_f32 v12, 1.0, v12
  v_add_f32 v13, 1.0, v13
  ds_read_b64_tr_b16 v[86:87], v8 offset:33024
  s_waitcnt lgkmcnt(4)
  v_mfma_f32_16x16x32_bf16 v[104:107], v[92:95], a[120:123], v[104:107]
  v_add_f32 v14, 1.0, v14
  v_add_f32 v15, 1.0, v15
  ds_read_b64_tr_b16 v[88:89], v7 offset:34816
  v_mfma_f32_16x16x32_bf16 v[108:111], v[92:95], a[124:127], v[108:111]
  v_rcp_f32 v12, v12
  v_rcp_f32 v13, v13
  ds_read_b64_tr_b16 v[90:91], v7 offset:35072
  s_waitcnt lgkmcnt(4)
  v_mfma_f32_16x16x32_bf16 v[96:99], v[80:83], a[128:131], v[96:99]
  v_rcp_f32 v14, v14
  v_rcp_f32 v15, v15
  v_mul_f32 v60, v60, v12
  ds_read_b64_tr_b16 v[92:93], v8 offset:34816
  v_mfma_f32_16x16x32_bf16 v[100:103], v[80:83], a[132:135], v[100:103]
  v_mul_f32 v61, v61, v13
  v_mul_f32 v62, v62, v14
  ds_read_b64_tr_b16 v[94:95], v8 offset:35072
  s_waitcnt lgkmcnt(4)
  v_mfma_f32_16x16x32_bf16 v[104:107], v[84:87], a[128:131], v[104:107]
  v_mul_f32 v63, v63, v15
  v_cvt_pk_bf16_f32 v70, v60, v61
  v_mfma_f32_16x16x32_bf16 v[108:111], v[84:87], a[132:135], v[108:111]
  v_cvt_pk_bf16_f32 v71, v62, v63
  buffer_store_dwordx2 v[70:71], v1, s[20:23], s38 offen offset:1280 sc1
  s_add_u32 s38, s38, 2048
  s_waitcnt lgkmcnt(2)
  v_mfma_f32_16x16x32_bf16 v[96:99], v[88:91], a[136:139], v[96:99]
  v_mfma_f32_16x16x32_bf16 v[100:103], v[88:91], a[140:143], v[100:103]
  s_waitcnt vmcnt(4)
  s_waitcnt lgkmcnt(0)
  s_barrier
  v_lshrrev_b32 v7, 5, v0
  v_lshlrev_b32 v7, 10, v7
  v_add_u32 v7, v7, v11
  v_add_u32 v7, 0, v7
  v_xor_b32 v8, 32, v7
  v_add_u32 v9, 0x10000, v7
  v_add_u32 v10, 0x10000, v8
  v_mfma_f32_16x16x32_bf16 v[104:107], v[92:95], a[136:139], v[104:107]
  ds_read_b64_tr_b16 v[80:81], v7 offset:0
  ds_read_b64_tr_b16 v[82:83], v7 offset:256
  ds_read_b64_tr_b16 v[84:85], v8 offset:0
  v_mfma_f32_16x16x32_bf16 v[108:111], v[92:95], a[140:143], v[108:111]
  ds_read_b64_tr_b16 v[86:87], v8 offset:256
  ds_read_b64_tr_b16 v[88:89], v7 offset:2048
  ds_read_b64_tr_b16 v[90:91], v7 offset:2304
  s_cmp_ge_u32 s36, 18
  s_cselect_b32 s42, 2322432, 0
  s_cselect_b32 s44, 1.0, 0x3eae1a93
  s_lshl_b32 s43, s36, 11
  s_add_u32 s42, s42, s43
  v_lshrrev_b32 v12, 5, v0
  v_lshlrev_b32 v12, 9, v12
  v_bfe_u32 v13, v0, 4, 1
  v_lshl_add_u32 v12, v13, 8, v12
  v_and_b32 v13, 15, v0
  v_lshl_add_u32 v12, v13, 3, v12
  s_mul_i32 s43, s33, 36864
  s_add_u32 s42, s42, s43
  v_mul_f32 v96, s44, v96
  v_mul_f32 v97, s44, v97
  v_mul_f32 v98, s44, v98
  v_mul_f32 v99, s44, v99
  v_mul_f32 v100, s44, v100
  v_mul_f32 v101, s44, v101
  v_mul_f32 v102, s44, v102
  v_mul_f32 v103, s44, v103
  v_mul_f32 v104, s44, v104
  v_mul_f32 v105, s44, v105
  v_mul_f32 v106, s44, v106
  v_mul_f32 v107, s44, v107
  v_mul_f32 v108, s44, v108
  v_mul_f32 v109, s44, v109
  v_mul_f32 v110, s44, v110
  v_mul_f32 v111, s44, v111
  v_cvt_pk_bf16_f32 v96, v96, v97
  v_cvt_pk_bf16_f32 v97, v98, v99
  v_cvt_pk_bf16_f32 v98, v100, v101
  v_cvt_pk_bf16_f32 v99, v102, v103
  v_cvt_pk_bf16_f32 v100, v104, v105
  v_cvt_pk_bf16_f32 v101, v106, v107
  v_cvt_pk_bf16_f32 v102, v108, v109
  v_cvt_pk_bf16_f32 v103, v110, v111
  buffer_store_dwordx2 v[96:97], v12, s[24:27], s42 offen offset:0 sc1
  buffer_store_dwordx2 v[98:99], v12, s[24:27], s42 offen offset:128 sc1
  buffer_store_dwordx2 v[100:101], v12, s[24:27], s42 offen offset:1024 sc1
  buffer_store_dwordx2 v[102:103], v12, s[24:27], s42 offen offset:1152 sc1
  s_add_u32 s36, s36, 16
  s_nop 0
  s_branch L_k1_sg1d
L_k1_sg1v:
  s_mov_b32 s16, s48
  s_mov_b32 s17, s49
  s_sub_u32 s43, s47, 16
  s_cmp_lt_u32 s43, 6
  s_cselect_b32 s18, 1990656, 0
  s_add_u32 s40, s36, 16
  s_lshl_b32 s40, s40, 6
  s_mul_i32 s42, s32, 55296
  s_add_u32 s40, s40, s42
  s_mov_b32 s41, 442368
  v_mov_b32 v5, v3
  s_waitcnt lgkmcnt(4)
  v_mfma_f32_16x16x32_bf16 v[96:99], a[0:3], v[80:83], 0
  ds_read_b64_tr_b16 v[92:93], v8 offset:2048
  v_mfma_f32_16x16x32_bf16 v[100:103], a[4:7], v[80:83], 0
  ds_read_b64_tr_b16 v[94:95], v8 offset:2304
  s_waitcnt lgkmcnt(4)
  v_mfma_f32_16x16x32_bf16 v[104:107], a[0:3], v[84:87], 0
  s_add_u32 m0, s39, 0
  s_nop 0
  buffer_load_dwordx4 v5, s[16:19], s40 offen lds
  s_add_u32 s40, s40, s41
  ds_read_b64_tr_b16 v[80:81], v7 offset:4096
  v_mfma_f32_16x16x32_bf16 v[108:111], a[4:7], v[84:87], 0
  ds_read_b64_tr_b16 v[82:83], v7 offset:4352
  s_waitcnt lgkmcnt(4)
  v_mfma_f32_16x16x32_bf16 v[96:99], a[8:11], v[88:91], v[96:99]
  ds_read_b64_tr_b16 v[84:85], v8 offset:4096
  v_mfma_f32_16x16x32_bf16 v[100:103], a[12:15], v[88:91], v[100:103]
  ds_read_b64_tr_b16 v[86:87], v8 offset:4352
  s_waitcnt lgkmcnt(4)
  v_mfma_f32_16x16x32_bf16 v[104:107], a[8:11], v[92:95], v[104:107]
  v_mul_f32 v12, v48, v48
  v_mul_f32 v13, v49, v49
  s_add_u32 m0, s39, 8192
  s_nop 0
  buffer_load_dwordx4 v5, s[16:19], s40 offen lds
  s_add_u32 s40, s40, s41
  ds_read_b64_tr_b16 v[88:89], v7 offset:6144
  v_mfma_f32_16x16x32_bf16 v[108:111], a[12:15], v[92:95], v[108:111]
  v_mul_f32 v14, v50, v50
  v_mul_f32 v15, v51, v51
  ds_read_b64_tr_b16 v[90:91], v7 offset:6400
  s_waitcnt lgkmcnt(4)
  v_mfma_f32_16x16x32_bf16 v[96:99], a[16:19], v[80:83], v[96:99]
  v_fmaak_f32 v12, v12, v6, 0xc0135761
  v_fmaak_f32 v13, v13, v6, 0xc0135761
  ds_read_b64_tr_b16 v[92:93], v8 offset:6144
  v_mfma_f32_16x16x32_bf16 v[100:103], a[20:23], v[80:83], v[100:103]
  v_fmaak_f32 v14, v14, v6, 0xc0135761
  v_fmaak_f32 v15, v15, v6, 0xc0135761
  v_mul_f32 v12, v12, v48
  ds_read_b64_tr_b16 v[94:95], v8 offset:6400
  s_waitcnt lgkmcnt(4)
  v_mfma_f32_16x16x32_bf16 v[104:107], a[16:19], v[84:87], v[104:107]
  v_mul_f32 v13, v13, v49
  v_mul_f32 v14, v14, v50
  s_add_u32 m0, s39, 16384
  s_nop 0
  buffer_load_dwordx4 v5, s[16:19], s40 offen lds
  s_add_u32 s40, s40, s41
  ds_read_b64_tr_b16 v[80:81], v7 offset:8192
  v_mfma_f32_16x16x32_bf16 v[108:111], a[20:23], v[84:87], v[108:111]
  v_mul_f32 v15, v15, v51
  v_exp_f32 v12, v12
  ds_read_b64_tr_b16 v[82:83], v7 offset:8448
  s_waitcnt lgkmcnt(4)
  v_mfma_f32_16x16x32_bf16 v[96:99], a[24:27], v[88:91], v[96:99]
  v_exp_f32 v13, v13
  v_exp_f32 v14, v14
  ds_read_b64_tr_b16 v[84:85], v8 offset:8192
  v_mfma_f32_16x16x32_bf16 v[100:103], a[28:31], v[88:91], v[100:103]
  v_exp_f32 v15, v15
  v_mul_f32 v48, v48, v64
  v_mul_f32 v49, v49, v65
  ds_read_b64_tr_b16 v[86:87], v8 offset:8448
  s_waitcnt lgkmcnt(4)
  v_mfma_f32_16x16x32_bf16 v[104:107], a[24:27], v[92:95], v[104:107]
  v_mul_f32 v50, v50, v66
  v_mul_f32 v51, v51, v67
  s_add_u32 m0, s39, 24576
  s_nop 0
  buffer_load_dwordx4 v5, s[16:19], s40 offen lds
  s_add_u32 s40, s40, s41
  ds_read_b64_tr_b16 v[88:89], v7 offset:10240
  v_mfma_f32_16x16x32_bf16 v[108:111], a[28:31], v[92:95], v[108:111]
  v_add_f32 v12, 1.0, v12
  v_add_f32 v13, 1.0, v13
  ds_read_b64_tr_b16 v[90:91], v7 offset:10496
  s_waitcnt lgkmcnt(4)
  v_mfma_f32_16x16x32_bf16 v[96:99], a[32:35], v[80:83], v[96:99]
  v_add_f32 v14, 1.0, v14
  v_add_f32 v15, 1.0, v15
  v_rcp_f32 v12, v12
  ds_read_b64_tr_b16 v[92:93], v8 offset:10240
  v_mfma_f32_16x16x32_bf16 v[100:103], a[36:39], v[80:83], v[100:103]
  v_rcp_f32 v13, v13
  v_rcp_f32 v14, v14
  ds_read_b64_tr_b16 v[94:95], v8 offset:10496
  s_waitcnt lgkmcnt(4)
  v_mfma_f32_16x16x32_bf16 v[104:107], a[32:35], v[84:87], v[104:107]
  v_rcp_f32 v15, v15
  v_mul_f32 v48, v48, v12
  s_add_u32 m0, s39, 32768
  s_nop 0
  buffer_load_dwordx4 v5, s[16:19], s40 offen lds
  s_add_u32 s40, s40, s41
  ds_read_b64_tr_b16 v[80:81], v7 offset:12288
  v_mfma_f32_16x16x32_bf16 v[108:111], a[36:39], v[84:87], v[108:111]
  v_mul_f32 v49, v49, v13
  v_mul_f32 v50, v50, v14
  ds_read_b64_tr_b16 v[82:83], v7 offset:12544
  s_waitcnt lgkmcnt(4)
  v_mfma_f32_16x16x32_bf16 v[96:99], a[40:43], v[88:91], v[96:99]
  v_mul_f32 v51, v51, v15
  v_cvt_pk_bf16_f32 v64, v48, v49
  v_cvt_pk_bf16_f32 v65, v50, v51
  ds_read_b64_tr_b16 v[84:85], v8 offset:12288
  v_mfma_f32_16x16x32_bf16 v[100:103], a[44:47], v[88:91], v[100:103]
  buffer_store_dwordx2 v[64:65], v1, s[20:23], s38 offen offset:0 sc1
  v_mul_f32 v12, v52, v52
  ds_read_b64_tr_b16 v[86:87], v8 offset:12544
  s_waitcnt lgkmcnt(4)
  v_mfma_f32_16x16x32_bf16 v[104:107], a[40:43], v[92:95], v[104:107]
  v_mul_f32 v13, v53, v53
  v_mul_f32 v14, v54, v54
  ds_read_b64_tr_b16 v[88:89], v7 offset:14336
  v_mfma_f32_16x16x32_bf16 v[108:111], a[44:47], v[92:95], v[108:111]
  v_mul_f32 v15, v55, v55
  v_fmaak_f32 v12, v12, v6, 0xc0135761
  ds_read_b64_tr_b16 v[90:91], v7 offset:14592
  s_waitcnt lgkmcnt(4)
  v_mfma_f32_16x16x32_bf16 v[96:99], a[48:51], v[80:83], v[96:99]
  v_fmaak_f32 v13, v13, v6, 0xc0135761
  v_fmaak_f32 v14, v14, v6, 0xc0135761
  v_fmaak_f32 v15, v15, v6, 0xc0135761
  ds_read_b64_tr_b16 v[92:93], v8 offset:14336
  v_mfma_f32_16x16x32_bf16 v[100:103], a[52:55], v[80:83], v[100:103]
  v_mul_f32 v12, v12, v52
  v_mul_f32 v13, v13, v53
  ds_read_b64_tr_b16 v[94:95], v8 offset:14592
  s_waitcnt lgkmcnt(4)
  v_mfma_f32_16x16x32_bf16 v[104:107], a[48:51], v[84:87], v[104:107]
  v_mul_f32 v14, v14, v54
  v_mul_f32 v15, v15, v55
  ds_read_b64_tr_b16 v[80:81], v7 offset:16384
  v_mfma_f32_16x16x32_bf16 v[108:111], a[52:55], v[84:87], v[108:111]
  v_exp_f32 v12, v12
  v_exp_f32 v13, v13
  v_exp_f32 v14, v14
  ds_read_b64_tr_b16 v[82:83], v7 offset:16640
  s_waitcnt lgkmcnt(4)
  v_mfma_f32_16x16x32_bf16 v[96:99], a[56:59], v[88:91], v[96:99]
  v_exp_f32 v15, v15
  v_mul_f32 v52, v52, v68
  ds_read_b64_tr_b16 v[84:85], v8 offset:16384
  v_mfma_f32_16x16x32_bf16 v[100:103], a[60:63], v[88:91], v[100:103]
  v_mul_f32 v53, v53, v69
  v_mul_f32 v54, v54, v70
  ds_read_b64_tr_b16 v[86:87], v8 offset:16640
  s_waitcnt lgkmcnt(4)
  v_mfma_f32_16x16x32_bf16 v[104:107], a[56:59], v[92:95], v[104:107]
  v_mul_f32 v55, v55, v71
  v_add_f32 v12, 1.0, v12
  ds_read_b64_tr_b16 v[88:89], v7 offset:18432
  v_mfma_f32_16x16x32_bf16 v[108:111], a[60:63], v[92:95], v[108:111]
  v_add_f32 v13, 1.0, v13
  v_add_f32 v14, 1.0, v14
  v_add_f32 v15, 1.0, v15
  ds_read_b64_tr_b16 v[90:91], v7 offset:18688
  s_waitcnt lgkmcnt(4)
  v_mfma_f32_16x16x32_bf16 v[96:99], a[64:67], v[80:83], v[96:99]
  v_rcp_f32 v12, v12
  v_rcp_f32 v13, v13
  ds_read_b64_tr_b16 v[92:93], v8 offset:18432
  v_mfma_f32_16x16x32_bf16 v[100:103], a[68:71], v[80:83], v[100:103]
  v_rcp_f32 v14, v14
  v_rcp_f32 v15, v15
  ds_read_b64_tr_b16 v[94:95], v8 offset:18688
  s_waitcnt lgkmcnt(4)
  v_mfma_f32_16x16x32_bf16 v[104:107], a[64:67], v[84:87], v[104:107]
  v_mul_f32 v52, v52, v12
  v_mul_f32 v53, v53, v13
  ds_read_b64_tr_b16 v[80:81], v7 offset:20480
  v_mfma_f32_16x16x32_bf16 v[108:111], a[68:71], v[84:87], v[108:111]
  v_mul_f32 v54, v54, v14
  v_mul_f32 v55, v55, v15
  v_cvt_pk_bf16_f32 v66, v52, v53
  ds_read_b64_tr_b16 v[82:83], v7 offset:20736
  s_waitcnt lgkmcnt(4)
  v_mfma_f32_16x16x32_bf16 v[96:99], a[72:75], v[88:91], v[96:99]
  v_cvt_pk_bf16_f32 v67, v54, v55
  buffer_store_dwordx2 v[66:67], v1, s[20:23], s38 offen offset:256 sc1
  ds_read_b64_tr_b16 v[84:85], v8 offset:20480
  v_mfma_f32_16x16x32_bf16 v[100:103], a[76:79], v[88:91], v[100:103]
  v_mul_f32 v12, v56, v56
  v_mul_f32 v13, v57, v57
  ds_read_b64_tr_b16 v[86:87], v8 offset:20736
  s_waitcnt lgkmcnt(4)
  v_mfma_f32_16x16x32_bf16 v[104:107], a[72:75], v[92:95], v[104:107]
  v_mul_f32 v14, v58, v58
  v_mul_f32 v15, v59, v59
  v_fmaak_f32 v12, v12, v6, 0xc0135761
  ds_read_b64_tr_b16 v[88:89], v7 offset:22528
  v_mfma_f32_16x16x32_bf16 v[108:111], a[76:79], v[92:95], v[108:111]
  v_fmaak_f32 v13, v13, v6, 0xc0135761
  v_fmaak_f32 v14, v14, v6, 0xc0135761
  ds_read_b64_tr_b16 v[90:91], v7 offset:22784
  s_waitcnt lgkmcnt(4)
  v_mfma_f32_16x16x32_bf16 v[96:99], a[80:83], v[80:83], v[96:99]
  v_fmaak_f32 v15, v15, v6, 0xc0135761
  v_mul_f32 v12, v12, v56
  ds_read_b64_tr_b16 v[92:93], v8 offset:22528
  v_mfma_f32_16x16x32_bf16 v[100:103], a[84:87], v[80:83], v[100:103]
  v_mul_f32 v13, v13, v57
  v_mul_f32 v14, v14, v58
  ds_read_b64_tr_b16 v[94:95], v8 offset:22784
  s_waitcnt lgkmcnt(4)
  v_mfma_f32_16x16x32_bf16 v[104:107], a[80:83], v[84:87], v[104:107]
  v_mul_f32 v15, v15, v59
  v_exp_f32 v12, v12
  v_exp_f32 v13, v13
  ds_read_b64_tr_b16 v[80:81], v7 offset:24576
  v_mfma_f32_16x16x32_bf16 v[108:111], a[84:87], v[84:87], v[108:111]
  v_exp_f32 v14, v14
  v_exp_f32 v15, v15
  ds_read_b64_tr_b16 v[82:83], v7 offset:24832
  s_waitcnt lgkmcnt(4)
  v_mfma_f32_16x16x32_bf16 v[96:99], a[88:91], v[88:91], v[96:99]
  v_mul_f32 v56, v56, v72
  v_mul_f32 v57, v57, v73
  ds_read_b64_tr_b16 v[84:85], v8 offset:24576
  v_mfma_f32_16x16x32_bf16 v[100:103], a[92:95], v[88:91], v[100:103]
  v_mul_f32 v58, v58, v74
  v_mul_f32 v59, v59, v75
  ds_read_b64_tr_b16 v[86:87], v8 offset:24832
  s_waitcnt lgkmcnt(4)
  v_mfma_f32_16x16x32_bf16 v[104:107], a[88:91], v[92:95], v[104:107]
  v_add_f32 v12, 1.0, v12
  v_add_f32 v13, 1.0, v13
  v_add_f32 v14, 1.0, v14
  ds_read_b64_tr_b16 v[88:89], v7 offset:26624
  v_mfma_f32_16x16x32_bf16 v[108:111], a[92:95], v[92:95], v[108:111]
  v_add_f32 v15, 1.0, v15
  v_rcp_f32 v12, v12
  ds_read_b64_tr_b16 v[90:91], v7 offset:26880
  s_waitcnt lgkmcnt(4)
  v_mfma_f32_16x16x32_bf16 v[96:99], a[96:99], v[80:83], v[96:99]
  v_rcp_f32 v13, v13
  v_rcp_f32 v14, v14
  ds_read_b64_tr_b16 v[92:93], v8 offset:26624
  v_mfma_f32_16x16x32_bf16 v[100:103], a[100:103], v[80:83], v[100:103]
  v_rcp_f32 v15, v15
  v_mul_f32 v56, v56, v12
  v_mul_f32 v57, v57, v13
  ds_read_b64_tr_b16 v[94:95], v8 offset:26880
  s_waitcnt lgkmcnt(4)
  v_mfma_f32_16x16x32_bf16 v[104:107], a[96:99], v[84:87], v[104:107]
  v_mul_f32 v58, v58, v14
  v_mul_f32 v59, v59, v15
  ds_read_b64_tr_b16 v[80:81], v7 offset:28672
  v_mfma_f32_16x16x32_bf16 v[108:111], a[100:103], v[84:87], v[108:111]
  v_cvt_pk_bf16_f32 v68, v56, v57
  v_cvt_pk_bf16_f32 v69, v58, v59
  ds_read_b64_tr_b16 v[82:83], v7 offset:28928
  s_waitcnt lgkmcnt(4)
  v_mfma_f32_16x16x32_bf16 v[96:99], a[104:107], v[88:91], v[96:99]
  buffer_store_dwordx2 v[68:69], v1, s[20:23], s38 offen offset:1024 sc1
  v_mul_f32 v12, v60, v60
  ds_read_b64_tr_b16 v[84:85], v8 offset:28672
  v_mfma_f32_16x16x32_bf16 v[100:103], a[108:111], v[88:91], v[100:103]
  v_mul_f32 v13, v61, v61
  v_mul_f32 v14, v62, v62
  v_mul_f32 v15, v63, v63
  ds_read_b64_tr_b16 v[86:87], v8 offset:28928
  s_waitcnt lgkmcnt(4)
  v_mfma_f32_16x16x32_bf16 v[104:107], a[104:107], v[92:95], v[104:107]
  v_fmaak_f32 v12, v12, v6, 0xc0135761
  v_fmaak_f32 v13, v13, v6, 0xc0135761
  ds_read_b64_tr_b16 v[88:89], v7 offset:30720
  v_mfma_f32_16x16x32_bf16 v[108:111], a[108:111], v[92:95], v[108:111]
  v_fmaak_f32 v14, v14, v6, 0xc0135761
  v_fmaak_f32 v15, v15, v6, 0xc0135761
  ds_read_b64_tr_b16 v[90:91], v7 offset:30976
  s_waitcnt lgkmcnt(4)
  v_mfma_f32_16x16x32_bf16 v[96:99], a[112:115], v[80:83], v[96:99]
  v_mul_f32 v12, v12, v60
  v_mul_f32 v13, v13, v61
  ds_read_b64_tr_b16 v[92:93], v8 offset:30720
  v_mfma_f32_16x16x32_bf16 v[100:103], a[116:119], v[80:83], v[100:103]
  v_mul_f32 v14, v14, v62
  v_mul_f32 v15, v15, v63
  v_exp_f32 v12, v12
  ds_read_b64_tr_b16 v[94:95], v8 offset:30976
  s_waitcnt lgkmcnt(4)
  v_mfma_f32_16x16x32_bf16 v[104:107], a[112:115], v[84:87], v[104:107]
  v_exp_f32 v13, v13
  v_exp_f32 v14, v14
  ds_read_b64_tr_b16 v[80:81], v7 offset:32768
  v_mfma_f32_16x16x32_bf16 v[108:111], a[116:119], v[84:87], v[108:111]
  v_exp_f32 v15, v15
  v_mul_f32 v60, v60, v76
  ds_read_b64_tr_b16 v[82:83], v7 offset:33024
  s_waitcnt lgkmcnt(4)
  v_mfma_f32_16x16x32_bf16 v[96:99], a[120:123], v[88:91], v[96:99]
  v_mul_f32 v61, v61, v77
  v_mul_f32 v62, v62, v78
  v_mul_f32 v63, v63, v79
  ds_read_b64_tr_b16 v[84:85], v8 offset:32768
  v_mfma_f32_16x16x32_bf16 v[100:103], a[124:127], v[88:91], v[100:103]
  v_add_f32 v12, 1.0, v12
  v_add_f32 v13, 1.0, v13
  ds_read_b64_tr_b16 v[86:87], v8 offset:33024
  s_waitcnt lgkmcnt(4)
  v_mfma_f32_16x16x32_bf16 v[104:107], a[120:123], v[92:95], v[104:107]
  v_add_f32 v14, 1.0, v14
  v_add_f32 v15, 1.0, v15
  ds_read_b64_tr_b16 v[88:89], v7 offset:34816
  v_mfma_f32_16x16x32_bf16 v[108:111], a[124:127], v[92:95], v[108:111]
  v_rcp_f32 v12, v12
  v_rcp_f32 v13, v13
  ds_read_b64_tr_b16 v[90:91], v7 offset:35072
  s_waitcnt lgkmcnt(4)
  v_mfma_f32_16x16x32_bf16 v[96:99], a[128:131], v[80:83], v[96:99]
  v_rcp_f32 v14, v14
  v_rcp_f32 v15, v15
  v_mul_f32 v60, v60, v12
  ds_read_b64_tr_b16 v[92:93], v8 offset:34816
  v_mfma_f32_16x16x32_bf16 v[100:103], a[132:135], v[80:83], v[100:103]
  v_mul_f32 v61, v61, v13
  v_mul_f32 v62, v62, v14
  ds_read_b64_tr_b16 v[94:95], v8 offset:35072
  s_waitcnt lgkmcnt(4)
  v_mfma_f32_16x16x32_bf16 v[104:107], a[128:131], v[84:87], v[104:107]
  v_mul_f32 v63, v63, v15
  v_cvt_pk_bf16_f32 v70, v60, v61
  v_mfma_f32_16x16x32_bf16 v[108:111], a[132:135], v[84:87], v[108:111]
  v_cvt_pk_bf16_f32 v71, v62, v63
  buffer_store_dwordx2 v[70:71], v1, s[20:23], s38 offen offset:1280 sc1
  s_add_u32 s38, s38, 2048
  s_waitcnt lgkmcnt(2)
  v_mfma_f32_16x16x32_bf16 v[96:99], a[136:139], v[88:91], v[96:99]
  v_mfma_f32_16x16x32_bf16 v[100:103], a[140:143], v[88:91], v[100:103]
  s_waitcnt vmcnt(4)
  s_waitcnt lgkmcnt(0)
  s_barrier
  v_lshrrev_b32 v7, 5, v0
  v_lshlrev_b32 v7, 10, v7
  v_add_u32 v7, v7, v11
  v_add_u32 v7, 0, v7
  v_xor_b32 v8, 32, v7
  v_add_u32 v9, 0x10000, v7
  v_add_u32 v10, 0x10000, v8
  v_mfma_f32_16x16x32_bf16 v[104:107], a[136:139], v[92:95], v[104:107]
  ds_read_b64_tr_b16 v[80:81], v7 offset:0
  ds_read_b64_tr_b16 v[82:83], v7 offset:256
  ds_read_b64_tr_b16 v[84:85], v8 offset:0
  v_mfma_f32_16x16x32_bf16 v[108:111], a[140:143], v[92:95], v[108:111]
  ds_read_b64_tr_b16 v[86:87], v8 offset:256
  ds_read_b64_tr_b16 v[88:89], v7 offset:2048
  ds_read_b64_tr_b16 v[90:91], v7 offset:2304
  s_sub_u32 s42, s36, 36
  s_lshl_b32 s42, s42, 11
  s_add_u32 s42, s42, 4718592
  v_lshrrev_b32 v12, 5, v0
  v_lshlrev_b32 v12, 9, v12
  v_and_b32 v13, 15, v0
  v_lshl_add_u32 v12, v13, 4, v12
  v_bfe_u32 v13, v0, 4, 1
  v_lshl_add_u32 v12, v13, 3, v12
  s_mul_i32 s43, s33, 36864
  s_add_u32 s42, s42, s43
  v_cvt_pk_bf16_f32 v96, v96, v97
  v_cvt_pk_bf16_f32 v97, v98, v99
  v_cvt_pk_bf16_f32 v98, v100, v101
  v_cvt_pk_bf16_f32 v99, v102, v103
  v_cvt_pk_bf16_f32 v100, v104, v105
  v_cvt_pk_bf16_f32 v101, v106, v107
  v_cvt_pk_bf16_f32 v102, v108, v109
  v_cvt_pk_bf16_f32 v103, v110, v111
  buffer_store_dwordx2 v[96:97], v12, s[24:27], s42 offen offset:0 sc1
  buffer_store_dwordx2 v[98:99], v12, s[24:27], s42 offen offset:1024 sc1
  buffer_store_dwordx2 v[100:101], v12, s[24:27], s42 offen offset:256 sc1
  buffer_store_dwordx2 v[102:103], v12, s[24:27], s42 offen offset:1280 sc1
  s_add_u32 s36, s36, 16
  s_nop 0
L_k1_sg1d:
  s_sub_u32 s43, s47, 16
  s_cmp_lt_u32 s43, 6
  s_cbranch_scc0 L_k1_fin
  s_mov_b32 s18, 0
  s_waitcnt lgkmcnt(4)
  v_mfma_f32_16x16x32_bf16 v[96:99], a[0:3], v[80:83], 0
  ds_read_b64_tr_b16 v[92:93], v8 offset:2048
  v_mfma_f32_16x16x32_bf16 v[100:103], a[4:7], v[80:83], 0
  ds_read_b64_tr_b16 v[94:95], v8 offset:2304
  s_waitcnt lgkmcnt(4)
  v_mfma_f32_16x16x32_bf16 v[104:107], a[0:3], v[84:87], 0
  ds_read_b64_tr_b16 v[80:81], v7 offset:4096
  v_mfma_f32_16x16x32_bf16 v[108:111], a[4:7], v[84:87], 0
  ds_read_b64_tr_b16 v[82:83], v7 offset:4352
  s_waitcnt lgkmcnt(4)
  v_mfma_f32_16x16x32_bf16 v[96:99], a[8:11], v[88:91], v[96:99]
  ds_read_b64_tr_b16 v[84:85], v8 offset:4096
  v_mfma_f32_16x16x32_bf16 v[100:103], a[12:15], v[88:91], v[100:103]
  ds_read_b64_tr_b16 v[86:87], v8 offset:4352
  s_waitcnt lgkmcnt(4)
  v_mfma_f32_16x16x32_bf16 v[104:107], a[8:11], v[92:95], v[104:107]
  ds_read_b64_tr_b16 v[88:89], v7 offset:6144
  v_mfma_f32_16x16x32_bf16 v[108:111], a[12:15], v[92:95], v[108:111]
  ds_read_b64_tr_b16 v[90:91], v7 offset:6400
  s_waitcnt lgkmcnt(4)
  v_mfma_f32_16x16x32_bf16 v[96:99], a[16:19], v[80:83], v[96:99]
  ds_read_b64_tr_b16 v[92:93], v8 offset:6144
  v_mfma_f32_16x16x32_bf16 v[100:103], a[20:23], v[80:83], v[100:103]
  ds_read_b64_tr_b16 v[94:95], v8 offset:6400
  s_waitcnt lgkmcnt(4)
  v_mfma_f32_16x16x32_bf16 v[104:107], a[16:19], v[84:87], v[104:107]
  ds_read_b64_tr_b16 v[80:81], v7 offset:8192
  v_mfma_f32_16x16x32_bf16 v[108:111], a[20:23], v[84:87], v[108:111]
  ds_read_b64_tr_b16 v[82:83], v7 offset:8448
  s_waitcnt lgkmcnt(4)
  v_mfma_f32_16x16x32_bf16 v[96:99], a[24:27], v[88:91], v[96:99]
  ds_read_b64_tr_b16 v[84:85], v8 offset:8192
  v_mfma_f32_16x16x32_bf16 v[100:103], a[28:31], v[88:91], v[100:103]
  ds_read_b64_tr_b16 v[86:87], v8 offset:8448
  s_waitcnt lgkmcnt(4)
  v_mfma_f32_16x16x32_bf16 v[104:107], a[24:27], v[92:95], v[104:107]
  ds_read_b64_tr_b16 v[88:89], v7 offset:10240
  v_mfma_f32_16x16x32_bf16 v[108:111], a[28:31], v[92:95], v[108:111]
  ds_read_b64_tr_b16 v[90:91], v7 offset:10496
  s_waitcnt lgkmcnt(4)
  v_mfma_f32_16x16x32_bf16 v[96:99], a[32:35], v[80:83], v[96:99]
  ds_read_b64_tr_b16 v[92:93], v8 offset:10240
  v_mfma_f32_16x16x32_bf16 v[100:103], a[36:39], v[80:83], v[100:103]
  ds_read_b64_tr_b16 v[94:95], v8 offset:10496
  s_waitcnt lgkmcnt(4)
  v_mfma_f32_16x16x32_bf16 v[104:107], a[32:35], v[84:87], v[104:107]
  ds_read_b64_tr_b16 v[80:81], v7 offset:12288
  v_mfma_f32_16x16x32_bf16 v[108:111], a[36:39], v[84:87], v[108:111]
  ds_read_b64_tr_b16 v[82:83], v7 offset:12544
  s_waitcnt lgkmcnt(4)
  v_mfma_f32_16x16x32_bf16 v[96:99], a[40:43], v[88:91], v[96:99]
  ds_read_b64_tr_b16 v[84:85], v8 offset:12288
  v_mfma_f32_16x16x32_bf16 v[100:103], a[44:47], v[88:91], v[100:103]
  ds_read_b64_tr_b16 v[86:87], v8 offset:12544
  s_waitcnt lgkmcnt(4)
  v_mfma_f32_16x16x32_bf16 v[104:107], a[40:43], v[92:95], v[104:107]
  ds_read_b64_tr_b16 v[88:89], v7 offset:14336
  v_mfma_f32_16x16x32_bf16 v[108:111], a[44:47], v[92:95], v[108:111]
  ds_read_b64_tr_b16 v[90:91], v7 offset:14592
  s_waitcnt lgkmcnt(4)
  v_mfma_f32_16x16x32_bf16 v[96:99], a[48:51], v[80:83], v[96:99]
  ds_read_b64_tr_b16 v[92:93], v8 offset:14336
  v_mfma_f32_16x16x32_bf16 v[100:103], a[52:55], v[80:83], v[100:103]
  ds_read_b64_tr_b16 v[94:95], v8 offset:14592
  s_waitcnt lgkmcnt(4)
  v_mfma_f32_16x16x32_bf16 v[104:107], a[48:51], v[84:87], v[104:107]
  ds_read_b64_tr_b16 v[80:81], v7 offset:16384
  v_mfma_f32_16x16x32_bf16 v[108:111], a[52:55], v[84:87], v[108:111]
  ds_read_b64_tr_b16 v[82:83], v7 offset:16640
  s_waitcnt lgkmcnt(4)
  v_mfma_f32_16x16x32_bf16 v[96:99], a[56:59], v[88:91], v[96:99]
  ds_read_b64_tr_b16 v[84:85], v8 offset:16384
  v_mfma_f32_16x16x32_bf16 v[100:103], a[60:63], v[88:91], v[100:103]
  ds_read_b64_tr_b16 v[86:87], v8 offset:16640
  s_waitcnt lgkmcnt(4)
  v_mfma_f32_16x16x32_bf16 v[104:107], a[56:59], v[92:95], v[104:107]
  ds_read_b64_tr_b16 v[88:89], v7 offset:18432
  v_mfma_f32_16x16x32_bf16 v[108:111], a[60:63], v[92:95], v[108:111]
  ds_read_b64_tr_b16 v[90:91], v7 offset:18688
  s_waitcnt lgkmcnt(4)
  v_mfma_f32_16x16x32_bf16 v[96:99], a[64:67], v[80:83], v[96:99]
  ds_read_b64_tr_b16 v[92:93], v8 offset:18432
  v_mfma_f32_16x16x32_bf16 v[100:103], a[68:71], v[80:83], v[100:103]
  ds_read_b64_tr_b16 v[94:95], v8 offset:18688
  s_waitcnt lgkmcnt(4)
  v_mfma_f32_16x16x32_bf16 v[104:107], a[64:67], v[84:87], v[104:107]
  ds_read_b64_tr_b16 v[80:81], v7 offset:20480
  v_mfma_f32_16x16x32_bf16 v[108:111], a[68:71], v[84:87], v[108:111]
  ds_read_b64_tr_b16 v[82:83], v7 offset:20736
  s_waitcnt lgkmcnt(4)
  v_mfma_f32_16x16x32_bf16 v[96:99], a[72:75], v[88:91], v[96:99]
  ds_read_b64_tr_b16 v[84:85], v8 offset:20480
  v_mfma_f32_16x16x32_bf16 v[100:103], a[76:79], v[88:91], v[100:103]
  ds_read_b64_tr_b16 v[86:87], v8 offset:20736
  s_waitcnt lgkmcnt(4)
  v_mfma_f32_16x16x32_bf16 v[104:107], a[72:75], v[92:95], v[104:107]
  ds_read_b64_tr_b16 v[88:89], v7 offset:22528
  v_mfma_f32_16x16x32_bf16 v[108:111], a[76:79], v[92:95], v[108:111]
  ds_read_b64_tr_b16 v[90:91], v7 offset:22784
  s_waitcnt lgkmcnt(4)
  v_mfma_f32_16x16x32_bf16 v[96:99], a[80:83], v[80:83], v[96:99]
  ds_read_b64_tr_b16 v[92:93], v8 offset:22528
  v_mfma_f32_16x16x32_bf16 v[100:103], a[84:87], v[80:83], v[100:103]
  ds_read_b64_tr_b16 v[94:95], v8 offset:22784
  s_waitcnt lgkmcnt(4)
  v_mfma_f32_16x16x32_bf16 v[104:107], a[80:83], v[84:87], v[104:107]
  ds_read_b64_tr_b16 v[80:81], v7 offset:24576
  v_mfma_f32_16x16x32_bf16 v[108:111], a[84:87], v[84:87], v[108:111]
  ds_read_b64_tr_b16 v[82:83], v7 offset:24832
  s_waitcnt lgkmcnt(4)
  v_mfma_f32_16x16x32_bf16 v[96:99], a[88:91], v[88:91], v[96:99]
  ds_read_b64_tr_b16 v[84:85], v8 offset:24576
  v_mfma_f32_16x16x32_bf16 v[100:103], a[92:95], v[88:91], v[100:103]
  ds_read_b64_tr_b16 v[86:87], v8 offset:24832
  s_waitcnt lgkmcnt(4)
  v_mfma_f32_16x16x32_bf16 v[104:107], a[88:91], v[92:95], v[104:107]
  ds_read_b64_tr_b16 v[88:89], v7 offset:26624
  v_mfma_f32_16x16x32_bf16 v[108:111], a[92:95], v[92:95], v[108:111]
  ds_read_b64_tr_b16 v[90:91], v7 offset:26880
  s_waitcnt lgkmcnt(4)
  v_mfma_f32_16x16x32_bf16 v[96:99], a[96:99], v[80:83], v[96:99]
  ds_read_b64_tr_b16 v[92:93], v8 offset:26624
  v_mfma_f32_16x16x32_bf16 v[100:103], a[100:103], v[80:83], v[100:103]
  ds_read_b64_tr_b16 v[94:95], v8 offset:26880
  s_waitcnt lgkmcnt(4)
  v_mfma_f32_16x16x32_bf16 v[104:107], a[96:99], v[84:87], v[104:107]
  ds_read_b64_tr_b16 v[80:81], v7 offset:28672
  v_mfma_f32_16x16x32_bf16 v[108:111], a[100:103], v[84:87], v[108:111]
  ds_read_b64_tr_b16 v[82:83], v7 offset:28928
  s_waitcnt lgkmcnt(4)
  v_mfma_f32_16x16x32_bf16 v[96:99], a[104:107], v[88:91], v[96:99]
  ds_read_b64_tr_b16 v[84:85], v8 offset:28672
  v_mfma_f32_16x16x32_bf16 v[100:103], a[108:111], v[88:91], v[100:103]
  ds_read_b64_tr_b16 v[86:87], v8 offset:28928
  s_waitcnt lgkmcnt(4)
  v_mfma_f32_16x16x32_bf16 v[104:107], a[104:107], v[92:95], v[104:107]
  ds_read_b64_tr_b16 v[88:89], v7 offset:30720
  v_mfma_f32_16x16x32_bf16 v[108:111], a[108:111], v[92:95], v[108:111]
  ds_read_b64_tr_b16 v[90:91], v7 offset:30976
  s_waitcnt lgkmcnt(4)
  v_mfma_f32_16x16x32_bf16 v[96:99], a[112:115], v[80:83], v[96:99]
  ds_read_b64_tr_b16 v[92:93], v8 offset:30720
  v_mfma_f32_16x16x32_bf16 v[100:103], a[116:119], v[80:83], v[100:103]
  ds_read_b64_tr_b16 v[94:95], v8 offset:30976
  s_waitcnt lgkmcnt(4)
  v_mfma_f32_16x16x32_bf16 v[104:107], a[112:115], v[84:87], v[104:107]
  ds_read_b64_tr_b16 v[80:81], v7 offset:32768
  v_mfma_f32_16x16x32_bf16 v[108:111], a[116:119], v[84:87], v[108:111]
  ds_read_b64_tr_b16 v[82:83], v7 offset:33024
  s_waitcnt lgkmcnt(4)
  v_mfma_f32_16x16x32_bf16 v[96:99], a[120:123], v[88:91], v[96:99]
  ds_read_b64_tr_b16 v[84:85], v8 offset:32768
  v_mfma_f32_16x16x32_bf16 v[100:103], a[124:127], v[88:91], v[100:103]
  ds_read_b64_tr_b16 v[86:87], v8 offset:33024
  s_waitcnt lgkmcnt(4)
  v_mfma_f32_16x16x32_bf16 v[104:107], a[120:123], v[92:95], v[104:107]
  ds_read_b64_tr_b16 v[88:89], v7 offset:34816
  v_mfma_f32_16x16x32_bf16 v[108:111], a[124:127], v[92:95], v[108:111]
  ds_read_b64_tr_b16 v[90:91], v7 offset:35072
  s_waitcnt lgkmcnt(4)
  v_mfma_f32_16x16x32_bf16 v[96:99], a[128:131], v[80:83], v[96:99]
  ds_read_b64_tr_b16 v[92:93], v8 offset:34816
  v_mfma_f32_16x16x32_bf16 v[100:103], a[132:135], v[80:83], v[100:103]
  ds_read_b64_tr_b16 v[94:95], v8 offset:35072
  s_waitcnt lgkmcnt(4)
  v_mfma_f32_16x16x32_bf16 v[104:107], a[128:131], v[84:87], v[104:107]
  v_mfma_f32_16x16x32_bf16 v[108:111], a[132:135], v[84:87], v[108:111]
  s_waitcnt lgkmcnt(2)
  v_mfma_f32_16x16x32_bf16 v[96:99], a[136:139], v[88:91], v[96:99]
  v_mfma_f32_16x16x32_bf16 v[100:103], a[140:143], v[88:91], v[100:103]
  s_waitcnt lgkmcnt(0)
  s_barrier
  v_lshrrev_b32 v7, 5, v0
  v_lshlrev_b32 v7, 10, v7
  v_add_u32 v7, v7, v11
  v_add_u32 v7, 73728, v7
  v_xor_b32 v8, 32, v7
  v_add_u32 v9, 0x10000, v7
  v_add_u32 v10, 0x10000, v8
  v_mfma_f32_16x16x32_bf16 v[104:107], a[136:139], v[92:95], v[104:107]
  ds_read_b64_tr_b16 v[80:81], v7 offset:0
  ds_read_b64_tr_b16 v[82:83], v7 offset:256
  ds_read_b64_tr_b16 v[84:85], v8 offset:0
  v_mfma_f32_16x16x32_bf16 v[108:111], a[140:143], v[92:95], v[108:111]
  ds_read_b64_tr_b16 v[86:87], v8 offset:256
  ds_read_b64_tr_b16 v[88:89], v7 offset:2048
  ds_read_b64_tr_b16 v[90:91], v7 offset:2304
  s_sub_u32 s42, s36, 36
  s_lshl_b32 s42, s42, 11
  s_add_u32 s42, s42, 4718592
  v_lshrrev_b32 v12, 5, v0
  v_lshlrev_b32 v12, 9, v12
  v_and_b32 v13, 15, v0
  v_lshl_add_u32 v12, v13, 4, v12
  v_bfe_u32 v13, v0, 4, 1
  v_lshl_add_u32 v12, v13, 3, v12
  s_mul_i32 s43, s33, 36864
  s_add_u32 s42, s42, s43
  v_cvt_pk_bf16_f32 v96, v96, v97
  v_cvt_pk_bf16_f32 v97, v98, v99
  v_cvt_pk_bf16_f32 v98, v100, v101
  v_cvt_pk_bf16_f32 v99, v102, v103
  v_cvt_pk_bf16_f32 v100, v104, v105
  v_cvt_pk_bf16_f32 v101, v106, v107
  v_cvt_pk_bf16_f32 v102, v108, v109
  v_cvt_pk_bf16_f32 v103, v110, v111
  buffer_store_dwordx2 v[96:97], v12, s[24:27], s42 offen offset:0 sc1
  buffer_store_dwordx2 v[98:99], v12, s[24:27], s42 offen offset:1024 sc1
  buffer_store_dwordx2 v[100:101], v12, s[24:27], s42 offen offset:256 sc1
  buffer_store_dwordx2 v[102:103], v12, s[24:27], s42 offen offset:1280 sc1
  s_add_u32 s36, s36, 16
  s_nop 0
  s_branch L_k1_fin
L_k1_drain:
  s_waitcnt lgkmcnt(0)
  s_nop 7
  v_mul_f32 v12, v16, v16
  v_mul_f32 v13, v17, v17
  v_mul_f32 v14, v18, v18
  v_mul_f32 v15, v19, v19
  v_fmaak_f32 v12, v12, v6, 0xc0135761
  v_fmaak_f32 v13, v13, v6, 0xc0135761
  v_fmaak_f32 v14, v14, v6, 0xc0135761
  v_fmaak_f32 v15, v15, v6, 0xc0135761
  v_mul_f32 v12, v12, v16
  v_mul_f32 v13, v13, v17
  v_mul_f32 v14, v14, v18
  v_mul_f32 v15, v15, v19
  v_exp_f32 v12, v12
  v_exp_f32 v13, v13
  v_exp_f32 v14, v14
  v_exp_f32 v15, v15
  v_mul_f32 v16, v16, v32
  v_mul_f32 v17, v17, v33
  v_mul_f32 v18, v18, v34
  v_mul_f32 v19, v19, v35
  v_add_f32 v12, 1.0, v12
  v_add_f32 v13, 1.0, v13
  v_add_f32 v14, 1.0, v14
  v_add_f32 v15, 1.0, v15
  v_rcp_f32 v12, v12
  v_rcp_f32 v13, v13
  v_rcp_f32 v14, v14
  v_rcp_f32 v15, v15
  v_mul_f32 v16, v16, v12
  v_mul_f32 v17, v17, v13
  v_mul_f32 v18, v18, v14
  v_mul_f32 v19, v19, v15
  v_cvt_pk_bf16_f32 v32, v16, v17
  v_cvt_pk_bf16_f32 v33, v18, v19
  buffer_store_dwordx2 v[32:33], v1, s[20:23], s38 offen offset:0 sc1
  v_mul_f32 v12, v20, v20
  v_mul_f32 v13, v21, v21
  v_mul_f32 v14, v22, v22
  v_mul_f32 v15, v23, v23
  v_fmaak_f32 v12, v12, v6, 0xc0135761
  v_fmaak_f32 v13, v13, v6, 0xc0135761
  v_fmaak_f32 v14, v14, v6, 0xc0135761
  v_fmaak_f32 v15, v15, v6, 0xc0135761
  v_mul_f32 v12, v12, v20
  v_mul_f32 v13, v13, v21
  v_mul_f32 v14, v14, v22
  v_mul_f32 v15, v15, v23
  v_exp_f32 v12, v12
  v_exp_f32 v13, v13
  v_exp_f32 v14, v14
  v_exp_f32 v15, v15
  v_mul_f32 v20, v20, v36
  v_mul_f32 v21, v21, v37
  v_mul_f32 v22, v22, v38
  v_mul_f32 v23, v23, v39
  v_add_f32 v12, 1.0, v12
  v_add_f32 v13, 1.0, v13
  v_add_f32 v14, 1.0, v14
  v_add_f32 v15, 1.0, v15
  v_rcp_f32 v12, v12
  v_rcp_f32 v13, v13
  v_rcp_f32 v14, v14
  v_rcp_f32 v15, v15
  v_mul_f32 v20, v20, v12
  v_mul_f32 v21, v21, v13
  v_mul_f32 v22, v22, v14
  v_mul_f32 v23, v23, v15
  v_cvt_pk_bf16_f32 v34, v20, v21
  v_cvt_pk_bf16_f32 v35, v22, v23
  buffer_store_dwordx2 v[34:35], v1, s[20:23], s38 offen offset:256 sc1
  v_mul_f32 v12, v24, v24
  v_mul_f32 v13, v25, v25
  v_mul_f32 v14, v26, v26
  v_mul_f32 v15, v27, v27
  v_fmaak_f32 v12, v12, v6, 0xc0135761
  v_fmaak_f32 v13, v13, v6, 0xc0135761
  v_fmaak_f32 v14, v14, v6, 0xc0135761
  v_fmaak_f32 v15, v15, v6, 0xc0135761
  v_mul_f32 v12, v12, v24
  v_mul_f32 v13, v13, v25
  v_mul_f32 v14, v14, v26
  v_mul_f32 v15, v15, v27
  v_exp_f32 v12, v12
  v_exp_f32 v13, v13
  v_exp_f32 v14, v14
  v_exp_f32 v15, v15
  v_mul_f32 v24, v24, v40
  v_mul_f32 v25, v25, v41
  v_mul_f32 v26, v26, v42
  v_mul_f32 v27, v27, v43
  v_add_f32 v12, 1.0, v12
  v_add_f32 v13, 1.0, v13
  v_add_f32 v14, 1.0, v14
  v_add_f32 v15, 1.0, v15
  v_rcp_f32 v12, v12
  v_rcp_f32 v13, v13
  v_rcp_f32 v14, v14
  v_rcp_f32 v15, v15
  v_mul_f32 v24, v24, v12
  v_mul_f32 v25, v25, v13
  v_mul_f32 v26, v26, v14
  v_mul_f32 v27, v27, v15
  v_cvt_pk_bf16_f32 v36, v24, v25
  v_cvt_pk_bf16_f32 v37, v26, v27
  buffer_store_dwordx2 v[36:37], v1, s[20:23], s38 offen offset:1024 sc1
  v_mul_f32 v12, v28, v28
  v_mul_f32 v13, v29, v29
  v_mul_f32 v14, v30, v30
  v_mul_f32 v15, v31, v31
  v_fmaak_f32 v12, v12, v6, 0xc0135761
  v_fmaak_f32 v13, v13, v6, 0xc0135761
  v_fmaak_f32 v14, v14, v6, 0xc0135761
  v_fmaak_f32 v15, v15, v6, 0xc0135761
  v_mul_f32 v12, v12, v28
  v_mul_f32 v13, v13, v29
  v_mul_f32 v14, v14, v30
  v_mul_f32 v15, v15, v31
  v_exp_f32 v12, v12
  v_exp_f32 v13, v13
  v_exp_f32 v14, v14
  v_exp_f32 v15, v15
  v_mul_f32 v28, v28, v44
  v_mul_f32 v29, v29, v45
  v_mul_f32 v30, v30, v46
  v_mul_f32 v31, v31, v47
  v_add_f32 v12, 1.0, v12
  v_add_f32 v13, 1.0, v13
  v_add_f32 v14, 1.0, v14
  v_add_f32 v15, 1.0, v15
  v_rcp_f32 v12, v12
  v_rcp_f32 v13, v13
  v_rcp_f32 v14, v14
  v_rcp_f32 v15, v15
  v_mul_f32 v28, v28, v12
  v_mul_f32 v29, v29, v13
  v_mul_f32 v30, v30, v14
  v_mul_f32 v31, v31, v15
  v_cvt_pk_bf16_f32 v38, v28, v29
  v_cvt_pk_bf16_f32 v39, v30, v31
  buffer_store_dwordx2 v[38:39], v1, s[20:23], s38 offen offset:1280 sc1
  s_add_u32 s38, s38, 2048
L_k1_fin:
  s_waitcnt lgkmcnt(0)
L_k1_end:
  s_endpgm

.section .rodata,"a"
.p2align 6
.amdhsa_kernel gemm1_kernel
  .amdhsa_next_free_vgpr 256
  .amdhsa_next_free_sgpr 100
  .amdhsa_accum_offset 112
  .amdhsa_group_segment_fixed_size 0
  .amdhsa_kernarg_size 80
  .amdhsa_user_sgpr_count 2
  .amdhsa_user_sgpr_kernarg_segment_ptr 1
  .amdhsa_system_sgpr_workgroup_id_x 1
.end_amdhsa_kernel

.text
.globl mix_kernel
.p2align 8
.type mix_kernel,@function
mix_kernel:
  s_cmp_ge_u32 s2, 768
  s_cbranch_scc1 L_mix_end
  s_cmp_ge_u32 s2, 512
  s_cbranch_scc1 L_mix_third
  s_cmp_ge_u32 s2, 256
  s_cbranch_scc1 L_mix_second
  s_setprio 1
  s_load_dwordx2 s[4:5], s[0:1], 72
  v_readfirstlane_b32 s24, v0
  v_and_b32 v0, 63, v0
  s_lshr_b32 s24, s24, 6
  s_and_b32 s25, s2, 7
  s_lshr_b32 s32, s2, 3
  s_and_b32 s32, s32, 3
  s_lshl_b32 s32, s32, 3
  s_add_u32 s25, s25, s32
  s_lshr_b32 s26, s2, 5
  s_and_b32 s26, s26, 7
  s_lshl_b32 s35, s26, 3
  s_lshl_b32 s32, s24, 1
  s_add_u32 s35, s35, s32
  v_lshlrev_b32 v1, 3, v0
  v_lshlrev_b32 v2, 4, v0
  v_mov_b32 v8, 0xdddddddd
  s_lshl_b32 s32, s24, 10
  v_add_u32 v9, s32, v2
  v_mul_u32_u24 v10, 43691, v9
  v_lshrrev_b32 v10, 26, v10
  v_mul_u32_u24 v10, 35328, v10
  v_add_u32 v5, v9, v10
  s_add_u32 s33, s24, 4
  s_cmp_lt_u32 s24, 2
  s_cselect_b32 s37, s33, s24
  s_lshl_b32 s32, s37, 10
  v_add_u32 v9, s32, v2
  v_mul_u32_u24 v10, 43691, v9
  v_lshrrev_b32 v10, 26, v10
  v_mul_u32_u24 v10, 35328, v10
  v_add_u32 v6, v9, v10
  s_lshl_b32 s37, s37, 10
  s_mul_i32 s36, s25, 18
  v_and_b32 v9, 31, v0
  v_min_u32 v9, 17, v9
  v_add_u32 v9, s36, v9
  v_lshrrev_b32 v10, 5, v9
  v_lshlrev_b32 v10, 11, v10
  v_and_b32 v9, 31, v9
  v_and_b32 v11, 32, v0
  v_add_u32 v9, v9, v11
  v_lshl_add_u32 v9, v9, 4, v10
  s_mul_i32 s32, s24, 36864
  v_add_u32 v7, s32, v9
  s_and_b32 s32, s36, 7
  v_lshrrev_b32 v9, 5, v0
  v_lshlrev_b32 v9, 2, v9
  v_subrev_u32 v12, s32, v9
  s_mov_b32 s40, 0x3ffff
  s_mov_b32 s41, 0x3ffff
  s_waitcnt lgkmcnt(0)
  s_add_u32 s8, s4, 4718592
  s_addc_u32 s9, s5, 0
  s_mov_b32 s10, 2359296
  s_mov_b32 s11, 0x20000
  s_add_u32 s12, s4, 7077888
  s_addc_u32 s13, s5, 0
  s_mov_b32 s14, 2359296
  s_mov_b32 s15, 0x20000
  s_add_u32 s16, s4, 2359296
  s_addc_u32 s17, s5, 0
  s_mov_b32 s18, 2359296
  s_mov_b32 s19, 0x20000
  s_add_u32 s20, s4, 9437184
  s_addc_u32 s21, s5, 0
  s_mov_b32 s22, 2359296
  s_mov_b32 s23, 0x20000
  s_mul_i32 s32, s25, 9
  s_lshr_b32 s32, s32, 2
  s_lshl_b32 s32, s32, 9
  s_mul_i32 s33, s35, 36864
  s_add_u32 s32, s32, s33
  buffer_load_dwordx2 v[80:81], v1, s[16:19], s32 offen
  buffer_load_dwordx2 v[82:83], v1, s[16:19], s32 offen offset:512
  buffer_load_dwordx2 v[84:85], v1, s[16:19], s32 offen offset:1024
  s_add_u32 s32, s32, 36864
  buffer_load_dwordx2 v[88:89], v1, s[16:19], s32 offen
  buffer_load_dwordx2 v[90:91], v1, s[16:19], s32 offen offset:512
  buffer_load_dwordx2 v[92:93], v1, s[16:19], s32 offen offset:1024
  s_add_u32 s32, s32, 36864
  s_lshl_b32 s33, s24, 10
  s_lshl_b32 s36, s24, 11
  s_add_u32 s36, s36, 6144
  s_mul_i32 s30, s25, 9
  s_lshr_b32 s30, s30, 2
  s_lshl_b32 s30, s30, 9
  s_sub_u32 s27, 0, s30
  s_add_u32 m0, s33, 0
  s_add_u32 s31, s30, s27
  buffer_load_dwordx4 v5, s[8:11], s30 offen lds
  s_add_u32 m0, s37, 0
  s_nop 0
  buffer_load_dwordx4 v6, s[8:11], s30 offen lds
  s_add_u32 m0, s36, 0
  s_mov_b64 exec, s[40:41]
  buffer_load_dwordx4 v7, s[12:15], s31 offen lds
  buffer_load_dwordx4 v7, s[12:15], s31 offen offset:1024 lds
  s_mov_b64 exec, -1
  s_add_u32 s30, s30, 147456
  s_add_u32 m0, s33, 14336
  s_add_u32 s31, s30, s27
  buffer_load_dwordx4 v5, s[8:11], s30 offen lds
  s_add_u32 m0, s37, 14336
  s_nop 0
  buffer_load_dwordx4 v6, s[8:11], s30 offen lds
  s_add_u32 m0, s36, 14336
  s_mov_b64 exec, s[40:41]
  buffer_load_dwordx4 v7, s[12:15], s31 offen lds
  buffer_load_dwordx4 v7, s[12:15], s31 offen offset:1024 lds
  s_mov_b64 exec, -1
  s_add_u32 s30, s30, 147456
  s_add_u32 m0, s33, 28672
  s_add_u32 s31, s30, s27
  buffer_load_dwordx4 v5, s[8:11], s30 offen lds
  s_add_u32 m0, s37, 28672
  s_nop 0
  buffer_load_dwordx4 v6, s[8:11], s30 offen lds
  s_add_u32 m0, s36, 28672
  s_mov_b64 exec, s[40:41]
  buffer_load_dwordx4 v7, s[12:15], s31 offen lds
  buffer_load_dwordx4 v7, s[12:15], s31 offen offset:1024 lds
  s_mov_b64 exec, -1
  s_add_u32 s30, s30, 147456
  s_mov_b32 s29, 4
  v_and_b32 v9, 31, v0
  v_cmp_eq_u32 vcc, 18, v9
  v_mov_b32 v10, 0x3f803f80
  s_nop 0
  v_cndmask_b32 v16, 0, v10, vcc
  v_mov_b32 v17, v16
  v_mov_b32 v18, v16
  v_mov_b32 v19, v16
  s_mul_i32 s32, s24, 2048
  v_add_u32 v9, s32, v2
  s_not_b64 exec, s[40:41]
  ds_write_b128 v9, v[16:19] offset:6144
  ds_write_b128 v9, v[16:19] offset:7168
  ds_write_b128 v9, v[16:19] offset:20480
  ds_write_b128 v9, v[16:19] offset:21504
  ds_write_b128 v9, v[16:19] offset:34816
  ds_write_b128 v9, v[16:19] offset:35840
  ds_write_b128 v9, v[16:19] offset:49152
  ds_write_b128 v9, v[16:19] offset:50176
  s_mov_b64 exec, -1
  v_mov_b32 v20, 0
  v_mov_b32 v21, 57344
  ds_write_b32 v21, v20
  v_mov_b32 v102, 0
  v_mov_b32 v103, 0
  v_mov_b32 v110, 0
  v_mov_b32 v111, 0
  s_waitcnt vmcnt(12)
  v_add_u32 v9, 0, v12
  v_cmp_gt_u32 vcc, 18, v9
  s_nop 1
  v_cndmask_b32 v80, 0, v80, vcc
  v_add_u32 v9, 2, v12
  v_cmp_gt_u32 vcc, 18, v9
  s_nop 1
  v_cndmask_b32 v81, 0, v81, vcc
  v_add_u32 v9, 8, v12
  v_cmp_gt_u32 vcc, 18, v9
  s_nop 1
  v_cndmask_b32 v82, 0, v82, vcc
  v_add_u32 v9, 10, v12
  v_cmp_gt_u32 vcc, 18, v9
  s_nop 1
  v_cndmask_b32 v83, 0, v83, vcc
  v_add_u32 v9, 16, v12
  v_cmp_gt_u32 vcc, 18, v9
  s_nop 1
  v_cndmask_b32 v84, 0, v84, vcc
  v_add_u32 v9, 18, v12
  v_cmp_gt_u32 vcc, 18, v9
  s_nop 1
  v_cndmask_b32 v85, 0, v85, vcc
  v_mov_b32 v86, 0
  v_mov_b32 v87, 0
  v_add_u32 v9, 0, v12
  v_cmp_gt_u32 vcc, 18, v9
  s_nop 1
  v_cndmask_b32 v88, 0, v88, vcc
  v_add_u32 v9, 2, v12
  v_cmp_gt_u32 vcc, 18, v9
  s_nop 1
  v_cndmask_b32 v89, 0, v89, vcc
  v_add_u32 v9, 8, v12
  v_cmp_gt_u32 vcc, 18, v9
  s_nop 1
  v_cndmask_b32 v90, 0, v90, vcc
  v_add_u32 v9, 10, v12
  v_cmp_gt_u32 vcc, 18, v9
  s_nop 1
  v_cndmask_b32 v91, 0, v91, vcc
  v_add_u32 v9, 16, v12
  v_cmp_gt_u32 vcc, 18, v9
  s_nop 1
  v_cndmask_b32 v92, 0, v92, vcc
  v_add_u32 v9, 18, v12
  v_cmp_gt_u32 vcc, 18, v9
  s_nop 1
  v_cndmask_b32 v93, 0, v93, vcc
  v_mov_b32 v94, 0
  v_mov_b32 v95, 0
  s_waitcnt lgkmcnt(0)
  s_mov_b32 s34, 0
  v_mov_b32 v48, 0
  v_mov_b32 v64, 0
  v_mov_b32 v32, 0
  v_mov_b32 v49, 0
  v_mov_b32 v65, 0
  v_mov_b32 v33, 0
  v_mov_b32 v50, 0
  v_mov_b32 v66, 0
  v_mov_b32 v34, 0
  v_mov_b32 v51, 0
  v_mov_b32 v67, 0
  v_mov_b32 v35, 0
  v_mov_b32 v52, 0
  v_mov_b32 v68, 0
  v_mov_b32 v36, 0
  v_mov_b32 v53, 0
  v_mov_b32 v69, 0
  v_mov_b32 v37, 0
  v_mov_b32 v54, 0
  v_mov_b32 v70, 0
  v_mov_b32 v38, 0
  v_mov_b32 v55, 0
  v_mov_b32 v71, 0
  v_mov_b32 v39, 0
  v_mov_b32 v56, 0
  v_mov_b32 v72, 0
  v_mov_b32 v40, 0
  v_mov_b32 v57, 0
  v_mov_b32 v73, 0
  v_mov_b32 v41, 0
  v_mov_b32 v58, 0
  v_mov_b32 v74, 0
  v_mov_b32 v42, 0
  v_mov_b32 v59, 0
  v_mov_b32 v75, 0
  v_mov_b32 v43, 0
  v_mov_b32 v60, 0
  v_mov_b32 v76, 0
  v_mov_b32 v44, 0
  v_mov_b32 v61, 0
  v_mov_b32 v77, 0
  v_mov_b32 v45, 0
  v_mov_b32 v62, 0
  v_mov_b32 v78, 0
  v_mov_b32 v46, 0
  v_mov_b32 v63, 0
  v_mov_b32 v79, 0
  v_mov_b32 v47, 0
  v_mov_b32 v120, 0
  v_mov_b32 v121, 0
  v_mov_b32 v122, 0
  v_mov_b32 v123, 0
  v_mov_b32 v124, 0
  v_mov_b32 v125, 0
  v_mov_b32 v126, 0
  v_mov_b32 v127, 0
  s_waitcnt vmcnt(8)
  s_barrier
  ds_read2st64_b64 v[96:99], v1 offset0:0 offset1:1
  ds_read_b64 v[100:101], v1 offset:1024
  s_waitcnt lgkmcnt(0)
  v_mfma_f32_32x32x16_bf16 v[16:31], v[96:99], v[80:83], 0
  v_mfma_f32_32x32x8bf16_1k v[16:31], v[100:101], v[84:85], v[16:31]
  s_nop 7
  s_nop 3
L_at_loop:
  s_waitcnt vmcnt(4)
  s_barrier
  v_smfmac_f32_32x32x32_bf16 v[64:79], v[120:123], v[32:39], v8
  ds_read_b128 v[112:115], v2 offset:6144
  ds_read_b128 v[116:119], v2 offset:7168
  ds_read2st64_b64 v[104:107], v1 offset0:3 offset1:4
  ds_read_b64 v[108:109], v1 offset:2560
  v_exp_f32 v16, v16
  v_exp_f32 v17, v17
  v_exp_f32 v18, v18
  v_smfmac_f32_32x32x32_bf16 v[64:79], v[124:127], v[40:47], v8
  s_add_u32 m0, s33, 43008
  s_add_u32 s31, s30, s27
  buffer_load_dwordx4 v5, s[8:11], s30 offen lds
  v_exp_f32 v19, v19
  v_exp_f32 v20, v20
  v_exp_f32 v21, v21
  v_mfma_f32_32x32x16_bf16 v[32:47], v[96:99], v[88:91], 0
  v_exp_f32 v22, v22
  v_exp_f32 v23, v23
  v_exp_f32 v24, v24
  v_mfma_f32_32x32x8bf16_1k v[32:47], v[100:101], v[92:93], v[32:47]
  v_exp_f32 v25, v25
  v_exp_f32 v26, v26
  v_exp_f32 v27, v27
  v_exp_f32 v28, v28
  v_exp_f32 v29, v29
  v_exp_f32 v30, v30
  v_exp_f32 v31, v31
  s_waitcnt lgkmcnt(0)
  v_smfmac_f32_32x32x32_bf16 v[48:63], v[112:115], v[16:23], v8
  v_exp_f32 v32, v32
  v_exp_f32 v33, v33
  v_exp_f32 v34, v34
  v_smfmac_f32_32x32x32_bf16 v[48:63], v[116:119], v[24:31], v8
  v_exp_f32 v35, v35
  v_exp_f32 v36, v36
  v_exp_f32 v37, v37
  v_mfma_f32_32x32x16_bf16 v[16:31], v[104:107], v[80:83], 0
  v_exp_f32 v38, v38
  v_exp_f32 v39, v39
  v_exp_f32 v40, v40
  v_mfma_f32_32x32x8bf16_1k v[16:31], v[108:109], v[84:85], v[16:31]
  v_exp_f32 v41, v41
  v_exp_f32 v42, v42
  v_exp_f32 v43, v43
  v_exp_f32 v44, v44
  v_exp_f32 v45, v45
  v_exp_f32 v46, v46
  v_exp_f32 v47, v47
  v_smfmac_f32_32x32x32_bf16 v[64:79], v[112:115], v[32:39], v8
  ds_read_b128 v[120:123], v2 offset:8192
  ds_read_b128 v[124:127], v2 offset:9216
  ds_read2st64_b64 v[96:99], v1 offset0:6 offset1:7
  ds_read_b64 v[100:101], v1 offset:4096
  v_exp_f32 v16, v16
  v_exp_f32 v17, v17
  v_exp_f32 v18, v18
  v_smfmac_f32_32x32x32_bf16 v[64:79], v[116:119], v[40:47], v8
  s_add_u32 m0, s37, 43008
  s_nop 0
  buffer_load_dwordx4 v6, s[8:11], s30 offen lds
  v_exp_f32 v19, v19
  v_exp_f32 v20, v20
  v_exp_f32 v21, v21
  v_mfma_f32_32x32x16_bf16 v[32:47], v[104:107], v[88:91], 0
  v_exp_f32 v22, v22
  v_exp_f32 v23, v23
  v_exp_f32 v24, v24
  v_mfma_f32_32x32x8bf16_1k v[32:47], v[108:109], v[92:93], v[32:47]
  v_exp_f32 v25, v25
  v_exp_f32 v26, v26
  v_exp_f32 v27, v27
  v_exp_f32 v28, v28
  v_exp_f32 v29, v29
  v_exp_f32 v30, v30
  v_exp_f32 v31, v31
  s_waitcnt lgkmcnt(0)
  v_smfmac_f32_32x32x32_bf16 v[48:63], v[120:123], v[16:23], v8
  v_exp_f32 v32, v32
  v_exp_f32 v33, v33
  v_exp_f32 v34, v34
  v_smfmac_f32_32x32x32_bf16 v[48:63], v[124:127], v[24:31], v8
  v_exp_f32 v35, v35
  v_exp_f32 v36, v36
  v_exp_f32 v37, v37
  v_mfma_f32_32x32x16_bf16 v[16:31], v[96:99], v[80:83], 0
  v_exp_f32 v38, v38
  v_exp_f32 v39, v39
  v_exp_f32 v40, v40
  v_mfma_f32_32x32x8bf16_1k v[16:31], v[100:101], v[84:85], v[16:31]
  v_exp_f32 v41, v41
  v_exp_f32 v42, v42
  v_exp_f32 v43, v43
  v_exp_f32 v44, v44
  v_exp_f32 v45, v45
  v_exp_f32 v46, v46
  v_exp_f32 v47, v47
  v_smfmac_f32_32x32x32_bf16 v[64:79], v[120:123], v[32:39], v8
  ds_read_b128 v[112:115], v2 offset:10240
  ds_read_b128 v[116:119], v2 offset:11264
  ds_read2st64_b64 v[104:107], v1 offset0:9 offset1:10
  ds_read_b64 v[108:109], v1 offset:5632
  v_exp_f32 v16, v16
  v_exp_f32 v17, v17
  v_exp_f32 v18, v18
  v_smfmac_f32_32x32x32_bf16 v[64:79], v[124:127], v[40:47], v8
  s_add_u32 m0, s36, 43008
  s_mov_b64 exec, s[40:41]
  buffer_load_dwordx4 v7, s[12:15], s31 offen lds
  buffer_load_dwordx4 v7, s[12:15], s31 offen offset:1024 lds
  s_mov_b64 exec, -1
  s_add_u32 s30, s30, 147456
  v_exp_f32 v19, v19
  v_exp_f32 v20, v20
  v_exp_f32 v21, v21
  v_mfma_f32_32x32x16_bf16 v[32:47], v[96:99], v[88:91], 0
  v_exp_f32 v22, v22
  v_exp_f32 v23, v23
  v_exp_f32 v24, v24
  v_mfma_f32_32x32x8bf16_1k v[32:47], v[100:101], v[92:93], v[32:47]
  v_exp_f32 v25, v25
  v_exp_f32 v26, v26
  v_exp_f32 v27, v27
  v_exp_f32 v28, v28
  v_exp_f32 v29, v29
  v_exp_f32 v30, v30
  v_exp_f32 v31, v31
  s_waitcnt lgkmcnt(0)
  v_smfmac_f32_32x32x32_bf16 v[48:63], v[112:115], v[16:23], v8
  v_exp_f32 v32, v32
  v_exp_f32 v33, v33
  v_exp_f32 v34, v34
  v_smfmac_f32_32x32x32_bf16 v[48:63], v[116:119], v[24:31], v8
  v_exp_f32 v35, v35
  v_exp_f32 v36, v36
  v_exp_f32 v37, v37
  v_mfma_f32_32x32x16_bf16 v[16:31], v[104:107], v[80:83], 0
  v_exp_f32 v38, v38
  v_exp_f32 v39, v39
  v_exp_f32 v40, v40
  v_mfma_f32_32x32x8bf16_1k v[16:31], v[108:109], v[84:85], v[16:31]
  v_exp_f32 v41, v41
  v_exp_f32 v42, v42
  v_exp_f32 v43, v43
  v_exp_f32 v44, v44
  v_exp_f32 v45, v45
  v_exp_f32 v46, v46
  v_exp_f32 v47, v47
  v_smfmac_f32_32x32x32_bf16 v[64:79], v[112:115], v[32:39], v8
  ds_read_b128 v[120:123], v2 offset:12288
  ds_read_b128 v[124:127], v2 offset:13312
  ds_read2st64_b64 v[96:99], v1 offset0:28 offset1:29
  ds_read_b64 v[100:101], v1 offset:15360
  v_exp_f32 v16, v16
  v_exp_f32 v17, v17
  v_exp_f32 v18, v18
  v_smfmac_f32_32x32x32_bf16 v[64:79], v[116:119], v[40:47], v8
  v_exp_f32 v19, v19
  v_exp_f32 v20, v20
  v_exp_f32 v21, v21
  v_mfma_f32_32x32x16_bf16 v[32:47], v[104:107], v[88:91], 0
  v_exp_f32 v22, v22
  v_exp_f32 v23, v23
  v_exp_f32 v24, v24
  v_mfma_f32_32x32x8bf16_1k v[32:47], v[108:109], v[92:93], v[32:47]
  v_exp_f32 v25, v25
  v_exp_f32 v26, v26
  v_exp_f32 v27, v27
  v_exp_f32 v28, v28
  v_exp_f32 v29, v29
  v_exp_f32 v30, v30
  v_exp_f32 v31, v31
  s_waitcnt lgkmcnt(0)
  v_smfmac_f32_32x32x32_bf16 v[48:63], v[120:123], v[16:23], v8
  v_exp_f32 v32, v32
  v_exp_f32 v33, v33
  v_exp_f32 v34, v34
  v_smfmac_f32_32x32x32_bf16 v[48:63], v[124:127], v[24:31], v8
  v_exp_f32 v35, v35
  v_exp_f32 v36, v36
  v_exp_f32 v37, v37
  v_mfma_f32_32x32x16_bf16 v[16:31], v[96:99], v[80:83], 0
  v_exp_f32 v38, v38
  v_exp_f32 v39, v39
  v_exp_f32 v40, v40
  v_mfma_f32_32x32x8bf16_1k v[16:31], v[100:101], v[84:85], v[16:31]
  v_exp_f32 v41, v41
  v_exp_f32 v42, v42
  v_exp_f32 v43, v43
  v_exp_f32 v44, v44
  v_exp_f32 v45, v45
  v_exp_f32 v46, v46
  v_exp_f32 v47, v47
  s_waitcnt vmcnt(4)
  s_barrier
  v_smfmac_f32_32x32x32_bf16 v[64:79], v[120:123], v[32:39], v8
  ds_read_b128 v[112:115], v2 offset:20480
  ds_read_b128 v[116:119], v2 offset:21504
  ds_read2st64_b64 v[104:107], v1 offset0:31 offset1:32
  ds_read_b64 v[108:109], v1 offset:16896
  v_exp_f32 v16, v16
  v_exp_f32 v17, v17
  v_exp_f32 v18, v18
  v_smfmac_f32_32x32x32_bf16 v[64:79], v[124:127], v[40:47], v8
  s_add_u32 m0, s33, 0
  s_add_u32 s31, s30, s27
  buffer_load_dwordx4 v5, s[8:11], s30 offen lds
  v_exp_f32 v19, v19
  v_exp_f32 v20, v20
  v_exp_f32 v21, v21
  v_mfma_f32_32x32x16_bf16 v[32:47], v[96:99], v[88:91], 0
  v_exp_f32 v22, v22
  v_exp_f32 v23, v23
  v_exp_f32 v24, v24
  v_mfma_f32_32x32x8bf16_1k v[32:47], v[100:101], v[92:93], v[32:47]
  v_exp_f32 v25, v25
  v_exp_f32 v26, v26
  v_exp_f32 v27, v27
  v_exp_f32 v28, v28
  v_exp_f32 v29, v29
  v_exp_f32 v30, v30
  v_exp_f32 v31, v31
  s_waitcnt lgkmcnt(0)
  v_smfmac_f32_32x32x32_bf16 v[48:63], v[112:115], v[16:23], v8
  v_exp_f32 v32, v32
  v_exp_f32 v33, v33
  v_exp_f32 v34, v34
  v_smfmac_f32_32x32x32_bf16 v[48:63], v[116:119], v[24:31], v8
  v_exp_f32 v35, v35
  v_exp_f32 v36, v36
  v_exp_f32 v37, v37
  v_mfma_f32_32x32x16_bf16 v[16:31], v[104:107], v[80:83], 0
  v_exp_f32 v38, v38
  v_exp_f32 v39, v39
  v_exp_f32 v40, v40
  v_mfma_f32_32x32x8bf16_1k v[16:31], v[108:109], v[84:85], v[16:31]
  v_exp_f32 v41, v41
  v_exp_f32 v42, v42
  v_exp_f32 v43, v43
  v_exp_f32 v44, v44
  v_exp_f32 v45, v45
  v_exp_f32 v46, v46
  v_exp_f32 v47, v47
  v_smfmac_f32_32x32x32_bf16 v[64:79], v[112:115], v[32:39], v8
  ds_read_b128 v[120:123], v2 offset:22528
  ds_read_b128 v[124:127], v2 offset:23552
  ds_read2st64_b64 v[96:99], v1 offset0:34 offset1:35
  ds_read_b64 v[100:101], v1 offset:18432
  v_exp_f32 v16, v16
  v_exp_f32 v17, v17
  v_exp_f32 v18, v18
  v_smfmac_f32_32x32x32_bf16 v[64:79], v[116:119], v[40:47], v8
  s_add_u32 m0, s37, 0
  s_nop 0
  buffer_load_dwordx4 v6, s[8:11], s30 offen lds
  v_exp_f32 v19, v19
  v_exp_f32 v20, v20
  v_exp_f32 v21, v21
  v_mfma_f32_32x32x16_bf16 v[32:47], v[104:107], v[88:91], 0
  v_exp_f32 v22, v22
  v_exp_f32 v23, v23
  v_exp_f32 v24, v24
  v_mfma_f32_32x32x8bf16_1k v[32:47], v[108:109], v[92:93], v[32:47]
  v_exp_f32 v25, v25
  v_exp_f32 v26, v26
  v_exp_f32 v27, v27
  v_exp_f32 v28, v28
  v_exp_f32 v29, v29
  v_exp_f32 v30, v30
  v_exp_f32 v31, v31
  s_waitcnt lgkmcnt(0)
  v_smfmac_f32_32x32x32_bf16 v[48:63], v[120:123], v[16:23], v8
  v_exp_f32 v32, v32
  v_exp_f32 v33, v33
  v_exp_f32 v34, v34
  v_smfmac_f32_32x32x32_bf16 v[48:63], v[124:127], v[24:31], v8
  v_exp_f32 v35, v35
  v_exp_f32 v36, v36
  v_exp_f32 v37, v37
  v_mfma_f32_32x32x16_bf16 v[16:31], v[96:99], v[80:83], 0
  v_exp_f32 v38, v38
  v_exp_f32 v39, v39
  v_exp_f32 v40, v40
  v_mfma_f32_32x32x8bf16_1k v[16:31], v[100:101], v[84:85], v[16:31]
  v_exp_f32 v41, v41
  v_exp_f32 v42, v42
  v_exp_f32 v43, v43
  v_exp_f32 v44, v44
  v_exp_f32 v45, v45
  v_exp_f32 v46, v46
  v_exp_f32 v47, v47
  v_smfmac_f32_32x32x32_bf16 v[64:79], v[120:123], v[32:39], v8
  ds_read_b128 v[112:115], v2 offset:24576
  ds_read_b128 v[116:119], v2 offset:25600
  ds_read2st64_b64 v[104:107], v1 offset0:37 offset1:38
  ds_read_b64 v[108:109], v1 offset:19968
  v_exp_f32 v16, v16
  v_exp_f32 v17, v17
  v_exp_f32 v18, v18
  v_smfmac_f32_32x32x32_bf16 v[64:79], v[124:127], v[40:47], v8
  s_add_u32 m0, s36, 0
  s_mov_b64 exec, s[40:41]
  buffer_load_dwordx4 v7, s[12:15], s31 offen lds
  buffer_load_dwordx4 v7, s[12:15], s31 offen offset:1024 lds
  s_mov_b64 exec, -1
  s_add_u32 s30, s30, 147456
  v_exp_f32 v19, v19
  v_exp_f32 v20, v20
  v_exp_f32 v21, v21
  v_mfma_f32_32x32x16_bf16 v[32:47], v[96:99], v[88:91], 0
  v_exp_f32 v22, v22
  v_exp_f32 v23, v23
  v_exp_f32 v24, v24
  v_mfma_f32_32x32x8bf16_1k v[32:47], v[100:101], v[92:93], v[32:47]
  v_exp_f32 v25, v25
  v_exp_f32 v26, v26
  v_exp_f32 v27, v27
  v_exp_f32 v28, v28
  v_exp_f32 v29, v29
  v_exp_f32 v30, v30
  v_exp_f32 v31, v31
  s_waitcnt lgkmcnt(0)
  v_smfmac_f32_32x32x32_bf16 v[48:63], v[112:115], v[16:23], v8
  v_exp_f32 v32, v32
  v_exp_f32 v33, v33
  v_exp_f32 v34, v34
  v_smfmac_f32_32x32x32_bf16 v[48:63], v[116:119], v[24:31], v8
  v_exp_f32 v35, v35
  v_exp_f32 v36, v36
  v_exp_f32 v37, v37
  v_mfma_f32_32x32x16_bf16 v[16:31], v[104:107], v[80:83], 0
  v_exp_f32 v38, v38
  v_exp_f32 v39, v39
  v_exp_f32 v40, v40
  v_mfma_f32_32x32x8bf16_1k v[16:31], v[108:109], v[84:85], v[16:31]
  v_exp_f32 v41, v41
  v_exp_f32 v42, v42
  v_exp_f32 v43, v43
  v_exp_f32 v44, v44
  v_exp_f32 v45, v45
  v_exp_f32 v46, v46
  v_exp_f32 v47, v47
  v_smfmac_f32_32x32x32_bf16 v[64:79], v[112:115], v[32:39], v8
  ds_read_b128 v[120:123], v2 offset:26624
  ds_read_b128 v[124:127], v2 offset:27648
  ds_read2st64_b64 v[96:99], v1 offset0:56 offset1:57
  ds_read_b64 v[100:101], v1 offset:29696
  v_exp_f32 v16, v16
  v_exp_f32 v17, v17
  v_exp_f32 v18, v18
  v_smfmac_f32_32x32x32_bf16 v[64:79], v[116:119], v[40:47], v8
  v_exp_f32 v19, v19
  v_exp_f32 v20, v20
  v_exp_f32 v21, v21
  v_mfma_f32_32x32x16_bf16 v[32:47], v[104:107], v[88:91], 0
  v_exp_f32 v22, v22
  v_exp_f32 v23, v23
  v_exp_f32 v24, v24
  v_mfma_f32_32x32x8bf16_1k v[32:47], v[108:109], v[92:93], v[32:47]
  v_exp_f32 v25, v25
  v_exp_f32 v26, v26
  v_exp_f32 v27, v27
  v_exp_f32 v28, v28
  v_exp_f32 v29, v29
  v_exp_f32 v30, v30
  v_exp_f32 v31, v31
  s_waitcnt lgkmcnt(0)
  v_smfmac_f32_32x32x32_bf16 v[48:63], v[120:123], v[16:23], v8
  v_exp_f32 v32, v32
  v_exp_f32 v33, v33
  v_exp_f32 v34, v34
  v_smfmac_f32_32x32x32_bf16 v[48:63], v[124:127], v[24:31], v8
  v_exp_f32 v35, v35
  v_exp_f32 v36, v36
  v_exp_f32 v37, v37
  v_mfma_f32_32x32x16_bf16 v[16:31], v[96:99], v[80:83], 0
  v_exp_f32 v38, v38
  v_exp_f32 v39, v39
  v_exp_f32 v40, v40
  v_mfma_f32_32x32x8bf16_1k v[16:31], v[100:101], v[84:85], v[16:31]
  v_exp_f32 v41, v41
  v_exp_f32 v42, v42
  v_exp_f32 v43, v43
  v_exp_f32 v44, v44
  v_exp_f32 v45, v45
  v_exp_f32 v46, v46
  v_exp_f32 v47, v47
  s_waitcnt vmcnt(4)
  s_barrier
  v_smfmac_f32_32x32x32_bf16 v[64:79], v[120:123], v[32:39], v8
  ds_read_b128 v[112:115], v2 offset:34816
  ds_read_b128 v[116:119], v2 offset:35840
  ds_read2st64_b64 v[104:107], v1 offset0:59 offset1:60
  ds_read_b64 v[108:109], v1 offset:31232
  v_exp_f32 v16, v16
  v_exp_f32 v17, v17
  v_exp_f32 v18, v18
  v_smfmac_f32_32x32x32_bf16 v[64:79], v[124:127], v[40:47], v8
  s_add_u32 m0, s33, 14336
  s_add_u32 s31, s30, s27
  buffer_load_dwordx4 v5, s[8:11], s30 offen lds
  v_exp_f32 v19, v19
  v_exp_f32 v20, v20
  v_exp_f32 v21, v21
  v_mfma_f32_32x32x16_bf16 v[32:47], v[96:99], v[88:91], 0
  v_exp_f32 v22, v22
  v_exp_f32 v23, v23
  v_exp_f32 v24, v24
  v_mfma_f32_32x32x8bf16_1k v[32:47], v[100:101], v[92:93], v[32:47]
  v_exp_f32 v25, v25
  v_exp_f32 v26, v26
  v_exp_f32 v27, v27
  v_exp_f32 v28, v28
  v_exp_f32 v29, v29
  v_exp_f32 v30, v30
  v_exp_f32 v31, v31
  s_waitcnt lgkmcnt(0)
  v_smfmac_f32_32x32x32_bf16 v[48:63], v[112:115], v[16:23], v8
  v_exp_f32 v32, v32
  v_exp_f32 v33, v33
  v_exp_f32 v34, v34
  v_smfmac_f32_32x32x32_bf16 v[48:63], v[116:119], v[24:31], v8
  v_exp_f32 v35, v35
  v_exp_f32 v36, v36
  v_exp_f32 v37, v37
  v_mfma_f32_32x32x16_bf16 v[16:31], v[104:107], v[80:83], 0
  v_exp_f32 v38, v38
  v_exp_f32 v39, v39
  v_exp_f32 v40, v40
  v_mfma_f32_32x32x8bf16_1k v[16:31], v[108:109], v[84:85], v[16:31]
  v_exp_f32 v41, v41
  v_exp_f32 v42, v42
  v_exp_f32 v43, v43
  v_exp_f32 v44, v44
  v_exp_f32 v45, v45
  v_exp_f32 v46, v46
  v_exp_f32 v47, v47
  v_smfmac_f32_32x32x32_bf16 v[64:79], v[112:115], v[32:39], v8
  ds_read_b128 v[120:123], v2 offset:36864
  ds_read_b128 v[124:127], v2 offset:37888
  ds_read2st64_b64 v[96:99], v1 offset0:62 offset1:63
  ds_read_b64 v[100:101], v1 offset:32768
  v_exp_f32 v16, v16
  v_exp_f32 v17, v17
  v_exp_f32 v18, v18
  v_smfmac_f32_32x32x32_bf16 v[64:79], v[116:119], v[40:47], v8
  s_add_u32 m0, s37, 14336
  s_nop 0
  buffer_load_dwordx4 v6, s[8:11], s30 offen lds
  v_exp_f32 v19, v19
  v_exp_f32 v20, v20
  v_exp_f32 v21, v21
  v_mfma_f32_32x32x16_bf16 v[32:47], v[104:107], v[88:91], 0
  v_exp_f32 v22, v22
  v_exp_f32 v23, v23
  v_exp_f32 v24, v24
  v_mfma_f32_32x32x8bf16_1k v[32:47], v[108:109], v[92:93], v[32:47]
  v_exp_f32 v25, v25
  v_exp_f32 v26, v26
  v_exp_f32 v27, v27
  v_exp_f32 v28, v28
  v_exp_f32 v29, v29
  v_exp_f32 v30, v30
  v_exp_f32 v31, v31
  s_waitcnt lgkmcnt(0)
  v_smfmac_f32_32x32x32_bf16 v[48:63], v[120:123], v[16:23], v8
  v_exp_f32 v32, v32
  v_exp_f32 v33, v33
  v_exp_f32 v34, v34
  v_smfmac_f32_32x32x32_bf16 v[48:63], v[124:127], v[24:31], v8
  v_exp_f32 v35, v35
  v_exp_f32 v36, v36
  v_exp_f32 v37, v37
  v_mfma_f32_32x32x16_bf16 v[16:31], v[96:99], v[80:83], 0
  v_exp_f32 v38, v38
  v_exp_f32 v39, v39
  v_exp_f32 v40, v40
  v_mfma_f32_32x32x8bf16_1k v[16:31], v[100:101], v[84:85], v[16:31]
  v_exp_f32 v41, v41
  v_exp_f32 v42, v42
  v_exp_f32 v43, v43
  v_exp_f32 v44, v44
  v_exp_f32 v45, v45
  v_exp_f32 v46, v46
  v_exp_f32 v47, v47
  v_smfmac_f32_32x32x32_bf16 v[64:79], v[120:123], v[32:39], v8
  ds_read_b128 v[112:115], v2 offset:38912
  ds_read_b128 v[116:119], v2 offset:39936
  ds_read2st64_b64 v[104:107], v1 offset0:65 offset1:66
  ds_read_b64 v[108:109], v1 offset:34304
  v_exp_f32 v16, v16
  v_exp_f32 v17, v17
  v_exp_f32 v18, v18
  v_smfmac_f32_32x32x32_bf16 v[64:79], v[124:127], v[40:47], v8
  s_add_u32 m0, s36, 14336
  s_mov_b64 exec, s[40:41]
  buffer_load_dwordx4 v7, s[12:15], s31 offen lds
  buffer_load_dwordx4 v7, s[12:15], s31 offen offset:1024 lds
  s_mov_b64 exec, -1
  s_add_u32 s30, s30, 147456
  v_exp_f32 v19, v19
  v_exp_f32 v20, v20
  v_exp_f32 v21, v21
  v_mfma_f32_32x32x16_bf16 v[32:47], v[96:99], v[88:91], 0
  v_exp_f32 v22, v22
  v_exp_f32 v23, v23
  v_exp_f32 v24, v24
  v_mfma_f32_32x32x8bf16_1k v[32:47], v[100:101], v[92:93], v[32:47]
  v_exp_f32 v25, v25
  v_exp_f32 v26, v26
  v_exp_f32 v27, v27
  v_exp_f32 v28, v28
  v_exp_f32 v29, v29
  v_exp_f32 v30, v30
  v_exp_f32 v31, v31
  s_waitcnt lgkmcnt(0)
  v_smfmac_f32_32x32x32_bf16 v[48:63], v[112:115], v[16:23], v8
  v_exp_f32 v32, v32
  v_exp_f32 v33, v33
  v_exp_f32 v34, v34
  v_smfmac_f32_32x32x32_bf16 v[48:63], v[116:119], v[24:31], v8
  v_exp_f32 v35, v35
  v_exp_f32 v36, v36
  v_exp_f32 v37, v37
  v_mfma_f32_32x32x16_bf16 v[16:31], v[104:107], v[80:83], 0
  v_exp_f32 v38, v38
  v_exp_f32 v39, v39
  v_exp_f32 v40, v40
  v_mfma_f32_32x32x8bf16_1k v[16:31], v[108:109], v[84:85], v[16:31]
  v_exp_f32 v41, v41
  v_exp_f32 v42, v42
  v_exp_f32 v43, v43
  v_exp_f32 v44, v44
  v_exp_f32 v45, v45
  v_exp_f32 v46, v46
  v_exp_f32 v47, v47
  v_smfmac_f32_32x32x32_bf16 v[64:79], v[112:115], v[32:39], v8
  ds_read_b128 v[120:123], v2 offset:40960
  ds_read_b128 v[124:127], v2 offset:41984
  ds_read2st64_b64 v[96:99], v1 offset0:84 offset1:85
  ds_read_b64 v[100:101], v1 offset:44032
  v_exp_f32 v16, v16
  v_exp_f32 v17, v17
  v_exp_f32 v18, v18
  v_smfmac_f32_32x32x32_bf16 v[64:79], v[116:119], v[40:47], v8
  v_exp_f32 v19, v19
  v_exp_f32 v20, v20
  v_exp_f32 v21, v21
  v_mfma_f32_32x32x16_bf16 v[32:47], v[104:107], v[88:91], 0
  v_exp_f32 v22, v22
  v_exp_f32 v23, v23
  v_exp_f32 v24, v24
  v_mfma_f32_32x32x8bf16_1k v[32:47], v[108:109], v[92:93], v[32:47]
  v_exp_f32 v25, v25
  v_exp_f32 v26, v26
  v_exp_f32 v27, v27
  v_exp_f32 v28, v28
  v_exp_f32 v29, v29
  v_exp_f32 v30, v30
  v_exp_f32 v31, v31
  s_waitcnt lgkmcnt(0)
  v_smfmac_f32_32x32x32_bf16 v[48:63], v[120:123], v[16:23], v8
  v_exp_f32 v32, v32
  v_exp_f32 v33, v33
  v_exp_f32 v34, v34
  v_smfmac_f32_32x32x32_bf16 v[48:63], v[124:127], v[24:31], v8
  v_exp_f32 v35, v35
  v_exp_f32 v36, v36
  v_exp_f32 v37, v37
  v_mfma_f32_32x32x16_bf16 v[16:31], v[96:99], v[80:83], 0
  v_exp_f32 v38, v38
  v_exp_f32 v39, v39
  v_exp_f32 v40, v40
  v_mfma_f32_32x32x8bf16_1k v[16:31], v[100:101], v[84:85], v[16:31]
  v_exp_f32 v41, v41
  v_exp_f32 v42, v42
  v_exp_f32 v43, v43
  v_exp_f32 v44, v44
  v_exp_f32 v45, v45
  v_exp_f32 v46, v46
  v_exp_f32 v47, v47
  s_waitcnt vmcnt(4)
  s_barrier
  v_smfmac_f32_32x32x32_bf16 v[64:79], v[120:123], v[32:39], v8
  ds_read_b128 v[112:115], v2 offset:49152
  ds_read_b128 v[116:119], v2 offset:50176
  ds_read2st64_b64 v[104:107], v1 offset0:87 offset1:88
  ds_read_b64 v[108:109], v1 offset:45568
  v_exp_f32 v16, v16
  v_exp_f32 v17, v17
  v_exp_f32 v18, v18
  v_smfmac_f32_32x32x32_bf16 v[64:79], v[124:127], v[40:47], v8
  s_add_u32 m0, s33, 28672
  s_add_u32 s31, s30, s27
  buffer_load_dwordx4 v5, s[8:11], s30 offen lds
  v_exp_f32 v19, v19
  v_exp_f32 v20, v20
  v_exp_f32 v21, v21
  v_mfma_f32_32x32x16_bf16 v[32:47], v[96:99], v[88:91], 0
  v_exp_f32 v22, v22
  v_exp_f32 v23, v23
  v_exp_f32 v24, v24
  v_mfma_f32_32x32x8bf16_1k v[32:47], v[100:101], v[92:93], v[32:47]
  v_exp_f32 v25, v25
  v_exp_f32 v26, v26
  v_exp_f32 v27, v27
  v_exp_f32 v28, v28
  v_exp_f32 v29, v29
  v_exp_f32 v30, v30
  v_exp_f32 v31, v31
  s_waitcnt lgkmcnt(0)
  v_smfmac_f32_32x32x32_bf16 v[48:63], v[112:115], v[16:23], v8
  v_exp_f32 v32, v32
  v_exp_f32 v33, v33
  v_exp_f32 v34, v34
  v_smfmac_f32_32x32x32_bf16 v[48:63], v[116:119], v[24:31], v8
  v_exp_f32 v35, v35
  v_exp_f32 v36, v36
  v_exp_f32 v37, v37
  v_mfma_f32_32x32x16_bf16 v[16:31], v[104:107], v[80:83], 0
  v_exp_f32 v38, v38
  v_exp_f32 v39, v39
  v_exp_f32 v40, v40
  v_mfma_f32_32x32x8bf16_1k v[16:31], v[108:109], v[84:85], v[16:31]
  v_exp_f32 v41, v41
  v_exp_f32 v42, v42
  v_exp_f32 v43, v43
  v_exp_f32 v44, v44
  v_exp_f32 v45, v45
  v_exp_f32 v46, v46
  v_exp_f32 v47, v47
  v_smfmac_f32_32x32x32_bf16 v[64:79], v[112:115], v[32:39], v8
  ds_read_b128 v[120:123], v2 offset:51200
  ds_read_b128 v[124:127], v2 offset:52224
  ds_read2st64_b64 v[96:99], v1 offset0:90 offset1:91
  ds_read_b64 v[100:101], v1 offset:47104
  v_exp_f32 v16, v16
  v_exp_f32 v17, v17
  v_exp_f32 v18, v18
  v_smfmac_f32_32x32x32_bf16 v[64:79], v[116:119], v[40:47], v8
  s_add_u32 m0, s37, 28672
  s_nop 0
  buffer_load_dwordx4 v6, s[8:11], s30 offen lds
  v_exp_f32 v19, v19
  v_exp_f32 v20, v20
  v_exp_f32 v21, v21
  v_mfma_f32_32x32x16_bf16 v[32:47], v[104:107], v[88:91], 0
  v_exp_f32 v22, v22
  v_exp_f32 v23, v23
  v_exp_f32 v24, v24
  v_mfma_f32_32x32x8bf16_1k v[32:47], v[108:109], v[92:93], v[32:47]
  v_exp_f32 v25, v25
  v_exp_f32 v26, v26
  v_exp_f32 v27, v27
  v_exp_f32 v28, v28
  v_exp_f32 v29, v29
  v_exp_f32 v30, v30
  v_exp_f32 v31, v31
  s_waitcnt lgkmcnt(0)
  v_smfmac_f32_32x32x32_bf16 v[48:63], v[120:123], v[16:23], v8
  v_exp_f32 v32, v32
  v_exp_f32 v33, v33
  v_exp_f32 v34, v34
  v_smfmac_f32_32x32x32_bf16 v[48:63], v[124:127], v[24:31], v8
  v_exp_f32 v35, v35
  v_exp_f32 v36, v36
  v_exp_f32 v37, v37
  v_mfma_f32_32x32x16_bf16 v[16:31], v[96:99], v[80:83], 0
  v_exp_f32 v38, v38
  v_exp_f32 v39, v39
  v_exp_f32 v40, v40
  v_mfma_f32_32x32x8bf16_1k v[16:31], v[100:101], v[84:85], v[16:31]
  v_exp_f32 v41, v41
  v_exp_f32 v42, v42
  v_exp_f32 v43, v43
  v_exp_f32 v44, v44
  v_exp_f32 v45, v45
  v_exp_f32 v46, v46
  v_exp_f32 v47, v47
  v_smfmac_f32_32x32x32_bf16 v[64:79], v[120:123], v[32:39], v8
  ds_read_b128 v[112:115], v2 offset:53248
  ds_read_b128 v[116:119], v2 offset:54272
  ds_read2st64_b64 v[104:107], v1 offset0:93 offset1:94
  ds_read_b64 v[108:109], v1 offset:48640
  v_exp_f32 v16, v16
  v_exp_f32 v17, v17
  v_exp_f32 v18, v18
  v_smfmac_f32_32x32x32_bf16 v[64:79], v[124:127], v[40:47], v8
  s_add_u32 m0, s36, 28672
  s_mov_b64 exec, s[40:41]
  buffer_load_dwordx4 v7, s[12:15], s31 offen lds
  buffer_load_dwordx4 v7, s[12:15], s31 offen offset:1024 lds
  s_mov_b64 exec, -1
  s_add_u32 s30, s30, 147456
  v_exp_f32 v19, v19
  v_exp_f32 v20, v20
  v_exp_f32 v21, v21
  v_mfma_f32_32x32x16_bf16 v[32:47], v[96:99], v[88:91], 0
  v_exp_f32 v22, v22
  v_exp_f32 v23, v23
  v_exp_f32 v24, v24
  v_mfma_f32_32x32x8bf16_1k v[32:47], v[100:101], v[92:93], v[32:47]
  v_exp_f32 v25, v25
  v_exp_f32 v26, v26
  v_exp_f32 v27, v27
  v_exp_f32 v28, v28
  v_exp_f32 v29, v29
  v_exp_f32 v30, v30
  v_exp_f32 v31, v31
  s_waitcnt lgkmcnt(0)
  v_smfmac_f32_32x32x32_bf16 v[48:63], v[112:115], v[16:23], v8
  v_exp_f32 v32, v32
  v_exp_f32 v33, v33
  v_exp_f32 v34, v34
  v_smfmac_f32_32x32x32_bf16 v[48:63], v[116:119], v[24:31], v8
  v_exp_f32 v35, v35
  v_exp_f32 v36, v36
  v_exp_f32 v37, v37
  v_mfma_f32_32x32x16_bf16 v[16:31], v[104:107], v[80:83], 0
  v_exp_f32 v38, v38
  v_exp_f32 v39, v39
  v_exp_f32 v40, v40
  v_mfma_f32_32x32x8bf16_1k v[16:31], v[108:109], v[84:85], v[16:31]
  v_exp_f32 v41, v41
  v_exp_f32 v42, v42
  v_exp_f32 v43, v43
  v_exp_f32 v44, v44
  v_exp_f32 v45, v45
  v_exp_f32 v46, v46
  v_exp_f32 v47, v47
  v_smfmac_f32_32x32x32_bf16 v[64:79], v[112:115], v[32:39], v8
  ds_read_b128 v[120:123], v2 offset:55296
  ds_read_b128 v[124:127], v2 offset:56320
  ds_read2st64_b64 v[96:99], v1 offset0:0 offset1:1
  ds_read_b64 v[100:101], v1 offset:1024
  v_exp_f32 v16, v16
  v_exp_f32 v17, v17
  v_exp_f32 v18, v18
  v_smfmac_f32_32x32x32_bf16 v[64:79], v[116:119], v[40:47], v8
  v_exp_f32 v19, v19
  v_exp_f32 v20, v20
  v_exp_f32 v21, v21
  v_mfma_f32_32x32x16_bf16 v[32:47], v[104:107], v[88:91], 0
  v_exp_f32 v22, v22
  v_exp_f32 v23, v23
  v_exp_f32 v24, v24
  v_mfma_f32_32x32x8bf16_1k v[32:47], v[108:109], v[92:93], v[32:47]
  v_exp_f32 v25, v25
  v_exp_f32 v26, v26
  v_exp_f32 v27, v27
  v_exp_f32 v28, v28
  v_exp_f32 v29, v29
  v_exp_f32 v30, v30
  v_exp_f32 v31, v31
  s_waitcnt lgkmcnt(0)
  v_smfmac_f32_32x32x32_bf16 v[48:63], v[120:123], v[16:23], v8
  v_exp_f32 v32, v32
  v_exp_f32 v33, v33
  v_exp_f32 v34, v34
  v_smfmac_f32_32x32x32_bf16 v[48:63], v[124:127], v[24:31], v8
  v_exp_f32 v35, v35
  v_exp_f32 v36, v36
  v_exp_f32 v37, v37
  v_mfma_f32_32x32x16_bf16 v[16:31], v[96:99], v[80:83], 0
  v_exp_f32 v38, v38
  v_exp_f32 v39, v39
  v_exp_f32 v40, v40
  v_mfma_f32_32x32x8bf16_1k v[16:31], v[100:101], v[84:85], v[16:31]
  v_exp_f32 v41, v41
  v_exp_f32 v42, v42
  v_exp_f32 v43, v43
  v_exp_f32 v44, v44
  v_exp_f32 v45, v45
  v_exp_f32 v46, v46
  v_exp_f32 v47, v47
  s_sub_u32 s29, s29, 1
  s_cmp_lg_u32 s29, 0
  s_cbranch_scc1 L_at_loop
  s_nop 1
  v_smfmac_f32_32x32x32_bf16 v[64:79], v[120:123], v[32:39], v8
  v_smfmac_f32_32x32x32_bf16 v[64:79], v[124:127], v[40:47], v8
  s_waitcnt vmcnt(0) lgkmcnt(0)
  s_nop 7
  s_nop 3
  v_mov_b32 v9, v58
  v_mov_b32 v11, v58
  s_nop 1
  v_permlane32_swap_b32 v9, v11
  v_mov_b32 v10, v74
  v_mov_b32 v11, v74
  s_nop 1
  v_permlane32_swap_b32 v10, v11
  v_mov_b32 v11, 0
  v_fmac_f32 v11, 0, v48
  v_fmac_f32 v11, 0, v49
  v_fmac_f32 v11, 0, v50
  v_fmac_f32 v11, 0, v51
  v_fmac_f32 v11, 0, v52
  v_fmac_f32 v11, 0, v53
  v_fmac_f32 v11, 0, v54
  v_fmac_f32 v11, 0, v55
  v_fmac_f32 v11, 0, v56
  v_fmac_f32 v11, 0, v57
  v_fmac_f32 v11, 0, v64
  v_fmac_f32 v11, 0, v65
  v_fmac_f32 v11, 0, v66
  v_fmac_f32 v11, 0, v67
  v_fmac_f32 v11, 0, v68
  v_fmac_f32 v11, 0, v69
  v_fmac_f32 v11, 0, v70
  v_fmac_f32 v11, 0, v71
  v_fmac_f32 v11, 0, v72
  v_fmac_f32 v11, 0, v73
  v_cmp_u_f32 vcc, v11, v11
  s_nop 0
  s_mov_b64 s[42:43], vcc
  v_cmp_nle_f32 vcc, 0x17800000, v9
  s_nop 0
  s_or_b64 s[42:43], s[42:43], vcc
  v_cmp_nge_f32 vcc, 0x71800000, v9
  s_nop 0
  s_or_b64 s[42:43], s[42:43], vcc
  v_cmp_nle_f32 vcc, 0x17800000, v10
  s_nop 0
  s_or_b64 s[42:43], s[42:43], vcc
  v_cmp_nge_f32 vcc, 0x71800000, v10
  s_nop 0
  s_or_b64 s[42:43], s[42:43], vcc
  s_cmp_lg_u64 s[42:43], 0
  s_cselect_b32 s32, 1, 0
  v_mov_b32 v20, s32
  v_mov_b32 v21, 57344
  ds_or_b32 v21, v20
  v_rcp_f32 v9, v9
  s_nop 0
  v_mul_f32 v48, v48, v9
  v_mul_f32 v49, v49, v9
  v_mul_f32 v50, v50, v9
  v_mul_f32 v51, v51, v9
  v_mul_f32 v52, v52, v9
  v_mul_f32 v53, v53, v9
  v_mul_f32 v54, v54, v9
  v_mul_f32 v55, v55, v9
  v_mul_f32 v56, v56, v9
  v_mul_f32 v57, v57, v9
  v_cvt_pk_bf16_f32 v16, v48, v49
  v_cvt_pk_bf16_f32 v17, v50, v51
  v_cvt_pk_bf16_f32 v18, v52, v53
  v_cvt_pk_bf16_f32 v19, v54, v55
  v_cvt_pk_bf16_f32 v20, v56, v57
  v_rcp_f32 v10, v10
  s_nop 0
  v_mul_f32 v64, v64, v10
  v_mul_f32 v65, v65, v10
  v_mul_f32 v66, v66, v10
  v_mul_f32 v67, v67, v10
  v_mul_f32 v68, v68, v10
  v_mul_f32 v69, v69, v10
  v_mul_f32 v70, v70, v10
  v_mul_f32 v71, v71, v10
  v_mul_f32 v72, v72, v10
  v_mul_f32 v73, v73, v10
  v_cvt_pk_bf16_f32 v24, v64, v65
  v_cvt_pk_bf16_f32 v25, v66, v67
  v_cvt_pk_bf16_f32 v26, v68, v69
  v_cvt_pk_bf16_f32 v27, v70, v71
  v_cvt_pk_bf16_f32 v28, v72, v73
  v_bfe_u32 v9, v0, 4, 1
  v_lshlrev_b32 v9, 10, v9
  v_lshrrev_b32 v10, 5, v0
  v_lshl_add_u32 v11, v10, 8, v9
  v_and_b32 v10, 15, v0
  v_lshl_add_u32 v11, v10, 4, v11
  v_lshl_add_u32 v9, v10, 4, v9
  s_mul_i32 s32, s35, 18
  s_lshr_b32 s33, s25, 1
  s_add_u32 s32, s32, s33
  s_lshl_b32 s32, s32, 11
  s_and_b32 s33, s25, 1
  s_lshl_b32 s33, s33, 9
  s_add_u32 s32, s32, s33
  buffer_store_dwordx4 v[16:19], v11, s[20:23], s32 offen sc1
  s_add_u32 s33, s32, 36864
  buffer_store_dwordx4 v[24:27], v11, s[20:23], s33 offen sc1
  s_mul_i32 s32, s35, 18
  s_lshr_b32 s33, s25, 4
  s_add_u32 s32, s32, s33
  s_add_u32 s32, s32, 16
  s_lshl_b32 s32, s32, 11
  s_bfe_u32 s33, s25, 0x20002
  s_lshl_b32 s33, s33, 8
  s_add_u32 s32, s32, s33
  s_and_b32 s33, s25, 3
  s_lshl_b32 s33, s33, 2
  s_add_u32 s32, s32, s33
  s_mov_b32 exec_hi, 0
  buffer_store_dword v20, v9, s[20:23], s32 offen sc1
  s_add_u32 s32, s32, 36864
  buffer_store_dword v28, v9, s[20:23], s32 offen sc1
  s_mov_b64 exec, -1
  s_waitcnt lgkmcnt(0)
  s_barrier
  ds_read_b32 v20, v21
  s_waitcnt lgkmcnt(0)
  v_readfirstlane_b32 s32, v20
  s_nop 3
  s_cmp_lg_u32 s32, 0
  s_cbranch_scc0 L_at_out
  s_waitcnt vmcnt(0)
  s_barrier
  s_lshl_b32 s33, s24, 10
  s_mul_i32 s30, s25, 9
  s_lshr_b32 s30, s30, 2
  s_lshl_b32 s30, s30, 9
  s_sub_u32 s27, 0, s30
  s_add_u32 m0, s33, 0
  s_add_u32 s31, s30, s27
  buffer_load_dwordx4 v5, s[8:11], s30 offen lds
  s_add_u32 m0, s37, 0
  s_nop 0
  buffer_load_dwordx4 v6, s[8:11], s30 offen lds
  s_add_u32 m0, s36, 0
  s_mov_b64 exec, s[40:41]
  buffer_load_dwordx4 v7, s[12:15], s31 offen lds
  buffer_load_dwordx4 v7, s[12:15], s31 offen offset:1024 lds
  s_mov_b64 exec, -1
  s_add_u32 s30, s30, 147456
  s_add_u32 m0, s33, 14336
  s_add_u32 s31, s30, s27
  buffer_load_dwordx4 v5, s[8:11], s30 offen lds
  s_add_u32 m0, s37, 14336
  s_nop 0
  buffer_load_dwordx4 v6, s[8:11], s30 offen lds
  s_add_u32 m0, s36, 14336
  s_mov_b64 exec, s[40:41]
  buffer_load_dwordx4 v7, s[12:15], s31 offen lds
  buffer_load_dwordx4 v7, s[12:15], s31 offen offset:1024 lds
  s_mov_b64 exec, -1
  s_add_u32 s30, s30, 147456
  s_add_u32 m0, s33, 28672
  s_add_u32 s31, s30, s27
  buffer_load_dwordx4 v5, s[8:11], s30 offen lds
  s_add_u32 m0, s37, 28672
  s_nop 0
  buffer_load_dwordx4 v6, s[8:11], s30 offen lds
  s_add_u32 m0, s36, 28672
  s_mov_b64 exec, s[40:41]
  buffer_load_dwordx4 v7, s[12:15], s31 offen lds
  buffer_load_dwordx4 v7, s[12:15], s31 offen offset:1024 lds
  s_mov_b64 exec, -1
  s_add_u32 s30, s30, 147456
  s_mov_b32 s29, 4
  v_mov_b32 v160, 0xff7fffff
  v_mov_b32 v161, 0xff7fffff
  s_waitcnt vmcnt(0)
  s_barrier
L_at_mx:
  s_waitcnt vmcnt(0)
  s_barrier
  s_add_u32 m0, s33, 43008
  s_add_u32 s31, s30, s27
  buffer_load_dwordx4 v5, s[8:11], s30 offen lds
  s_add_u32 m0, s37, 43008
  s_nop 0
  buffer_load_dwordx4 v6, s[8:11], s30 offen lds
  s_add_u32 m0, s36, 43008
  s_mov_b64 exec, s[40:41]
  buffer_load_dwordx4 v7, s[12:15], s31 offen lds
  buffer_load_dwordx4 v7, s[12:15], s31 offen offset:1024 lds
  s_mov_b64 exec, -1
  s_add_u32 s30, s30, 147456
  ds_read2st64_b64 v[96:99], v1 offset0:0 offset1:1
  ds_read_b64 v[100:101], v1 offset:1024
  s_waitcnt lgkmcnt(0)
  v_mfma_f32_32x32x16_bf16 v[16:31], v[96:99], v[80:83], 0
  v_mfma_f32_32x32x8bf16_1k v[16:31], v[100:101], v[84:85], v[16:31]
  v_mfma_f32_32x32x16_bf16 v[32:47], v[96:99], v[88:91], 0
  v_mfma_f32_32x32x8bf16_1k v[32:47], v[100:101], v[92:93], v[32:47]
  s_nop 7
  s_nop 3
  v_max3_f32 v160, v16, v17, v160
  v_max3_f32 v160, v18, v19, v160
  v_max3_f32 v160, v20, v21, v160
  v_max3_f32 v160, v22, v23, v160
  v_max3_f32 v160, v24, v25, v160
  v_max3_f32 v160, v26, v27, v160
  v_max3_f32 v160, v28, v29, v160
  v_max3_f32 v160, v30, v31, v160
  v_max3_f32 v161, v32, v33, v161
  v_max3_f32 v161, v34, v35, v161
  v_max3_f32 v161, v36, v37, v161
  v_max3_f32 v161, v38, v39, v161
  v_max3_f32 v161, v40, v41, v161
  v_max3_f32 v161, v42, v43, v161
  v_max3_f32 v161, v44, v45, v161
  v_max3_f32 v161, v46, v47, v161
  ds_read2st64_b64 v[96:99], v1 offset0:3 offset1:4
  ds_read_b64 v[100:101], v1 offset:2560
  s_waitcnt lgkmcnt(0)
  v_mfma_f32_32x32x16_bf16 v[16:31], v[96:99], v[80:83], 0
  v_mfma_f32_32x32x8bf16_1k v[16:31], v[100:101], v[84:85], v[16:31]
  v_mfma_f32_32x32x16_bf16 v[32:47], v[96:99], v[88:91], 0
  v_mfma_f32_32x32x8bf16_1k v[32:47], v[100:101], v[92:93], v[32:47]
  s_nop 7
  s_nop 3
  v_max3_f32 v160, v16, v17, v160
  v_max3_f32 v160, v18, v19, v160
  v_max3_f32 v160, v20, v21, v160
  v_max3_f32 v160, v22, v23, v160
  v_max3_f32 v160, v24, v25, v160
  v_max3_f32 v160, v26, v27, v160
  v_max3_f32 v160, v28, v29, v160
  v_max3_f32 v160, v30, v31, v160
  v_max3_f32 v161, v32, v33, v161
  v_max3_f32 v161, v34, v35, v161
  v_max3_f32 v161, v36, v37, v161
  v_max3_f32 v161, v38, v39, v161
  v_max3_f32 v161, v40, v41, v161
  v_max3_f32 v161, v42, v43, v161
  v_max3_f32 v161, v44, v45, v161
  v_max3_f32 v161, v46, v47, v161
  ds_read2st64_b64 v[96:99], v1 offset0:6 offset1:7
  ds_read_b64 v[100:101], v1 offset:4096
  s_waitcnt lgkmcnt(0)
  v_mfma_f32_32x32x16_bf16 v[16:31], v[96:99], v[80:83], 0
  v_mfma_f32_32x32x8bf16_1k v[16:31], v[100:101], v[84:85], v[16:31]
  v_mfma_f32_32x32x16_bf16 v[32:47], v[96:99], v[88:91], 0
  v_mfma_f32_32x32x8bf16_1k v[32:47], v[100:101], v[92:93], v[32:47]
  s_nop 7
  s_nop 3
  v_max3_f32 v160, v16, v17, v160
  v_max3_f32 v160, v18, v19, v160
  v_max3_f32 v160, v20, v21, v160
  v_max3_f32 v160, v22, v23, v160
  v_max3_f32 v160, v24, v25, v160
  v_max3_f32 v160, v26, v27, v160
  v_max3_f32 v160, v28, v29, v160
  v_max3_f32 v160, v30, v31, v160
  v_max3_f32 v161, v32, v33, v161
  v_max3_f32 v161, v34, v35, v161
  v_max3_f32 v161, v36, v37, v161
  v_max3_f32 v161, v38, v39, v161
  v_max3_f32 v161, v40, v41, v161
  v_max3_f32 v161, v42, v43, v161
  v_max3_f32 v161, v44, v45, v161
  v_max3_f32 v161, v46, v47, v161
  ds_read2st64_b64 v[96:99], v1 offset0:9 offset1:10
  ds_read_b64 v[100:101], v1 offset:5632
  s_waitcnt lgkmcnt(0)
  v_mfma_f32_32x32x16_bf16 v[16:31], v[96:99], v[80:83], 0
  v_mfma_f32_32x32x8bf16_1k v[16:31], v[100:101], v[84:85], v[16:31]
  v_mfma_f32_32x32x16_bf16 v[32:47], v[96:99], v[88:91], 0
  v_mfma_f32_32x32x8bf16_1k v[32:47], v[100:101], v[92:93], v[32:47]
  s_nop 7
  s_nop 3
  v_max3_f32 v160, v16, v17, v160
  v_max3_f32 v160, v18, v19, v160
  v_max3_f32 v160, v20, v21, v160
  v_max3_f32 v160, v22, v23, v160
  v_max3_f32 v160, v24, v25, v160
  v_max3_f32 v160, v26, v27, v160
  v_max3_f32 v160, v28, v29, v160
  v_max3_f32 v160, v30, v31, v160
  v_max3_f32 v161, v32, v33, v161
  v_max3_f32 v161, v34, v35, v161
  v_max3_f32 v161, v36, v37, v161
  v_max3_f32 v161, v38, v39, v161
  v_max3_f32 v161, v40, v41, v161
  v_max3_f32 v161, v42, v43, v161
  v_max3_f32 v161, v44, v45, v161
  v_max3_f32 v161, v46, v47, v161
  s_waitcnt vmcnt(0)
  s_barrier
  s_add_u32 m0, s33, 0
  s_add_u32 s31, s30, s27
  buffer_load_dwordx4 v5, s[8:11], s30 offen lds
  s_add_u32 m0, s37, 0
  s_nop 0
  buffer_load_dwordx4 v6, s[8:11], s30 offen lds
  s_add_u32 m0, s36, 0
  s_mov_b64 exec, s[40:41]
  buffer_load_dwordx4 v7, s[12:15], s31 offen lds
  buffer_load_dwordx4 v7, s[12:15], s31 offen offset:1024 lds
  s_mov_b64 exec, -1
  s_add_u32 s30, s30, 147456
  ds_read2st64_b64 v[96:99], v1 offset0:28 offset1:29
  ds_read_b64 v[100:101], v1 offset:15360
  s_waitcnt lgkmcnt(0)
  v_mfma_f32_32x32x16_bf16 v[16:31], v[96:99], v[80:83], 0
  v_mfma_f32_32x32x8bf16_1k v[16:31], v[100:101], v[84:85], v[16:31]
  v_mfma_f32_32x32x16_bf16 v[32:47], v[96:99], v[88:91], 0
  v_mfma_f32_32x32x8bf16_1k v[32:47], v[100:101], v[92:93], v[32:47]
  s_nop 7
  s_nop 3
  v_max3_f32 v160, v16, v17, v160
  v_max3_f32 v160, v18, v19, v160
  v_max3_f32 v160, v20, v21, v160
  v_max3_f32 v160, v22, v23, v160
  v_max3_f32 v160, v24, v25, v160
  v_max3_f32 v160, v26, v27, v160
  v_max3_f32 v160, v28, v29, v160
  v_max3_f32 v160, v30, v31, v160
  v_max3_f32 v161, v32, v33, v161
  v_max3_f32 v161, v34, v35, v161
  v_max3_f32 v161, v36, v37, v161
  v_max3_f32 v161, v38, v39, v161
  v_max3_f32 v161, v40, v41, v161
  v_max3_f32 v161, v42, v43, v161
  v_max3_f32 v161, v44, v45, v161
  v_max3_f32 v161, v46, v47, v161
  ds_read2st64_b64 v[96:99], v1 offset0:31 offset1:32
  ds_read_b64 v[100:101], v1 offset:16896
  s_waitcnt lgkmcnt(0)
  v_mfma_f32_32x32x16_bf16 v[16:31], v[96:99], v[80:83], 0
  v_mfma_f32_32x32x8bf16_1k v[16:31], v[100:101], v[84:85], v[16:31]
  v_mfma_f32_32x32x16_bf16 v[32:47], v[96:99], v[88:91], 0
  v_mfma_f32_32x32x8bf16_1k v[32:47], v[100:101], v[92:93], v[32:47]
  s_nop 7
  s_nop 3
  v_max3_f32 v160, v16, v17, v160
  v_max3_f32 v160, v18, v19, v160
  v_max3_f32 v160, v20, v21, v160
  v_max3_f32 v160, v22, v23, v160
  v_max3_f32 v160, v24, v25, v160
  v_max3_f32 v160, v26, v27, v160
  v_max3_f32 v160, v28, v29, v160
  v_max3_f32 v160, v30, v31, v160
  v_max3_f32 v161, v32, v33, v161
  v_max3_f32 v161, v34, v35, v161
  v_max3_f32 v161, v36, v37, v161
  v_max3_f32 v161, v38, v39, v161
  v_max3_f32 v161, v40, v41, v161
  v_max3_f32 v161, v42, v43, v161
  v_max3_f32 v161, v44, v45, v161
  v_max3_f32 v161, v46, v47, v161
  ds_read2st64_b64 v[96:99], v1 offset0:34 offset1:35
  ds_read_b64 v[100:101], v1 offset:18432
  s_waitcnt lgkmcnt(0)
  v_mfma_f32_32x32x16_bf16 v[16:31], v[96:99], v[80:83], 0
  v_mfma_f32_32x32x8bf16_1k v[16:31], v[100:101], v[84:85], v[16:31]
  v_mfma_f32_32x32x16_bf16 v[32:47], v[96:99], v[88:91], 0
  v_mfma_f32_32x32x8bf16_1k v[32:47], v[100:101], v[92:93], v[32:47]
  s_nop 7
  s_nop 3
  v_max3_f32 v160, v16, v17, v160
  v_max3_f32 v160, v18, v19, v160
  v_max3_f32 v160, v20, v21, v160
  v_max3_f32 v160, v22, v23, v160
  v_max3_f32 v160, v24, v25, v160
  v_max3_f32 v160, v26, v27, v160
  v_max3_f32 v160, v28, v29, v160
  v_max3_f32 v160, v30, v31, v160
  v_max3_f32 v161, v32, v33, v161
  v_max3_f32 v161, v34, v35, v161
  v_max3_f32 v161, v36, v37, v161
  v_max3_f32 v161, v38, v39, v161
  v_max3_f32 v161, v40, v41, v161
  v_max3_f32 v161, v42, v43, v161
  v_max3_f32 v161, v44, v45, v161
  v_max3_f32 v161, v46, v47, v161
  ds_read2st64_b64 v[96:99], v1 offset0:37 offset1:38
  ds_read_b64 v[100:101], v1 offset:19968
  s_waitcnt lgkmcnt(0)
  v_mfma_f32_32x32x16_bf16 v[16:31], v[96:99], v[80:83], 0
  v_mfma_f32_32x32x8bf16_1k v[16:31], v[100:101], v[84:85], v[16:31]
  v_mfma_f32_32x32x16_bf16 v[32:47], v[96:99], v[88:91], 0
  v_mfma_f32_32x32x8bf16_1k v[32:47], v[100:101], v[92:93], v[32:47]
  s_nop 7
  s_nop 3
  v_max3_f32 v160, v16, v17, v160
  v_max3_f32 v160, v18, v19, v160
  v_max3_f32 v160, v20, v21, v160
  v_max3_f32 v160, v22, v23, v160
  v_max3_f32 v160, v24, v25, v160
  v_max3_f32 v160, v26, v27, v160
  v_max3_f32 v160, v28, v29, v160
  v_max3_f32 v160, v30, v31, v160
  v_max3_f32 v161, v32, v33, v161
  v_max3_f32 v161, v34, v35, v161
  v_max3_f32 v161, v36, v37, v161
  v_max3_f32 v161, v38, v39, v161
  v_max3_f32 v161, v40, v41, v161
  v_max3_f32 v161, v42, v43, v161
  v_max3_f32 v161, v44, v45, v161
  v_max3_f32 v161, v46, v47, v161
  s_waitcnt vmcnt(0)
  s_barrier
  s_add_u32 m0, s33, 14336
  s_add_u32 s31, s30, s27
  buffer_load_dwordx4 v5, s[8:11], s30 offen lds
  s_add_u32 m0, s37, 14336
  s_nop 0
  buffer_load_dwordx4 v6, s[8:11], s30 offen lds
  s_add_u32 m0, s36, 14336
  s_mov_b64 exec, s[40:41]
  buffer_load_dwordx4 v7, s[12:15], s31 offen lds
  buffer_load_dwordx4 v7, s[12:15], s31 offen offset:1024 lds
  s_mov_b64 exec, -1
  s_add_u32 s30, s30, 147456
  ds_read2st64_b64 v[96:99], v1 offset0:56 offset1:57
  ds_read_b64 v[100:101], v1 offset:29696
  s_waitcnt lgkmcnt(0)
  v_mfma_f32_32x32x16_bf16 v[16:31], v[96:99], v[80:83], 0
  v_mfma_f32_32x32x8bf16_1k v[16:31], v[100:101], v[84:85], v[16:31]
  v_mfma_f32_32x32x16_bf16 v[32:47], v[96:99], v[88:91], 0
  v_mfma_f32_32x32x8bf16_1k v[32:47], v[100:101], v[92:93], v[32:47]
  s_nop 7
  s_nop 3
  v_max3_f32 v160, v16, v17, v160
  v_max3_f32 v160, v18, v19, v160
  v_max3_f32 v160, v20, v21, v160
  v_max3_f32 v160, v22, v23, v160
  v_max3_f32 v160, v24, v25, v160
  v_max3_f32 v160, v26, v27, v160
  v_max3_f32 v160, v28, v29, v160
  v_max3_f32 v160, v30, v31, v160
  v_max3_f32 v161, v32, v33, v161
  v_max3_f32 v161, v34, v35, v161
  v_max3_f32 v161, v36, v37, v161
  v_max3_f32 v161, v38, v39, v161
  v_max3_f32 v161, v40, v41, v161
  v_max3_f32 v161, v42, v43, v161
  v_max3_f32 v161, v44, v45, v161
  v_max3_f32 v161, v46, v47, v161
  ds_read2st64_b64 v[96:99], v1 offset0:59 offset1:60
  ds_read_b64 v[100:101], v1 offset:31232
  s_waitcnt lgkmcnt(0)
  v_mfma_f32_32x32x16_bf16 v[16:31], v[96:99], v[80:83], 0
  v_mfma_f32_32x32x8bf16_1k v[16:31], v[100:101], v[84:85], v[16:31]
  v_mfma_f32_32x32x16_bf16 v[32:47], v[96:99], v[88:91], 0
  v_mfma_f32_32x32x8bf16_1k v[32:47], v[100:101], v[92:93], v[32:47]
  s_nop 7
  s_nop 3
  v_max3_f32 v160, v16, v17, v160
  v_max3_f32 v160, v18, v19, v160
  v_max3_f32 v160, v20, v21, v160
  v_max3_f32 v160, v22, v23, v160
  v_max3_f32 v160, v24, v25, v160
  v_max3_f32 v160, v26, v27, v160
  v_max3_f32 v160, v28, v29, v160
  v_max3_f32 v160, v30, v31, v160
  v_max3_f32 v161, v32, v33, v161
  v_max3_f32 v161, v34, v35, v161
  v_max3_f32 v161, v36, v37, v161
  v_max3_f32 v161, v38, v39, v161
  v_max3_f32 v161, v40, v41, v161
  v_max3_f32 v161, v42, v43, v161
  v_max3_f32 v161, v44, v45, v161
  v_max3_f32 v161, v46, v47, v161
  ds_read2st64_b64 v[96:99], v1 offset0:62 offset1:63
  ds_read_b64 v[100:101], v1 offset:32768
  s_waitcnt lgkmcnt(0)
  v_mfma_f32_32x32x16_bf16 v[16:31], v[96:99], v[80:83], 0
  v_mfma_f32_32x32x8bf16_1k v[16:31], v[100:101], v[84:85], v[16:31]
  v_mfma_f32_32x32x16_bf16 v[32:47], v[96:99], v[88:91], 0
  v_mfma_f32_32x32x8bf16_1k v[32:47], v[100:101], v[92:93], v[32:47]
  s_nop 7
  s_nop 3
  v_max3_f32 v160, v16, v17, v160
  v_max3_f32 v160, v18, v19, v160
  v_max3_f32 v160, v20, v21, v160
  v_max3_f32 v160, v22, v23, v160
  v_max3_f32 v160, v24, v25, v160
  v_max3_f32 v160, v26, v27, v160
  v_max3_f32 v160, v28, v29, v160
  v_max3_f32 v160, v30, v31, v160
  v_max3_f32 v161, v32, v33, v161
  v_max3_f32 v161, v34, v35, v161
  v_max3_f32 v161, v36, v37, v161
  v_max3_f32 v161, v38, v39, v161
  v_max3_f32 v161, v40, v41, v161
  v_max3_f32 v161, v42, v43, v161
  v_max3_f32 v161, v44, v45, v161
  v_max3_f32 v161, v46, v47, v161
  ds_read2st64_b64 v[96:99], v1 offset0:65 offset1:66
  ds_read_b64 v[100:101], v1 offset:34304
  s_waitcnt lgkmcnt(0)
  v_mfma_f32_32x32x16_bf16 v[16:31], v[96:99], v[80:83], 0
  v_mfma_f32_32x32x8bf16_1k v[16:31], v[100:101], v[84:85], v[16:31]
  v_mfma_f32_32x32x16_bf16 v[32:47], v[96:99], v[88:91], 0
  v_mfma_f32_32x32x8bf16_1k v[32:47], v[100:101], v[92:93], v[32:47]
  s_nop 7
  s_nop 3
  v_max3_f32 v160, v16, v17, v160
  v_max3_f32 v160, v18, v19, v160
  v_max3_f32 v160, v20, v21, v160
  v_max3_f32 v160, v22, v23, v160
  v_max3_f32 v160, v24, v25, v160
  v_max3_f32 v160, v26, v27, v160
  v_max3_f32 v160, v28, v29, v160
  v_max3_f32 v160, v30, v31, v160
  v_max3_f32 v161, v32, v33, v161
  v_max3_f32 v161, v34, v35, v161
  v_max3_f32 v161, v36, v37, v161
  v_max3_f32 v161, v38, v39, v161
  v_max3_f32 v161, v40, v41, v161
  v_max3_f32 v161, v42, v43, v161
  v_max3_f32 v161, v44, v45, v161
  v_max3_f32 v161, v46, v47, v161
  s_waitcnt vmcnt(0)
  s_barrier
  s_add_u32 m0, s33, 28672
  s_add_u32 s31, s30, s27
  buffer_load_dwordx4 v5, s[8:11], s30 offen lds
  s_add_u32 m0, s37, 28672
  s_nop 0
  buffer_load_dwordx4 v6, s[8:11], s30 offen lds
  s_add_u32 m0, s36, 28672
  s_mov_b64 exec, s[40:41]
  buffer_load_dwordx4 v7, s[12:15], s31 offen lds
  buffer_load_dwordx4 v7, s[12:15], s31 offen offset:1024 lds
  s_mov_b64 exec, -1
  s_add_u32 s30, s30, 147456
  ds_read2st64_b64 v[96:99], v1 offset0:84 offset1:85
  ds_read_b64 v[100:101], v1 offset:44032
  s_waitcnt lgkmcnt(0)
  v_mfma_f32_32x32x16_bf16 v[16:31], v[96:99], v[80:83], 0
  v_mfma_f32_32x32x8bf16_1k v[16:31], v[100:101], v[84:85], v[16:31]
  v_mfma_f32_32x32x16_bf16 v[32:47], v[96:99], v[88:91], 0
  v_mfma_f32_32x32x8bf16_1k v[32:47], v[100:101], v[92:93], v[32:47]
  s_nop 7
  s_nop 3
  v_max3_f32 v160, v16, v17, v160
  v_max3_f32 v160, v18, v19, v160
  v_max3_f32 v160, v20, v21, v160
  v_max3_f32 v160, v22, v23, v160
  v_max3_f32 v160, v24, v25, v160
  v_max3_f32 v160, v26, v27, v160
  v_max3_f32 v160, v28, v29, v160
  v_max3_f32 v160, v30, v31, v160
  v_max3_f32 v161, v32, v33, v161
  v_max3_f32 v161, v34, v35, v161
  v_max3_f32 v161, v36, v37, v161
  v_max3_f32 v161, v38, v39, v161
  v_max3_f32 v161, v40, v41, v161
  v_max3_f32 v161, v42, v43, v161
  v_max3_f32 v161, v44, v45, v161
  v_max3_f32 v161, v46, v47, v161
  ds_read2st64_b64 v[96:99], v1 offset0:87 offset1:88
  ds_read_b64 v[100:101], v1 offset:45568
  s_waitcnt lgkmcnt(0)
  v_mfma_f32_32x32x16_bf16 v[16:31], v[96:99], v[80:83], 0
  v_mfma_f32_32x32x8bf16_1k v[16:31], v[100:101], v[84:85], v[16:31]
  v_mfma_f32_32x32x16_bf16 v[32:47], v[96:99], v[88:91], 0
  v_mfma_f32_32x32x8bf16_1k v[32:47], v[100:101], v[92:93], v[32:47]
  s_nop 7
  s_nop 3
  v_max3_f32 v160, v16, v17, v160
  v_max3_f32 v160, v18, v19, v160
  v_max3_f32 v160, v20, v21, v160
  v_max3_f32 v160, v22, v23, v160
  v_max3_f32 v160, v24, v25, v160
  v_max3_f32 v160, v26, v27, v160
  v_max3_f32 v160, v28, v29, v160
  v_max3_f32 v160, v30, v31, v160
  v_max3_f32 v161, v32, v33, v161
  v_max3_f32 v161, v34, v35, v161
  v_max3_f32 v161, v36, v37, v161
  v_max3_f32 v161, v38, v39, v161
  v_max3_f32 v161, v40, v41, v161
  v_max3_f32 v161, v42, v43, v161
  v_max3_f32 v161, v44, v45, v161
  v_max3_f32 v161, v46, v47, v161
  ds_read2st64_b64 v[96:99], v1 offset0:90 offset1:91
  ds_read_b64 v[100:101], v1 offset:47104
  s_waitcnt lgkmcnt(0)
  v_mfma_f32_32x32x16_bf16 v[16:31], v[96:99], v[80:83], 0
  v_mfma_f32_32x32x8bf16_1k v[16:31], v[100:101], v[84:85], v[16:31]
  v_mfma_f32_32x32x16_bf16 v[32:47], v[96:99], v[88:91], 0
  v_mfma_f32_32x32x8bf16_1k v[32:47], v[100:101], v[92:93], v[32:47]
  s_nop 7
  s_nop 3
  v_max3_f32 v160, v16, v17, v160
  v_max3_f32 v160, v18, v19, v160
  v_max3_f32 v160, v20, v21, v160
  v_max3_f32 v160, v22, v23, v160
  v_max3_f32 v160, v24, v25, v160
  v_max3_f32 v160, v26, v27, v160
  v_max3_f32 v160, v28, v29, v160
  v_max3_f32 v160, v30, v31, v160
  v_max3_f32 v161, v32, v33, v161
  v_max3_f32 v161, v34, v35, v161
  v_max3_f32 v161, v36, v37, v161
  v_max3_f32 v161, v38, v39, v161
  v_max3_f32 v161, v40, v41, v161
  v_max3_f32 v161, v42, v43, v161
  v_max3_f32 v161, v44, v45, v161
  v_max3_f32 v161, v46, v47, v161
  ds_read2st64_b64 v[96:99], v1 offset0:93 offset1:94
  ds_read_b64 v[100:101], v1 offset:48640
  s_waitcnt lgkmcnt(0)
  v_mfma_f32_32x32x16_bf16 v[16:31], v[96:99], v[80:83], 0
  v_mfma_f32_32x32x8bf16_1k v[16:31], v[100:101], v[84:85], v[16:31]
  v_mfma_f32_32x32x16_bf16 v[32:47], v[96:99], v[88:91], 0
  v_mfma_f32_32x32x8bf16_1k v[32:47], v[100:101], v[92:93], v[32:47]
  s_nop 7
  s_nop 3
  v_max3_f32 v160, v16, v17, v160
  v_max3_f32 v160, v18, v19, v160
  v_max3_f32 v160, v20, v21, v160
  v_max3_f32 v160, v22, v23, v160
  v_max3_f32 v160, v24, v25, v160
  v_max3_f32 v160, v26, v27, v160
  v_max3_f32 v160, v28, v29, v160
  v_max3_f32 v160, v30, v31, v160
  v_max3_f32 v161, v32, v33, v161
  v_max3_f32 v161, v34, v35, v161
  v_max3_f32 v161, v36, v37, v161
  v_max3_f32 v161, v38, v39, v161
  v_max3_f32 v161, v40, v41, v161
  v_max3_f32 v161, v42, v43, v161
  v_max3_f32 v161, v44, v45, v161
  v_max3_f32 v161, v46, v47, v161
  s_sub_u32 s29, s29, 1
  s_cmp_lg_u32 s29, 0
  s_cbranch_scc1 L_at_mx
  v_mov_b32 v11, v160
  s_nop 1
  v_permlane32_swap_b32 v160, v11
  s_nop 0
  v_max_f32 v160, v160, v11
  v_sub_f32 v128, 0, v160
  v_sub_f32 v129, 0, v160
  v_sub_f32 v130, 0, v160
  v_sub_f32 v131, 0, v160
  v_sub_f32 v132, 0, v160
  v_sub_f32 v133, 0, v160
  v_sub_f32 v134, 0, v160
  v_sub_f32 v135, 0, v160
  v_sub_f32 v136, 0, v160
  v_sub_f32 v137, 0, v160
  v_sub_f32 v138, 0, v160
  v_sub_f32 v139, 0, v160
  v_sub_f32 v140, 0, v160
  v_sub_f32 v141, 0, v160
  v_sub_f32 v142, 0, v160
  v_sub_f32 v143, 0, v160
  v_mov_b32 v11, v161
  s_nop 1
  v_permlane32_swap_b32 v161, v11
  s_nop 0
  v_max_f32 v161, v161, v11
  v_sub_f32 v144, 0, v161
  v_sub_f32 v145, 0, v161
  v_sub_f32 v146, 0, v161
  v_sub_f32 v147, 0, v161
  v_sub_f32 v148, 0, v161
  v_sub_f32 v149, 0, v161
  v_sub_f32 v150, 0, v161
  v_sub_f32 v151, 0, v161
  v_sub_f32 v152, 0, v161
  v_sub_f32 v153, 0, v161
  v_sub_f32 v154, 0, v161
  v_sub_f32 v155, 0, v161
  v_sub_f32 v156, 0, v161
  v_sub_f32 v157, 0, v161
  v_sub_f32 v158, 0, v161
  v_sub_f32 v159, 0, v161
  s_waitcnt vmcnt(0)
  s_barrier
  s_mul_i32 s30, s25, 9
  s_lshr_b32 s30, s30, 2
  s_lshl_b32 s30, s30, 9
  s_sub_u32 s27, 0, s30
  s_add_u32 m0, s33, 0
  s_add_u32 s31, s30, s27
  buffer_load_dwordx4 v5, s[8:11], s30 offen lds
  s_add_u32 m0, s37, 0
  s_nop 0
  buffer_load_dwordx4 v6, s[8:11], s30 offen lds
  s_add_u32 m0, s36, 0
  s_mov_b64 exec, s[40:41]
  buffer_load_dwordx4 v7, s[12:15], s31 offen lds
  buffer_load_dwordx4 v7, s[12:15], s31 offen offset:1024 lds
  s_mov_b64 exec, -1
  s_add_u32 s30, s30, 147456
  s_add_u32 m0, s33, 14336
  s_add_u32 s31, s30, s27
  buffer_load_dwordx4 v5, s[8:11], s30 offen lds
  s_add_u32 m0, s37, 14336
  s_nop 0
  buffer_load_dwordx4 v6, s[8:11], s30 offen lds
  s_add_u32 m0, s36, 14336
  s_mov_b64 exec, s[40:41]
  buffer_load_dwordx4 v7, s[12:15], s31 offen lds
  buffer_load_dwordx4 v7, s[12:15], s31 offen offset:1024 lds
  s_mov_b64 exec, -1
  s_add_u32 s30, s30, 147456
  s_add_u32 m0, s33, 28672
  s_add_u32 s31, s30, s27
  buffer_load_dwordx4 v5, s[8:11], s30 offen lds
  s_add_u32 m0, s37, 28672
  s_nop 0
  buffer_load_dwordx4 v6, s[8:11], s30 offen lds
  s_add_u32 m0, s36, 28672
  s_mov_b64 exec, s[40:41]
  buffer_load_dwordx4 v7, s[12:15], s31 offen lds
  buffer_load_dwordx4 v7, s[12:15], s31 offen offset:1024 lds
  s_mov_b64 exec, -1
  s_add_u32 s30, s30, 147456
  s_mov_b32 s29, 4
  v_mov_b32 v48, 0
  v_mov_b32 v64, 0
  v_mov_b32 v32, 0
  v_mov_b32 v49, 0
  v_mov_b32 v65, 0
  v_mov_b32 v33, 0
  v_mov_b32 v50, 0
  v_mov_b32 v66, 0
  v_mov_b32 v34, 0
  v_mov_b32 v51, 0
  v_mov_b32 v67, 0
  v_mov_b32 v35, 0
  v_mov_b32 v52, 0
  v_mov_b32 v68, 0
  v_mov_b32 v36, 0
  v_mov_b32 v53, 0
  v_mov_b32 v69, 0
  v_mov_b32 v37, 0
  v_mov_b32 v54, 0
  v_mov_b32 v70, 0
  v_mov_b32 v38, 0
  v_mov_b32 v55, 0
  v_mov_b32 v71, 0
  v_mov_b32 v39, 0
  v_mov_b32 v56, 0
  v_mov_b32 v72, 0
  v_mov_b32 v40, 0
  v_mov_b32 v57, 0
  v_mov_b32 v73, 0
  v_mov_b32 v41, 0
  v_mov_b32 v58, 0
  v_mov_b32 v74, 0
  v_mov_b32 v42, 0
  v_mov_b32 v59, 0
  v_mov_b32 v75, 0
  v_mov_b32 v43, 0
  v_mov_b32 v60, 0
  v_mov_b32 v76, 0
  v_mov_b32 v44, 0
  v_mov_b32 v61, 0
  v_mov_b32 v77, 0
  v_mov_b32 v45, 0
  v_mov_b32 v62, 0
  v_mov_b32 v78, 0
  v_mov_b32 v46, 0
  v_mov_b32 v63, 0
  v_mov_b32 v79, 0
  v_mov_b32 v47, 0
  v_mov_b32 v120, 0
  v_mov_b32 v121, 0
  v_mov_b32 v122, 0
  v_mov_b32 v123, 0
  v_mov_b32 v124, 0
  v_mov_b32 v125, 0
  v_mov_b32 v126, 0
  v_mov_b32 v127, 0
  s_waitcnt vmcnt(8)
  s_barrier
  ds_read2st64_b64 v[96:99], v1 offset0:0 offset1:1
  ds_read_b64 v[100:101], v1 offset:1024
  s_waitcnt lgkmcnt(0)
  v_mfma_f32_32x32x16_bf16 v[16:31], v[96:99], v[80:83], v[128:143]
  v_mfma_f32_32x32x8bf16_1k v[16:31], v[100:101], v[84:85], v[16:31]
  s_nop 7
  s_nop 3
L_at_loop2:
  s_waitcnt vmcnt(4)
  s_barrier
  v_smfmac_f32_32x32x32_bf16 v[64:79], v[120:123], v[32:39], v8
  ds_read_b128 v[112:115], v2 offset:6144
  ds_read_b128 v[116:119], v2 offset:7168
  ds_read2st64_b64 v[104:107], v1 offset0:3 offset1:4
  ds_read_b64 v[108:109], v1 offset:2560
  v_exp_f32 v16, v16
  v_exp_f32 v17, v17
  v_exp_f32 v18, v18
  v_smfmac_f32_32x32x32_bf16 v[64:79], v[124:127], v[40:47], v8
  s_add_u32 m0, s33, 43008
  s_add_u32 s31, s30, s27
  buffer_load_dwordx4 v5, s[8:11], s30 offen lds
  v_exp_f32 v19, v19
  v_exp_f32 v20, v20
  v_exp_f32 v21, v21
  v_mfma_f32_32x32x16_bf16 v[32:47], v[96:99], v[88:91], v[144:159]
  v_exp_f32 v22, v22
  v_exp_f32 v23, v23
  v_exp_f32 v24, v24
  v_mfma_f32_32x32x8bf16_1k v[32:47], v[100:101], v[92:93], v[32:47]
  v_exp_f32 v25, v25
  v_exp_f32 v26, v26
  v_exp_f32 v27, v27
  v_exp_f32 v28, v28
  v_exp_f32 v29, v29
  v_exp_f32 v30, v30
  v_exp_f32 v31, v31
  s_waitcnt lgkmcnt(0)
  v_smfmac_f32_32x32x32_bf16 v[48:63], v[112:115], v[16:23], v8
  v_exp_f32 v32, v32
  v_exp_f32 v33, v33
  v_exp_f32 v34, v34
  v_smfmac_f32_32x32x32_bf16 v[48:63], v[116:119], v[24:31], v8
  v_exp_f32 v35, v35
  v_exp_f32 v36, v36
  v_exp_f32 v37, v37
  v_mfma_f32_32x32x16_bf16 v[16:31], v[104:107], v[80:83], v[128:143]
  v_exp_f32 v38, v38
  v_exp_f32 v39, v39
  v_exp_f32 v40, v40
  v_mfma_f32_32x32x8bf16_1k v[16:31], v[108:109], v[84:85], v[16:31]
  v_exp_f32 v41, v41
  v_exp_f32 v42, v42
  v_exp_f32 v43, v43
  v_exp_f32 v44, v44
  v_exp_f32 v45, v45
  v_exp_f32 v46, v46
  v_exp_f32 v47, v47
  v_smfmac_f32_32x32x32_bf16 v[64:79], v[112:115], v[32:39], v8
  ds_read_b128 v[120:123], v2 offset:8192
  ds_read_b128 v[124:127], v2 offset:9216
  ds_read2st64_b64 v[96:99], v1 offset0:6 offset1:7
  ds_read_b64 v[100:101], v1 offset:4096
  v_exp_f32 v16, v16
  v_exp_f32 v17, v17
  v_exp_f32 v18, v18
  v_smfmac_f32_32x32x32_bf16 v[64:79], v[116:119], v[40:47], v8
  s_add_u32 m0, s37, 43008
  s_nop 0
  buffer_load_dwordx4 v6, s[8:11], s30 offen lds
  v_exp_f32 v19, v19
  v_exp_f32 v20, v20
  v_exp_f32 v21, v21
  v_mfma_f32_32x32x16_bf16 v[32:47], v[104:107], v[88:91], v[144:159]
  v_exp_f32 v22, v22
  v_exp_f32 v23, v23
  v_exp_f32 v24, v24
  v_mfma_f32_32x32x8bf16_1k v[32:47], v[108:109], v[92:93], v[32:47]
  v_exp_f32 v25, v25
  v_exp_f32 v26, v26
  v_exp_f32 v27, v27
  v_exp_f32 v28, v28
  v_exp_f32 v29, v29
  v_exp_f32 v30, v30
  v_exp_f32 v31, v31
  s_waitcnt lgkmcnt(0)
  v_smfmac_f32_32x32x32_bf16 v[48:63], v[120:123], v[16:23], v8
  v_exp_f32 v32, v32
  v_exp_f32 v33, v33
  v_exp_f32 v34, v34
  v_smfmac_f32_32x32x32_bf16 v[48:63], v[124:127], v[24:31], v8
  v_exp_f32 v35, v35
  v_exp_f32 v36, v36
  v_exp_f32 v37, v37
  v_mfma_f32_32x32x16_bf16 v[16:31], v[96:99], v[80:83], v[128:143]
  v_exp_f32 v38, v38
  v_exp_f32 v39, v39
  v_exp_f32 v40, v40
  v_mfma_f32_32x32x8bf16_1k v[16:31], v[100:101], v[84:85], v[16:31]
  v_exp_f32 v41, v41
  v_exp_f32 v42, v42
  v_exp_f32 v43, v43
  v_exp_f32 v44, v44
  v_exp_f32 v45, v45
  v_exp_f32 v46, v46
  v_exp_f32 v47, v47
  v_smfmac_f32_32x32x32_bf16 v[64:79], v[120:123], v[32:39], v8
  ds_read_b128 v[112:115], v2 offset:10240
  ds_read_b128 v[116:119], v2 offset:11264
  ds_read2st64_b64 v[104:107], v1 offset0:9 offset1:10
  ds_read_b64 v[108:109], v1 offset:5632
  v_exp_f32 v16, v16
  v_exp_f32 v17, v17
  v_exp_f32 v18, v18
  v_smfmac_f32_32x32x32_bf16 v[64:79], v[124:127], v[40:47], v8
  s_add_u32 m0, s36, 43008
  s_mov_b64 exec, s[40:41]
  buffer_load_dwordx4 v7, s[12:15], s31 offen lds
  buffer_load_dwordx4 v7, s[12:15], s31 offen offset:1024 lds
  s_mov_b64 exec, -1
  s_add_u32 s30, s30, 147456
  v_exp_f32 v19, v19
  v_exp_f32 v20, v20
  v_exp_f32 v21, v21
  v_mfma_f32_32x32x16_bf16 v[32:47], v[96:99], v[88:91], v[144:159]
  v_exp_f32 v22, v22
  v_exp_f32 v23, v23
  v_exp_f32 v24, v24
  v_mfma_f32_32x32x8bf16_1k v[32:47], v[100:101], v[92:93], v[32:47]
  v_exp_f32 v25, v25
  v_exp_f32 v26, v26
  v_exp_f32 v27, v27
  v_exp_f32 v28, v28
  v_exp_f32 v29, v29
  v_exp_f32 v30, v30
  v_exp_f32 v31, v31
  s_waitcnt lgkmcnt(0)
  v_smfmac_f32_32x32x32_bf16 v[48:63], v[112:115], v[16:23], v8
  v_exp_f32 v32, v32
  v_exp_f32 v33, v33
  v_exp_f32 v34, v34
  v_smfmac_f32_32x32x32_bf16 v[48:63], v[116:119], v[24:31], v8
  v_exp_f32 v35, v35
  v_exp_f32 v36, v36
  v_exp_f32 v37, v37
  v_mfma_f32_32x32x16_bf16 v[16:31], v[104:107], v[80:83], v[128:143]
  v_exp_f32 v38, v38
  v_exp_f32 v39, v39
  v_exp_f32 v40, v40
  v_mfma_f32_32x32x8bf16_1k v[16:31], v[108:109], v[84:85], v[16:31]
  v_exp_f32 v41, v41
  v_exp_f32 v42, v42
  v_exp_f32 v43, v43
  v_exp_f32 v44, v44
  v_exp_f32 v45, v45
  v_exp_f32 v46, v46
  v_exp_f32 v47, v47
  v_smfmac_f32_32x32x32_bf16 v[64:79], v[112:115], v[32:39], v8
  ds_read_b128 v[120:123], v2 offset:12288
  ds_read_b128 v[124:127], v2 offset:13312
  ds_read2st64_b64 v[96:99], v1 offset0:28 offset1:29
  ds_read_b64 v[100:101], v1 offset:15360
  v_exp_f32 v16, v16
  v_exp_f32 v17, v17
  v_exp_f32 v18, v18
  v_smfmac_f32_32x32x32_bf16 v[64:79], v[116:119], v[40:47], v8
  v_exp_f32 v19, v19
  v_exp_f32 v20, v20
  v_exp_f32 v21, v21
  v_mfma_f32_32x32x16_bf16 v[32:47], v[104:107], v[88:91], v[144:159]
  v_exp_f32 v22, v22
  v_exp_f32 v23, v23
  v_exp_f32 v24, v24
  v_mfma_f32_32x32x8bf16_1k v[32:47], v[108:109], v[92:93], v[32:47]
  v_exp_f32 v25, v25
  v_exp_f32 v26, v26
  v_exp_f32 v27, v27
  v_exp_f32 v28, v28
  v_exp_f32 v29, v29
  v_exp_f32 v30, v30
  v_exp_f32 v31, v31
  s_waitcnt lgkmcnt(0)
  v_smfmac_f32_32x32x32_bf16 v[48:63], v[120:123], v[16:23], v8
  v_exp_f32 v32, v32
  v_exp_f32 v33, v33
  v_exp_f32 v34, v34
  v_smfmac_f32_32x32x32_bf16 v[48:63], v[124:127], v[24:31], v8
  v_exp_f32 v35, v35
  v_exp_f32 v36, v36
  v_exp_f32 v37, v37
  v_mfma_f32_32x32x16_bf16 v[16:31], v[96:99], v[80:83], v[128:143]
  v_exp_f32 v38, v38
  v_exp_f32 v39, v39
  v_exp_f32 v40, v40
  v_mfma_f32_32x32x8bf16_1k v[16:31], v[100:101], v[84:85], v[16:31]
  v_exp_f32 v41, v41
  v_exp_f32 v42, v42
  v_exp_f32 v43, v43
  v_exp_f32 v44, v44
  v_exp_f32 v45, v45
  v_exp_f32 v46, v46
  v_exp_f32 v47, v47
  s_waitcnt vmcnt(4)
  s_barrier
  v_smfmac_f32_32x32x32_bf16 v[64:79], v[120:123], v[32:39], v8
  ds_read_b128 v[112:115], v2 offset:20480
  ds_read_b128 v[116:119], v2 offset:21504
  ds_read2st64_b64 v[104:107], v1 offset0:31 offset1:32
  ds_read_b64 v[108:109], v1 offset:16896
  v_exp_f32 v16, v16
  v_exp_f32 v17, v17
  v_exp_f32 v18, v18
  v_smfmac_f32_32x32x32_bf16 v[64:79], v[124:127], v[40:47], v8
  s_add_u32 m0, s33, 0
  s_add_u32 s31, s30, s27
  buffer_load_dwordx4 v5, s[8:11], s30 offen lds
  v_exp_f32 v19, v19
  v_exp_f32 v20, v20
  v_exp_f32 v21, v21
  v_mfma_f32_32x32x16_bf16 v[32:47], v[96:99], v[88:91], v[144:159]
  v_exp_f32 v22, v22
  v_exp_f32 v23, v23
  v_exp_f32 v24, v24
  v_mfma_f32_32x32x8bf16_1k v[32:47], v[100:101], v[92:93], v[32:47]
  v_exp_f32 v25, v25
  v_exp_f32 v26, v26
  v_exp_f32 v27, v27
  v_exp_f32 v28, v28
  v_exp_f32 v29, v29
  v_exp_f32 v30, v30
  v_exp_f32 v31, v31
  s_waitcnt lgkmcnt(0)
  v_smfmac_f32_32x32x32_bf16 v[48:63], v[112:115], v[16:23], v8
  v_exp_f32 v32, v32
  v_exp_f32 v33, v33
  v_exp_f32 v34, v34
  v_smfmac_f32_32x32x32_bf16 v[48:63], v[116:119], v[24:31], v8
  v_exp_f32 v35, v35
  v_exp_f32 v36, v36
  v_exp_f32 v37, v37
  v_mfma_f32_32x32x16_bf16 v[16:31], v[104:107], v[80:83], v[128:143]
  v_exp_f32 v38, v38
  v_exp_f32 v39, v39
  v_exp_f32 v40, v40
  v_mfma_f32_32x32x8bf16_1k v[16:31], v[108:109], v[84:85], v[16:31]
  v_exp_f32 v41, v41
  v_exp_f32 v42, v42
  v_exp_f32 v43, v43
  v_exp_f32 v44, v44
  v_exp_f32 v45, v45
  v_exp_f32 v46, v46
  v_exp_f32 v47, v47
  v_smfmac_f32_32x32x32_bf16 v[64:79], v[112:115], v[32:39], v8
  ds_read_b128 v[120:123], v2 offset:22528
  ds_read_b128 v[124:127], v2 offset:23552
  ds_read2st64_b64 v[96:99], v1 offset0:34 offset1:35
  ds_read_b64 v[100:101], v1 offset:18432
  v_exp_f32 v16, v16
  v_exp_f32 v17, v17
  v_exp_f32 v18, v18
  v_smfmac_f32_32x32x32_bf16 v[64:79], v[116:119], v[40:47], v8
  s_add_u32 m0, s37, 0
  s_nop 0
  buffer_load_dwordx4 v6, s[8:11], s30 offen lds
  v_exp_f32 v19, v19
  v_exp_f32 v20, v20
  v_exp_f32 v21, v21
  v_mfma_f32_32x32x16_bf16 v[32:47], v[104:107], v[88:91], v[144:159]
  v_exp_f32 v22, v22
  v_exp_f32 v23, v23
  v_exp_f32 v24, v24
  v_mfma_f32_32x32x8bf16_1k v[32:47], v[108:109], v[92:93], v[32:47]
  v_exp_f32 v25, v25
  v_exp_f32 v26, v26
  v_exp_f32 v27, v27
  v_exp_f32 v28, v28
  v_exp_f32 v29, v29
  v_exp_f32 v30, v30
  v_exp_f32 v31, v31
  s_waitcnt lgkmcnt(0)
  v_smfmac_f32_32x32x32_bf16 v[48:63], v[120:123], v[16:23], v8
  v_exp_f32 v32, v32
  v_exp_f32 v33, v33
  v_exp_f32 v34, v34
  v_smfmac_f32_32x32x32_bf16 v[48:63], v[124:127], v[24:31], v8
  v_exp_f32 v35, v35
  v_exp_f32 v36, v36
  v_exp_f32 v37, v37
  v_mfma_f32_32x32x16_bf16 v[16:31], v[96:99], v[80:83], v[128:143]
  v_exp_f32 v38, v38
  v_exp_f32 v39, v39
  v_exp_f32 v40, v40
  v_mfma_f32_32x32x8bf16_1k v[16:31], v[100:101], v[84:85], v[16:31]
  v_exp_f32 v41, v41
  v_exp_f32 v42, v42
  v_exp_f32 v43, v43
  v_exp_f32 v44, v44
  v_exp_f32 v45, v45
  v_exp_f32 v46, v46
  v_exp_f32 v47, v47
  v_smfmac_f32_32x32x32_bf16 v[64:79], v[120:123], v[32:39], v8
  ds_read_b128 v[112:115], v2 offset:24576
  ds_read_b128 v[116:119], v2 offset:25600
  ds_read2st64_b64 v[104:107], v1 offset0:37 offset1:38
  ds_read_b64 v[108:109], v1 offset:19968
  v_exp_f32 v16, v16
  v_exp_f32 v17, v17
  v_exp_f32 v18, v18
  v_smfmac_f32_32x32x32_bf16 v[64:79], v[124:127], v[40:47], v8
  s_add_u32 m0, s36, 0
  s_mov_b64 exec, s[40:41]
  buffer_load_dwordx4 v7, s[12:15], s31 offen lds
  buffer_load_dwordx4 v7, s[12:15], s31 offen offset:1024 lds
  s_mov_b64 exec, -1
  s_add_u32 s30, s30, 147456
  v_exp_f32 v19, v19
  v_exp_f32 v20, v20
  v_exp_f32 v21, v21
  v_mfma_f32_32x32x16_bf16 v[32:47], v[96:99], v[88:91], v[144:159]
  v_exp_f32 v22, v22
  v_exp_f32 v23, v23
  v_exp_f32 v24, v24
  v_mfma_f32_32x32x8bf16_1k v[32:47], v[100:101], v[92:93], v[32:47]
  v_exp_f32 v25, v25
  v_exp_f32 v26, v26
  v_exp_f32 v27, v27
  v_exp_f32 v28, v28
  v_exp_f32 v29, v29
  v_exp_f32 v30, v30
  v_exp_f32 v31, v31
  s_waitcnt lgkmcnt(0)
  v_smfmac_f32_32x32x32_bf16 v[48:63], v[112:115], v[16:23], v8
  v_exp_f32 v32, v32
  v_exp_f32 v33, v33
  v_exp_f32 v34, v34
  v_smfmac_f32_32x32x32_bf16 v[48:63], v[116:119], v[24:31], v8
  v_exp_f32 v35, v35
  v_exp_f32 v36, v36
  v_exp_f32 v37, v37
  v_mfma_f32_32x32x16_bf16 v[16:31], v[104:107], v[80:83], v[128:143]
  v_exp_f32 v38, v38
  v_exp_f32 v39, v39
  v_exp_f32 v40, v40
  v_mfma_f32_32x32x8bf16_1k v[16:31], v[108:109], v[84:85], v[16:31]
  v_exp_f32 v41, v41
  v_exp_f32 v42, v42
  v_exp_f32 v43, v43
  v_exp_f32 v44, v44
  v_exp_f32 v45, v45
  v_exp_f32 v46, v46
  v_exp_f32 v47, v47
  v_smfmac_f32_32x32x32_bf16 v[64:79], v[112:115], v[32:39], v8
  ds_read_b128 v[120:123], v2 offset:26624
  ds_read_b128 v[124:127], v2 offset:27648
  ds_read2st64_b64 v[96:99], v1 offset0:56 offset1:57
  ds_read_b64 v[100:101], v1 offset:29696
  v_exp_f32 v16, v16
  v_exp_f32 v17, v17
  v_exp_f32 v18, v18
  v_smfmac_f32_32x32x32_bf16 v[64:79], v[116:119], v[40:47], v8
  v_exp_f32 v19, v19
  v_exp_f32 v20, v20
  v_exp_f32 v21, v21
  v_mfma_f32_32x32x16_bf16 v[32:47], v[104:107], v[88:91], v[144:159]
  v_exp_f32 v22, v22
  v_exp_f32 v23, v23
  v_exp_f32 v24, v24
  v_mfma_f32_32x32x8bf16_1k v[32:47], v[108:109], v[92:93], v[32:47]
  v_exp_f32 v25, v25
  v_exp_f32 v26, v26
  v_exp_f32 v27, v27
  v_exp_f32 v28, v28
  v_exp_f32 v29, v29
  v_exp_f32 v30, v30
  v_exp_f32 v31, v31
  s_waitcnt lgkmcnt(0)
  v_smfmac_f32_32x32x32_bf16 v[48:63], v[120:123], v[16:23], v8
  v_exp_f32 v32, v32
  v_exp_f32 v33, v33
  v_exp_f32 v34, v34
  v_smfmac_f32_32x32x32_bf16 v[48:63], v[124:127], v[24:31], v8
  v_exp_f32 v35, v35
  v_exp_f32 v36, v36
  v_exp_f32 v37, v37
  v_mfma_f32_32x32x16_bf16 v[16:31], v[96:99], v[80:83], v[128:143]
  v_exp_f32 v38, v38
  v_exp_f32 v39, v39
  v_exp_f32 v40, v40
  v_mfma_f32_32x32x8bf16_1k v[16:31], v[100:101], v[84:85], v[16:31]
  v_exp_f32 v41, v41
  v_exp_f32 v42, v42
  v_exp_f32 v43, v43
  v_exp_f32 v44, v44
  v_exp_f32 v45, v45
  v_exp_f32 v46, v46
  v_exp_f32 v47, v47
  s_waitcnt vmcnt(4)
  s_barrier
  v_smfmac_f32_32x32x32_bf16 v[64:79], v[120:123], v[32:39], v8
  ds_read_b128 v[112:115], v2 offset:34816
  ds_read_b128 v[116:119], v2 offset:35840
  ds_read2st64_b64 v[104:107], v1 offset0:59 offset1:60
  ds_read_b64 v[108:109], v1 offset:31232
  v_exp_f32 v16, v16
  v_exp_f32 v17, v17
  v_exp_f32 v18, v18
  v_smfmac_f32_32x32x32_bf16 v[64:79], v[124:127], v[40:47], v8
  s_add_u32 m0, s33, 14336
  s_add_u32 s31, s30, s27
  buffer_load_dwordx4 v5, s[8:11], s30 offen lds
  v_exp_f32 v19, v19
  v_exp_f32 v20, v20
  v_exp_f32 v21, v21
  v_mfma_f32_32x32x16_bf16 v[32:47], v[96:99], v[88:91], v[144:159]
  v_exp_f32 v22, v22
  v_exp_f32 v23, v23
  v_exp_f32 v24, v24
  v_mfma_f32_32x32x8bf16_1k v[32:47], v[100:101], v[92:93], v[32:47]
  v_exp_f32 v25, v25
  v_exp_f32 v26, v26
  v_exp_f32 v27, v27
  v_exp_f32 v28, v28
  v_exp_f32 v29, v29
  v_exp_f32 v30, v30
  v_exp_f32 v31, v31
  s_waitcnt lgkmcnt(0)
  v_smfmac_f32_32x32x32_bf16 v[48:63], v[112:115], v[16:23], v8
  v_exp_f32 v32, v32
  v_exp_f32 v33, v33
  v_exp_f32 v34, v34
  v_smfmac_f32_32x32x32_bf16 v[48:63], v[116:119], v[24:31], v8
  v_exp_f32 v35, v35
  v_exp_f32 v36, v36
  v_exp_f32 v37, v37
  v_mfma_f32_32x32x16_bf16 v[16:31], v[104:107], v[80:83], v[128:143]
  v_exp_f32 v38, v38
  v_exp_f32 v39, v39
  v_exp_f32 v40, v40
  v_mfma_f32_32x32x8bf16_1k v[16:31], v[108:109], v[84:85], v[16:31]
  v_exp_f32 v41, v41
  v_exp_f32 v42, v42
  v_exp_f32 v43, v43
  v_exp_f32 v44, v44
  v_exp_f32 v45, v45
  v_exp_f32 v46, v46
  v_exp_f32 v47, v47
  v_smfmac_f32_32x32x32_bf16 v[64:79], v[112:115], v[32:39], v8
  ds_read_b128 v[120:123], v2 offset:36864
  ds_read_b128 v[124:127], v2 offset:37888
  ds_read2st64_b64 v[96:99], v1 offset0:62 offset1:63
  ds_read_b64 v[100:101], v1 offset:32768
  v_exp_f32 v16, v16
  v_exp_f32 v17, v17
  v_exp_f32 v18, v18
  v_smfmac_f32_32x32x32_bf16 v[64:79], v[116:119], v[40:47], v8
  s_add_u32 m0, s37, 14336
  s_nop 0
  buffer_load_dwordx4 v6, s[8:11], s30 offen lds
  v_exp_f32 v19, v19
  v_exp_f32 v20, v20
  v_exp_f32 v21, v21
  v_mfma_f32_32x32x16_bf16 v[32:47], v[104:107], v[88:91], v[144:159]
  v_exp_f32 v22, v22
  v_exp_f32 v23, v23
  v_exp_f32 v24, v24
  v_mfma_f32_32x32x8bf16_1k v[32:47], v[108:109], v[92:93], v[32:47]
  v_exp_f32 v25, v25
  v_exp_f32 v26, v26
  v_exp_f32 v27, v27
  v_exp_f32 v28, v28
  v_exp_f32 v29, v29
  v_exp_f32 v30, v30
  v_exp_f32 v31, v31
  s_waitcnt lgkmcnt(0)
  v_smfmac_f32_32x32x32_bf16 v[48:63], v[120:123], v[16:23], v8
  v_exp_f32 v32, v32
  v_exp_f32 v33, v33
  v_exp_f32 v34, v34
  v_smfmac_f32_32x32x32_bf16 v[48:63], v[124:127], v[24:31], v8
  v_exp_f32 v35, v35
  v_exp_f32 v36, v36
  v_exp_f32 v37, v37
  v_mfma_f32_32x32x16_bf16 v[16:31], v[96:99], v[80:83], v[128:143]
  v_exp_f32 v38, v38
  v_exp_f32 v39, v39
  v_exp_f32 v40, v40
  v_mfma_f32_32x32x8bf16_1k v[16:31], v[100:101], v[84:85], v[16:31]
  v_exp_f32 v41, v41
  v_exp_f32 v42, v42
  v_exp_f32 v43, v43
  v_exp_f32 v44, v44
  v_exp_f32 v45, v45
  v_exp_f32 v46, v46
  v_exp_f32 v47, v47
  v_smfmac_f32_32x32x32_bf16 v[64:79], v[120:123], v[32:39], v8
  ds_read_b128 v[112:115], v2 offset:38912
  ds_read_b128 v[116:119], v2 offset:39936
  ds_read2st64_b64 v[104:107], v1 offset0:65 offset1:66
  ds_read_b64 v[108:109], v1 offset:34304
  v_exp_f32 v16, v16
  v_exp_f32 v17, v17
  v_exp_f32 v18, v18
  v_smfmac_f32_32x32x32_bf16 v[64:79], v[124:127], v[40:47], v8
  s_add_u32 m0, s36, 14336
  s_mov_b64 exec, s[40:41]
  buffer_load_dwordx4 v7, s[12:15], s31 offen lds
  buffer_load_dwordx4 v7, s[12:15], s31 offen offset:1024 lds
  s_mov_b64 exec, -1
  s_add_u32 s30, s30, 147456
  v_exp_f32 v19, v19
  v_exp_f32 v20, v20
  v_exp_f32 v21, v21
  v_mfma_f32_32x32x16_bf16 v[32:47], v[96:99], v[88:91], v[144:159]
  v_exp_f32 v22, v22
  v_exp_f32 v23, v23
  v_exp_f32 v24, v24
  v_mfma_f32_32x32x8bf16_1k v[32:47], v[100:101], v[92:93], v[32:47]
  v_exp_f32 v25, v25
  v_exp_f32 v26, v26
  v_exp_f32 v27, v27
  v_exp_f32 v28, v28
  v_exp_f32 v29, v29
  v_exp_f32 v30, v30
  v_exp_f32 v31, v31
  s_waitcnt lgkmcnt(0)
  v_smfmac_f32_32x32x32_bf16 v[48:63], v[112:115], v[16:23], v8
  v_exp_f32 v32, v32
  v_exp_f32 v33, v33
  v_exp_f32 v34, v34
  v_smfmac_f32_32x32x32_bf16 v[48:63], v[116:119], v[24:31], v8
  v_exp_f32 v35, v35
  v_exp_f32 v36, v36
  v_exp_f32 v37, v37
  v_mfma_f32_32x32x16_bf16 v[16:31], v[104:107], v[80:83], v[128:143]
  v_exp_f32 v38, v38
  v_exp_f32 v39, v39
  v_exp_f32 v40, v40
  v_mfma_f32_32x32x8bf16_1k v[16:31], v[108:109], v[84:85], v[16:31]
  v_exp_f32 v41, v41
  v_exp_f32 v42, v42
  v_exp_f32 v43, v43
  v_exp_f32 v44, v44
  v_exp_f32 v45, v45
  v_exp_f32 v46, v46
  v_exp_f32 v47, v47
  v_smfmac_f32_32x32x32_bf16 v[64:79], v[112:115], v[32:39], v8
  ds_read_b128 v[120:123], v2 offset:40960
  ds_read_b128 v[124:127], v2 offset:41984
  ds_read2st64_b64 v[96:99], v1 offset0:84 offset1:85
  ds_read_b64 v[100:101], v1 offset:44032
  v_exp_f32 v16, v16
  v_exp_f32 v17, v17
  v_exp_f32 v18, v18
  v_smfmac_f32_32x32x32_bf16 v[64:79], v[116:119], v[40:47], v8
  v_exp_f32 v19, v19
  v_exp_f32 v20, v20
  v_exp_f32 v21, v21
  v_mfma_f32_32x32x16_bf16 v[32:47], v[104:107], v[88:91], v[144:159]
  v_exp_f32 v22, v22
  v_exp_f32 v23, v23
  v_exp_f32 v24, v24
  v_mfma_f32_32x32x8bf16_1k v[32:47], v[108:109], v[92:93], v[32:47]
  v_exp_f32 v25, v25
  v_exp_f32 v26, v26
  v_exp_f32 v27, v27
  v_exp_f32 v28, v28
  v_exp_f32 v29, v29
  v_exp_f32 v30, v30
  v_exp_f32 v31, v31
  s_waitcnt lgkmcnt(0)
  v_smfmac_f32_32x32x32_bf16 v[48:63], v[120:123], v[16:23], v8
  v_exp_f32 v32, v32
  v_exp_f32 v33, v33
  v_exp_f32 v34, v34
  v_smfmac_f32_32x32x32_bf16 v[48:63], v[124:127], v[24:31], v8
  v_exp_f32 v35, v35
  v_exp_f32 v36, v36
  v_exp_f32 v37, v37
  v_mfma_f32_32x32x16_bf16 v[16:31], v[96:99], v[80:83], v[128:143]
  v_exp_f32 v38, v38
  v_exp_f32 v39, v39
  v_exp_f32 v40, v40
  v_mfma_f32_32x32x8bf16_1k v[16:31], v[100:101], v[84:85], v[16:31]
  v_exp_f32 v41, v41
  v_exp_f32 v42, v42
  v_exp_f32 v43, v43
  v_exp_f32 v44, v44
  v_exp_f32 v45, v45
  v_exp_f32 v46, v46
  v_exp_f32 v47, v47
  s_waitcnt vmcnt(4)
  s_barrier
  v_smfmac_f32_32x32x32_bf16 v[64:79], v[120:123], v[32:39], v8
  ds_read_b128 v[112:115], v2 offset:49152
  ds_read_b128 v[116:119], v2 offset:50176
  ds_read2st64_b64 v[104:107], v1 offset0:87 offset1:88
  ds_read_b64 v[108:109], v1 offset:45568
  v_exp_f32 v16, v16
  v_exp_f32 v17, v17
  v_exp_f32 v18, v18
  v_smfmac_f32_32x32x32_bf16 v[64:79], v[124:127], v[40:47], v8
  s_add_u32 m0, s33, 28672
  s_add_u32 s31, s30, s27
  buffer_load_dwordx4 v5, s[8:11], s30 offen lds
  v_exp_f32 v19, v19
  v_exp_f32 v20, v20
  v_exp_f32 v21, v21
  v_mfma_f32_32x32x16_bf16 v[32:47], v[96:99], v[88:91], v[144:159]
  v_exp_f32 v22, v22
  v_exp_f32 v23, v23
  v_exp_f32 v24, v24
  v_mfma_f32_32x32x8bf16_1k v[32:47], v[100:101], v[92:93], v[32:47]
  v_exp_f32 v25, v25
  v_exp_f32 v26, v26
  v_exp_f32 v27, v27
  v_exp_f32 v28, v28
  v_exp_f32 v29, v29
  v_exp_f32 v30, v30
  v_exp_f32 v31, v31
  s_waitcnt lgkmcnt(0)
  v_smfmac_f32_32x32x32_bf16 v[48:63], v[112:115], v[16:23], v8
  v_exp_f32 v32, v32
  v_exp_f32 v33, v33
  v_exp_f32 v34, v34
  v_smfmac_f32_32x32x32_bf16 v[48:63], v[116:119], v[24:31], v8
  v_exp_f32 v35, v35
  v_exp_f32 v36, v36
  v_exp_f32 v37, v37
  v_mfma_f32_32x32x16_bf16 v[16:31], v[104:107], v[80:83], v[128:143]
  v_exp_f32 v38, v38
  v_exp_f32 v39, v39
  v_exp_f32 v40, v40
  v_mfma_f32_32x32x8bf16_1k v[16:31], v[108:109], v[84:85], v[16:31]
  v_exp_f32 v41, v41
  v_exp_f32 v42, v42
  v_exp_f32 v43, v43
  v_exp_f32 v44, v44
  v_exp_f32 v45, v45
  v_exp_f32 v46, v46
  v_exp_f32 v47, v47
  v_smfmac_f32_32x32x32_bf16 v[64:79], v[112:115], v[32:39], v8
  ds_read_b128 v[120:123], v2 offset:51200
  ds_read_b128 v[124:127], v2 offset:52224
  ds_read2st64_b64 v[96:99], v1 offset0:90 offset1:91
  ds_read_b64 v[100:101], v1 offset:47104
  v_exp_f32 v16, v16
  v_exp_f32 v17, v17
  v_exp_f32 v18, v18
  v_smfmac_f32_32x32x32_bf16 v[64:79], v[116:119], v[40:47], v8
  s_add_u32 m0, s37, 28672
  s_nop 0
  buffer_load_dwordx4 v6, s[8:11], s30 offen lds
  v_exp_f32 v19, v19
  v_exp_f32 v20, v20
  v_exp_f32 v21, v21
  v_mfma_f32_32x32x16_bf16 v[32:47], v[104:107], v[88:91], v[144:159]
  v_exp_f32 v22, v22
  v_exp_f32 v23, v23
  v_exp_f32 v24, v24
  v_mfma_f32_32x32x8bf16_1k v[32:47], v[108:109], v[92:93], v[32:47]
  v_exp_f32 v25, v25
  v_exp_f32 v26, v26
  v_exp_f32 v27, v27
  v_exp_f32 v28, v28
  v_exp_f32 v29, v29
  v_exp_f32 v30, v30
  v_exp_f32 v31, v31
  s_waitcnt lgkmcnt(0)
  v_smfmac_f32_32x32x32_bf16 v[48:63], v[120:123], v[16:23], v8
  v_exp_f32 v32, v32
  v_exp_f32 v33, v33
  v_exp_f32 v34, v34
  v_smfmac_f32_32x32x32_bf16 v[48:63], v[124:127], v[24:31], v8
  v_exp_f32 v35, v35
  v_exp_f32 v36, v36
  v_exp_f32 v37, v37
  v_mfma_f32_32x32x16_bf16 v[16:31], v[96:99], v[80:83], v[128:143]
  v_exp_f32 v38, v38
  v_exp_f32 v39, v39
  v_exp_f32 v40, v40
  v_mfma_f32_32x32x8bf16_1k v[16:31], v[100:101], v[84:85], v[16:31]
  v_exp_f32 v41, v41
  v_exp_f32 v42, v42
  v_exp_f32 v43, v43
  v_exp_f32 v44, v44
  v_exp_f32 v45, v45
  v_exp_f32 v46, v46
  v_exp_f32 v47, v47
  v_smfmac_f32_32x32x32_bf16 v[64:79], v[120:123], v[32:39], v8
  ds_read_b128 v[112:115], v2 offset:53248
  ds_read_b128 v[116:119], v2 offset:54272
  ds_read2st64_b64 v[104:107], v1 offset0:93 offset1:94
  ds_read_b64 v[108:109], v1 offset:48640
  v_exp_f32 v16, v16
  v_exp_f32 v17, v17
  v_exp_f32 v18, v18
  v_smfmac_f32_32x32x32_bf16 v[64:79], v[124:127], v[40:47], v8
  s_add_u32 m0, s36, 28672
  s_mov_b64 exec, s[40:41]
  buffer_load_dwordx4 v7, s[12:15], s31 offen lds
  buffer_load_dwordx4 v7, s[12:15], s31 offen offset:1024 lds
  s_mov_b64 exec, -1
  s_add_u32 s30, s30, 147456
  v_exp_f32 v19, v19
  v_exp_f32 v20, v20
  v_exp_f32 v21, v21
  v_mfma_f32_32x32x16_bf16 v[32:47], v[96:99], v[88:91], v[144:159]
  v_exp_f32 v22, v22
  v_exp_f32 v23, v23
  v_exp_f32 v24, v24
  v_mfma_f32_32x32x8bf16_1k v[32:47], v[100:101], v[92:93], v[32:47]
  v_exp_f32 v25, v25
  v_exp_f32 v26, v26
  v_exp_f32 v27, v27
  v_exp_f32 v28, v28
  v_exp_f32 v29, v29
  v_exp_f32 v30, v30
  v_exp_f32 v31, v31
  s_waitcnt lgkmcnt(0)
  v_smfmac_f32_32x32x32_bf16 v[48:63], v[112:115], v[16:23], v8
  v_exp_f32 v32, v32
  v_exp_f32 v33, v33
  v_exp_f32 v34, v34
  v_smfmac_f32_32x32x32_bf16 v[48:63], v[116:119], v[24:31], v8
  v_exp_f32 v35, v35
  v_exp_f32 v36, v36
  v_exp_f32 v37, v37
  v_mfma_f32_32x32x16_bf16 v[16:31], v[104:107], v[80:83], v[128:143]
  v_exp_f32 v38, v38
  v_exp_f32 v39, v39
  v_exp_f32 v40, v40
  v_mfma_f32_32x32x8bf16_1k v[16:31], v[108:109], v[84:85], v[16:31]
  v_exp_f32 v41, v41
  v_exp_f32 v42, v42
  v_exp_f32 v43, v43
  v_exp_f32 v44, v44
  v_exp_f32 v45, v45
  v_exp_f32 v46, v46
  v_exp_f32 v47, v47
  v_smfmac_f32_32x32x32_bf16 v[64:79], v[112:115], v[32:39], v8
  ds_read_b128 v[120:123], v2 offset:55296
  ds_read_b128 v[124:127], v2 offset:56320
  ds_read2st64_b64 v[96:99], v1 offset0:0 offset1:1
  ds_read_b64 v[100:101], v1 offset:1024
  v_exp_f32 v16, v16
  v_exp_f32 v17, v17
  v_exp_f32 v18, v18
  v_smfmac_f32_32x32x32_bf16 v[64:79], v[116:119], v[40:47], v8
  v_exp_f32 v19, v19
  v_exp_f32 v20, v20
  v_exp_f32 v21, v21
  v_mfma_f32_32x32x16_bf16 v[32:47], v[104:107], v[88:91], v[144:159]
  v_exp_f32 v22, v22
  v_exp_f32 v23, v23
  v_exp_f32 v24, v24
  v_mfma_f32_32x32x8bf16_1k v[32:47], v[108:109], v[92:93], v[32:47]
  v_exp_f32 v25, v25
  v_exp_f32 v26, v26
  v_exp_f32 v27, v27
  v_exp_f32 v28, v28
  v_exp_f32 v29, v29
  v_exp_f32 v30, v30
  v_exp_f32 v31, v31
  s_waitcnt lgkmcnt(0)
  v_smfmac_f32_32x32x32_bf16 v[48:63], v[120:123], v[16:23], v8
  v_exp_f32 v32, v32
  v_exp_f32 v33, v33
  v_exp_f32 v34, v34
  v_smfmac_f32_32x32x32_bf16 v[48:63], v[124:127], v[24:31], v8
  v_exp_f32 v35, v35
  v_exp_f32 v36, v36
  v_exp_f32 v37, v37
  v_mfma_f32_32x32x16_bf16 v[16:31], v[96:99], v[80:83], v[128:143]
  v_exp_f32 v38, v38
  v_exp_f32 v39, v39
  v_exp_f32 v40, v40
  v_mfma_f32_32x32x8bf16_1k v[16:31], v[100:101], v[84:85], v[16:31]
  v_exp_f32 v41, v41
  v_exp_f32 v42, v42
  v_exp_f32 v43, v43
  v_exp_f32 v44, v44
  v_exp_f32 v45, v45
  v_exp_f32 v46, v46
  v_exp_f32 v47, v47
  s_sub_u32 s29, s29, 1
  s_cmp_lg_u32 s29, 0
  s_cbranch_scc1 L_at_loop2
  s_nop 1
  v_smfmac_f32_32x32x32_bf16 v[64:79], v[120:123], v[32:39], v8
  v_smfmac_f32_32x32x32_bf16 v[64:79], v[124:127], v[40:47], v8
  s_waitcnt vmcnt(0) lgkmcnt(0)
  s_nop 7
  s_nop 3
  v_mov_b32 v9, v58
  v_mov_b32 v11, v58
  s_nop 1
  v_permlane32_swap_b32 v9, v11
  v_mov_b32 v10, v74
  v_mov_b32 v11, v74
  s_nop 1
  v_permlane32_swap_b32 v10, v11
  v_rcp_f32 v9, v9
  s_nop 0
  v_mul_f32 v48, v48, v9
  v_mul_f32 v49, v49, v9
  v_mul_f32 v50, v50, v9
  v_mul_f32 v51, v51, v9
  v_mul_f32 v52, v52, v9
  v_mul_f32 v53, v53, v9
  v_mul_f32 v54, v54, v9
  v_mul_f32 v55, v55, v9
  v_mul_f32 v56, v56, v9
  v_mul_f32 v57, v57, v9
  v_cvt_pk_bf16_f32 v16, v48, v49
  v_cvt_pk_bf16_f32 v17, v50, v51
  v_cvt_pk_bf16_f32 v18, v52, v53
  v_cvt_pk_bf16_f32 v19, v54, v55
  v_cvt_pk_bf16_f32 v20, v56, v57
  v_rcp_f32 v10, v10
  s_nop 0
  v_mul_f32 v64, v64, v10
  v_mul_f32 v65, v65, v10
  v_mul_f32 v66, v66, v10
  v_mul_f32 v67, v67, v10
  v_mul_f32 v68, v68, v10
  v_mul_f32 v69, v69, v10
  v_mul_f32 v70, v70, v10
  v_mul_f32 v71, v71, v10
  v_mul_f32 v72, v72, v10
  v_mul_f32 v73, v73, v10
  v_cvt_pk_bf16_f32 v24, v64, v65
  v_cvt_pk_bf16_f32 v25, v66, v67
  v_cvt_pk_bf16_f32 v26, v68, v69
  v_cvt_pk_bf16_f32 v27, v70, v71
  v_cvt_pk_bf16_f32 v28, v72, v73
  v_bfe_u32 v9, v0, 4, 1
  v_lshlrev_b32 v9, 10, v9
  v_lshrrev_b32 v10, 5, v0
  v_lshl_add_u32 v11, v10, 8, v9
  v_and_b32 v10, 15, v0
  v_lshl_add_u32 v11, v10, 4, v11
  v_lshl_add_u32 v9, v10, 4, v9
  s_mul_i32 s32, s35, 18
  s_lshr_b32 s33, s25, 1
  s_add_u32 s32, s32, s33
  s_lshl_b32 s32, s32, 11
  s_and_b32 s33, s25, 1
  s_lshl_b32 s33, s33, 9
  s_add_u32 s32, s32, s33
  buffer_store_dwordx4 v[16:19], v11, s[20:23], s32 offen sc1
  s_add_u32 s33, s32, 36864
  buffer_store_dwordx4 v[24:27], v11, s[20:23], s33 offen sc1
  s_mul_i32 s32, s35, 18
  s_lshr_b32 s33, s25, 4
  s_add_u32 s32, s32, s33
  s_add_u32 s32, s32, 16
  s_lshl_b32 s32, s32, 11
  s_bfe_u32 s33, s25, 0x20002
  s_lshl_b32 s33, s33, 8
  s_add_u32 s32, s32, s33
  s_and_b32 s33, s25, 3
  s_lshl_b32 s33, s33, 2
  s_add_u32 s32, s32, s33
  s_mov_b32 exec_hi, 0
  buffer_store_dword v20, v9, s[20:23], s32 offen sc1
  s_add_u32 s32, s32, 36864
  buffer_store_dword v28, v9, s[20:23], s32 offen sc1
  s_mov_b64 exec, -1
L_at_out:
  s_waitcnt vmcnt(0)
  s_barrier
  s_cmp_lg_u32 s24, 0
  s_cbranch_scc1 L_siga
  s_lshl_b32 s32, s26, 3
  s_lshl_b32 s32, s32, 7
  s_add_u32 s32, s32, 50216960
  v_lshlrev_b32 v9, 7, v0
  v_add_u32 v9, s32, v9
  v_mov_b32 v10, 1
  s_mov_b64 exec, 255
  global_atomic_add v9, v10, s[4:5] sc1
  s_mov_b64 exec, -1
L_siga:
  s_branch L_mix_done
L_mix_second:
  s_load_dwordx2 s[4:5], s[0:1], 72
  s_load_dwordx2 s[6:7], s[0:1], 48
  v_readfirstlane_b32 s24, v0
  v_and_b32 v0, 63, v0
  s_lshr_b32 s24, s24, 6
  s_and_b32 s25, s2, 7
  s_bfe_u32 s27, s2, 0x10003
  s_bfe_u32 s26, s2, 0x40004
  s_lshl_b32 s26, s26, 2
  s_add_u32 s26, s26, s24
  s_lshl_b32 s35, s24, 10
  v_lshlrev_b32 v1, 4, v0
  v_lshrrev_b32 v10, 5, v0
  v_lshlrev_b32 v10, 4, v10
  v_bfe_u32 v11, v0, 4, 1
  v_lshl_add_u32 v10, v11, 2, v10
  v_bfe_u32 v9, v0, 2, 2
  v_add_u32 v10, v10, v9
  v_mul_u32_u24 v10, 576, v10
  v_and_b32 v9, 3, v0
  v_lshl_add_u32 v10, v9, 3, v10
  v_lshlrev_b32 v11, 5, v11
  v_add_u32 v2, v10, v11
  v_sub_u32 v88, v10, v11
  v_mov_b32 v84, v2
  v_mov_b32 v85, v88
  v_lshrrev_b32 v10, 5, v0
  v_lshlrev_b32 v10, 10, v10
  v_bfe_u32 v11, v0, 4, 1
  v_lshl_add_u32 v10, v11, 9, v10
  v_and_b32 v11, 15, v0
  v_lshl_add_u32 v3, v11, 4, v10
  v_bfe_u32 v10, v0, 4, 1
  v_lshlrev_b32 v10, 9, v10
  v_lshl_add_u32 v10, v11, 4, v10
  v_lshrrev_b32 v11, 5, v0
  v_lshl_add_u32 v89, v11, 3, v10
  s_add_u32 s33, s24, 0
  s_lshl_b32 s34, s33, 10
  v_add_u32 v10, s34, v1
  v_lshrrev_b32 v11, 6, v10
  v_mul_u32_u24 v11, 7282, v11
  v_lshrrev_b32 v11, 16, v11
  v_mul_u32_u24 v11, 576, v11
  v_add_u32 v4, v10, v11
  v_lshrrev_b32 v11, 6, v10
  v_mul_u32_u24 v11, 7282, v11
  v_lshrrev_b32 v11, 16, v11
  v_mul_u32_u24 v9, 576, v11
  v_sub_u32 v9, v10, v9
  v_bfe_u32 v11, v11, 2, 1
  v_lshlrev_b32 v11, 5, v11
  v_xor_b32 v11, v9, v11
  v_sub_u32 v11, v11, v9
  v_add_u32 v4, v4, v11
  s_add_u32 s33, s24, 4
  s_lshl_b32 s34, s33, 10
  v_add_u32 v10, s34, v1
  v_lshrrev_b32 v11, 6, v10
  v_mul_u32_u24 v11, 7282, v11
  v_lshrrev_b32 v11, 16, v11
  v_mul_u32_u24 v11, 576, v11
  v_add_u32 v5, v10, v11
  v_lshrrev_b32 v11, 6, v10
  v_mul_u32_u24 v11, 7282, v11
  v_lshrrev_b32 v11, 16, v11
  v_mul_u32_u24 v9, 576, v11
  v_sub_u32 v9, v10, v9
  v_bfe_u32 v11, v11, 2, 1
  v_lshlrev_b32 v11, 5, v11
  v_xor_b32 v11, v9, v11
  v_sub_u32 v11, v11, v9
  v_add_u32 v5, v5, v11
  s_add_u32 s33, s24, 8
  s_lshl_b32 s34, s33, 10
  v_add_u32 v10, s34, v1
  v_lshrrev_b32 v11, 6, v10
  v_mul_u32_u24 v11, 7282, v11
  v_lshrrev_b32 v11, 16, v11
  v_mul_u32_u24 v11, 576, v11
  v_add_u32 v6, v10, v11
  v_lshrrev_b32 v11, 6, v10
  v_mul_u32_u24 v11, 7282, v11
  v_lshrrev_b32 v11, 16, v11
  v_mul_u32_u24 v9, 576, v11
  v_sub_u32 v9, v10, v9
  v_bfe_u32 v11, v11, 2, 1
  v_lshlrev_b32 v11, 5, v11
  v_xor_b32 v11, v9, v11
  v_sub_u32 v11, v11, v9
  v_add_u32 v6, v6, v11
  s_add_u32 s33, s24, 12
  s_lshl_b32 s34, s33, 10
  v_add_u32 v10, s34, v1
  v_lshrrev_b32 v11, 6, v10
  v_mul_u32_u24 v11, 7282, v11
  v_lshrrev_b32 v11, 16, v11
  v_mul_u32_u24 v11, 576, v11
  v_add_u32 v7, v10, v11
  v_lshrrev_b32 v11, 6, v10
  v_mul_u32_u24 v11, 7282, v11
  v_lshrrev_b32 v11, 16, v11
  v_mul_u32_u24 v9, 576, v11
  v_sub_u32 v9, v10, v9
  v_bfe_u32 v11, v11, 2, 1
  v_lshlrev_b32 v11, 5, v11
  v_xor_b32 v11, v9, v11
  v_sub_u32 v11, v11, v9
  v_add_u32 v7, v7, v11
  s_add_u32 s33, s24, 16
  s_lshl_b32 s34, s33, 10
  v_add_u32 v10, s34, v1
  v_lshrrev_b32 v11, 6, v10
  v_mul_u32_u24 v11, 7282, v11
  v_lshrrev_b32 v11, 16, v11
  v_mul_u32_u24 v11, 576, v11
  v_add_u32 v8, v10, v11
  v_lshrrev_b32 v11, 6, v10
  v_mul_u32_u24 v11, 7282, v11
  v_lshrrev_b32 v11, 16, v11
  v_mul_u32_u24 v9, 576, v11
  v_sub_u32 v9, v10, v9
  v_bfe_u32 v11, v11, 2, 1
  v_lshlrev_b32 v11, 5, v11
  v_xor_b32 v11, v9, v11
  v_sub_u32 v11, v11, v9
  v_add_u32 v8, v8, v11
  s_cmp_ge_u32 s33, 18
  s_cselect_b32 s34, 0x7f000000, 0
  v_add_u32 v8, s34, v8
  s_waitcnt lgkmcnt(0)
  s_mov_b32 s8, s6
  s_mov_b32 s9, s7
  s_mov_b32 s10, 5308416
  s_mov_b32 s11, 0x20000
  s_add_u32 s12, s4, 11796480
  s_addc_u32 s13, s5, 0
  s_mov_b32 s14, 18874368
  s_mov_b32 s15, 0x20000
  s_add_u32 s16, s4, 30670848
  s_addc_u32 s17, s5, 0
  s_mov_b32 s18, 18874368
  s_mov_b32 s19, 0x20000
  s_mul_i32 s30, s25, 663552
  s_mul_i32 s33, s27, 576
  s_add_u32 s30, s30, s33
  s_mul_i32 s31, s26, 288
  s_mul_i32 s33, s25, 36
  s_add_u32 s31, s31, s33
  s_lshl_b32 s31, s31, 10
  s_mov_b32 s29, s35
  s_mov_b32 s28, 0
  s_add_u32 m0, s29, 0
  s_nop 0
  buffer_load_dwordx4 v4, s[8:11], s30 offen lds
  s_add_u32 m0, s29, 4096
  s_nop 0
  buffer_load_dwordx4 v5, s[8:11], s30 offen lds
  s_add_u32 m0, s29, 8192
  s_nop 0
  buffer_load_dwordx4 v6, s[8:11], s30 offen lds
  s_add_u32 m0, s29, 12288
  s_nop 0
  buffer_load_dwordx4 v7, s[8:11], s30 offen lds
  s_add_u32 m0, s29, 16384
  s_nop 0
  buffer_load_dwordx4 v8, s[8:11], s30 offen lds
  s_add_u32 s30, s30, 36864
  s_add_u32 s29, s29, 20480
  s_cmp_ge_u32 s29, 81920
  s_cselect_b32 s33, 81920, 0
  s_sub_u32 s29, s29, s33
  buffer_load_dwordx4 v[36:39], v3, s[12:15], s31 offen offset:0
  buffer_load_dwordx4 v[40:43], v3, s[12:15], s31 offen offset:256
  s_add_u32 s31, s31, 2048
  s_add_u32 m0, s29, 0
  s_nop 0
  buffer_load_dwordx4 v4, s[8:11], s30 offen lds
  s_add_u32 m0, s29, 4096
  s_nop 0
  buffer_load_dwordx4 v5, s[8:11], s30 offen lds
  s_add_u32 m0, s29, 8192
  s_nop 0
  buffer_load_dwordx4 v6, s[8:11], s30 offen lds
  s_add_u32 m0, s29, 12288
  s_nop 0
  buffer_load_dwordx4 v7, s[8:11], s30 offen lds
  s_add_u32 m0, s29, 16384
  s_nop 0
  buffer_load_dwordx4 v8, s[8:11], s30 offen lds
  s_add_u32 s30, s30, 36864
  s_add_u32 s29, s29, 20480
  s_cmp_ge_u32 s29, 81920
  s_cselect_b32 s33, 81920, 0
  s_sub_u32 s29, s29, s33
  buffer_load_dwordx4 v[44:47], v3, s[12:15], s31 offen offset:0
  buffer_load_dwordx4 v[48:51], v3, s[12:15], s31 offen offset:256
  s_add_u32 s31, s31, 2048
  buffer_load_dwordx4 v[52:55], v3, s[12:15], s31 offen offset:0
  buffer_load_dwordx4 v[56:59], v3, s[12:15], s31 offen offset:256
  s_add_u32 s31, s31, 2048
  s_add_u32 m0, s29, 0
  s_nop 0
  buffer_load_dwordx4 v4, s[8:11], s30 offen lds
  s_add_u32 m0, s29, 4096
  s_nop 0
  buffer_load_dwordx4 v5, s[8:11], s30 offen lds
  s_add_u32 m0, s29, 8192
  s_nop 0
  buffer_load_dwordx4 v6, s[8:11], s30 offen lds
  s_add_u32 m0, s29, 12288
  s_nop 0
  buffer_load_dwordx4 v7, s[8:11], s30 offen lds
  s_add_u32 m0, s29, 16384
  s_nop 0
  buffer_load_dwordx4 v8, s[8:11], s30 offen lds
  s_add_u32 s30, s30, 36864
  s_add_u32 s29, s29, 20480
  s_cmp_ge_u32 s29, 81920
  s_cselect_b32 s33, 81920, 0
  s_sub_u32 s29, s29, s33
  buffer_load_dwordx4 v[60:63], v3, s[12:15], s31 offen offset:0
  buffer_load_dwordx4 v[64:67], v3, s[12:15], s31 offen offset:256
  s_add_u32 s31, s31, 2048
  buffer_load_dwordx4 v[68:71], v3, s[12:15], s31 offen offset:0
  buffer_load_dwordx4 v[72:75], v3, s[12:15], s31 offen offset:256
  s_add_u32 s31, s31, 2048
  v_mov_b32 v96, 0
  v_mov_b32 v97, 0
  v_mov_b32 v98, 0
  v_mov_b32 v99, 0
  v_mov_b32 v100, 0
  v_mov_b32 v101, 0
  v_mov_b32 v102, 0
  v_mov_b32 v103, 0
  v_mov_b32 v104, 0
  v_mov_b32 v105, 0
  v_mov_b32 v106, 0
  v_mov_b32 v107, 0
  v_mov_b32 v108, 0
  v_mov_b32 v109, 0
  v_mov_b32 v110, 0
  v_mov_b32 v111, 0
  v_mov_b32 v112, 0
  v_mov_b32 v113, 0
  v_mov_b32 v114, 0
  v_mov_b32 v115, 0
  v_mov_b32 v116, 0
  v_mov_b32 v117, 0
  v_mov_b32 v118, 0
  v_mov_b32 v119, 0
  v_mov_b32 v120, 0
  v_mov_b32 v121, 0
  v_mov_b32 v122, 0
  v_mov_b32 v123, 0
  v_mov_b32 v124, 0
  v_mov_b32 v125, 0
  v_mov_b32 v126, 0
  v_mov_b32 v127, 0
  v_mov_b32 v128, 0
  v_mov_b32 v129, 0
  v_mov_b32 v130, 0
  v_mov_b32 v131, 0
  v_mov_b32 v132, 0
  v_mov_b32 v133, 0
  v_mov_b32 v134, 0
  v_mov_b32 v135, 0
  v_mov_b32 v136, 0
  v_mov_b32 v137, 0
  v_mov_b32 v138, 0
  v_mov_b32 v139, 0
  v_mov_b32 v140, 0
  v_mov_b32 v141, 0
  v_mov_b32 v142, 0
  v_mov_b32 v143, 0
  v_mov_b32 v144, 0
  v_mov_b32 v145, 0
  v_mov_b32 v146, 0
  v_mov_b32 v147, 0
  v_mov_b32 v148, 0
  v_mov_b32 v149, 0
  v_mov_b32 v150, 0
  v_mov_b32 v151, 0
  v_mov_b32 v152, 0
  v_mov_b32 v153, 0
  v_mov_b32 v154, 0
  v_mov_b32 v155, 0
  v_mov_b32 v156, 0
  v_mov_b32 v157, 0
  v_mov_b32 v158, 0
  v_mov_b32 v159, 0
  v_mov_b32 v160, 0
  v_mov_b32 v161, 0
  v_mov_b32 v162, 0
  v_mov_b32 v163, 0
  v_mov_b32 v164, 0
  v_mov_b32 v165, 0
  v_mov_b32 v166, 0
  v_mov_b32 v167, 0
  v_mov_b32 v168, 0
  v_mov_b32 v169, 0
  v_mov_b32 v170, 0
  v_mov_b32 v171, 0
  v_mov_b32 v172, 0
  v_mov_b32 v173, 0
  v_mov_b32 v174, 0
  v_mov_b32 v175, 0
  v_mov_b32 v176, 0
  v_mov_b32 v177, 0
  v_mov_b32 v178, 0
  v_mov_b32 v179, 0
  v_mov_b32 v180, 0
  v_mov_b32 v181, 0
  v_mov_b32 v182, 0
  v_mov_b32 v183, 0
  v_mov_b32 v184, 0
  v_mov_b32 v185, 0
  v_mov_b32 v186, 0
  v_mov_b32 v187, 0
  v_mov_b32 v188, 0
  v_mov_b32 v189, 0
  v_mov_b32 v190, 0
  v_mov_b32 v191, 0
  v_mov_b32 v192, 0
  v_mov_b32 v193, 0
  v_mov_b32 v194, 0
  v_mov_b32 v195, 0
  v_mov_b32 v196, 0
  v_mov_b32 v197, 0
  v_mov_b32 v198, 0
  v_mov_b32 v199, 0
  v_mov_b32 v200, 0
  v_mov_b32 v201, 0
  v_mov_b32 v202, 0
  v_mov_b32 v203, 0
  v_mov_b32 v204, 0
  v_mov_b32 v205, 0
  v_mov_b32 v206, 0
  v_mov_b32 v207, 0
  v_mov_b32 v208, 0
  v_mov_b32 v209, 0
  v_mov_b32 v210, 0
  v_mov_b32 v211, 0
  v_mov_b32 v212, 0
  v_mov_b32 v213, 0
  v_mov_b32 v214, 0
  v_mov_b32 v215, 0
  v_mov_b32 v216, 0
  v_mov_b32 v217, 0
  v_mov_b32 v218, 0
  v_mov_b32 v219, 0
  v_mov_b32 v220, 0
  v_mov_b32 v221, 0
  v_mov_b32 v222, 0
  v_mov_b32 v223, 0
  v_mov_b32 v224, 0
  v_mov_b32 v225, 0
  v_mov_b32 v226, 0
  v_mov_b32 v227, 0
  v_mov_b32 v228, 0
  v_mov_b32 v229, 0
  v_mov_b32 v230, 0
  v_mov_b32 v231, 0
  v_mov_b32 v232, 0
  v_mov_b32 v233, 0
  v_mov_b32 v234, 0
  v_mov_b32 v235, 0
  v_mov_b32 v236, 0
  v_mov_b32 v237, 0
  v_mov_b32 v238, 0
  v_mov_b32 v239, 0
  s_waitcnt vmcnt(20)
  s_barrier
  ds_read_b64_tr_b16 v[12:13], v84 offset:0
  ds_read_b64_tr_b16 v[14:15], v84 offset:4608
  ds_read_b64_tr_b16 v[16:17], v85 offset:32
  ds_read_b64_tr_b16 v[18:19], v85 offset:4640
  ds_read_b64_tr_b16 v[20:21], v84 offset:64
  ds_read_b64_tr_b16 v[22:23], v84 offset:4672
  ds_read_b64_tr_b16 v[24:25], v85 offset:96
  ds_read_b64_tr_b16 v[26:27], v85 offset:4704
  ds_read_b64_tr_b16 v[28:29], v84 offset:128
  ds_read_b64_tr_b16 v[30:31], v84 offset:4736
  ds_read_b64_tr_b16 v[32:33], v85 offset:160
  ds_read_b64_tr_b16 v[34:35], v85 offset:4768
  s_mov_b32 s32, 3
  s_setprio 2
L_dn_loop:
  s_waitcnt vmcnt(7)
  s_barrier
  s_waitcnt lgkmcnt(10)
  v_mfma_f32_16x16x32_bf16 v[96:99], v[12:15], v[36:39], v[96:99]
  ds_read_b64_tr_b16 v[240:241], v84 offset:192
  v_mfma_f32_16x16x32_bf16 v[100:103], v[12:15], v[40:43], v[100:103]
  ds_read_b64_tr_b16 v[242:243], v84 offset:4800
  s_waitcnt lgkmcnt(10)
  v_mfma_f32_16x16x32_bf16 v[104:107], v[16:19], v[36:39], v[104:107]
  ds_read_b64_tr_b16 v[244:245], v85 offset:224
  v_mfma_f32_16x16x32_bf16 v[108:111], v[16:19], v[40:43], v[108:111]
  ds_read_b64_tr_b16 v[246:247], v85 offset:4832
  buffer_load_dwordx4 v[76:79], v3, s[12:15], s31 offen offset:0
  s_waitcnt lgkmcnt(10)
  v_mfma_f32_16x16x32_bf16 v[112:115], v[20:23], v[36:39], v[112:115]
  ds_read_b64_tr_b16 v[248:249], v84 offset:256
  v_mfma_f32_16x16x32_bf16 v[116:119], v[20:23], v[40:43], v[116:119]
  ds_read_b64_tr_b16 v[250:251], v84 offset:4864
  s_add_u32 m0, s29, 0
  s_nop 0
  buffer_load_dwordx4 v4, s[8:11], s30 offen lds
  s_waitcnt lgkmcnt(10)
  v_mfma_f32_16x16x32_bf16 v[120:123], v[24:27], v[36:39], v[120:123]
  ds_read_b64_tr_b16 v[12:13], v85 offset:288
  v_mfma_f32_16x16x32_bf16 v[124:127], v[24:27], v[40:43], v[124:127]
  ds_read_b64_tr_b16 v[14:15], v85 offset:4896
  s_waitcnt lgkmcnt(10)
  v_mfma_f32_16x16x32_bf16 v[128:131], v[28:31], v[36:39], v[128:131]
  ds_read_b64_tr_b16 v[16:17], v84 offset:320
  v_mfma_f32_16x16x32_bf16 v[132:135], v[28:31], v[40:43], v[132:135]
  ds_read_b64_tr_b16 v[18:19], v84 offset:4928
  s_waitcnt lgkmcnt(10)
  v_mfma_f32_16x16x32_bf16 v[136:139], v[32:35], v[36:39], v[136:139]
  ds_read_b64_tr_b16 v[20:21], v85 offset:352
  v_mfma_f32_16x16x32_bf16 v[140:143], v[32:35], v[40:43], v[140:143]
  ds_read_b64_tr_b16 v[22:23], v85 offset:4960
  s_add_u32 m0, s29, 4096
  s_nop 0
  buffer_load_dwordx4 v5, s[8:11], s30 offen lds
  s_waitcnt lgkmcnt(10)
  v_mfma_f32_16x16x32_bf16 v[144:147], v[240:243], v[36:39], v[144:147]
  ds_read_b64_tr_b16 v[24:25], v84 offset:384
  v_mfma_f32_16x16x32_bf16 v[148:151], v[240:243], v[40:43], v[148:151]
  ds_read_b64_tr_b16 v[26:27], v84 offset:4992
  s_waitcnt lgkmcnt(10)
  v_mfma_f32_16x16x32_bf16 v[152:155], v[244:247], v[36:39], v[152:155]
  ds_read_b64_tr_b16 v[28:29], v85 offset:416
  v_mfma_f32_16x16x32_bf16 v[156:159], v[244:247], v[40:43], v[156:159]
  ds_read_b64_tr_b16 v[30:31], v85 offset:5024
  s_waitcnt lgkmcnt(10)
  v_mfma_f32_16x16x32_bf16 v[160:163], v[248:251], v[36:39], v[160:163]
  ds_read_b64_tr_b16 v[32:33], v84 offset:448
  v_mfma_f32_16x16x32_bf16 v[164:167], v[248:251], v[40:43], v[164:167]
  ds_read_b64_tr_b16 v[34:35], v84 offset:5056
  s_add_u32 m0, s29, 8192
  s_nop 0
  buffer_load_dwordx4 v6, s[8:11], s30 offen lds
  s_waitcnt lgkmcnt(10)
  v_mfma_f32_16x16x32_bf16 v[168:171], v[12:15], v[36:39], v[168:171]
  ds_read_b64_tr_b16 v[240:241], v85 offset:480
  v_mfma_f32_16x16x32_bf16 v[172:175], v[12:15], v[40:43], v[172:175]
  ds_read_b64_tr_b16 v[242:243], v85 offset:5088
  s_waitcnt lgkmcnt(10)
  v_mfma_f32_16x16x32_bf16 v[176:179], v[16:19], v[36:39], v[176:179]
  s_add_u32 s28, s28, 20480
  s_cmp_eq_u32 s28, 81920
  s_cselect_b32 s28, 0, s28
  v_add_u32 v86, s28, v2
  v_add_u32 v87, s28, v88
  ds_read_b64_tr_b16 v[244:245], v84 offset:512
  v_mfma_f32_16x16x32_bf16 v[180:183], v[16:19], v[40:43], v[180:183]
  ds_read_b64_tr_b16 v[246:247], v84 offset:5120
  buffer_load_dwordx4 v[80:83], v3, s[12:15], s31 offen offset:256
  s_add_u32 s31, s31, 2048
  s_cmp_eq_u32 s32, 1
  s_cselect_b32 s14, 0, 18874368
  s_waitcnt lgkmcnt(10)
  v_mfma_f32_16x16x32_bf16 v[184:187], v[20:23], v[36:39], v[184:187]
  ds_read_b64_tr_b16 v[248:249], v85 offset:544
  v_mfma_f32_16x16x32_bf16 v[188:191], v[20:23], v[40:43], v[188:191]
  ds_read_b64_tr_b16 v[250:251], v85 offset:5152
  s_add_u32 m0, s29, 12288
  s_nop 0
  buffer_load_dwordx4 v7, s[8:11], s30 offen lds
  s_waitcnt lgkmcnt(10)
  v_mfma_f32_16x16x32_bf16 v[192:195], v[24:27], v[36:39], v[192:195]
  ds_read_b64_tr_b16 v[12:13], v86 offset:0
  v_mfma_f32_16x16x32_bf16 v[196:199], v[24:27], v[40:43], v[196:199]
  ds_read_b64_tr_b16 v[14:15], v86 offset:4608
  s_waitcnt lgkmcnt(10)
  v_mfma_f32_16x16x32_bf16 v[200:203], v[28:31], v[36:39], v[200:203]
  ds_read_b64_tr_b16 v[16:17], v87 offset:32
  v_mfma_f32_16x16x32_bf16 v[204:207], v[28:31], v[40:43], v[204:207]
  ds_read_b64_tr_b16 v[18:19], v87 offset:4640
  s_waitcnt lgkmcnt(10)
  v_mfma_f32_16x16x32_bf16 v[208:211], v[32:35], v[36:39], v[208:211]
  ds_read_b64_tr_b16 v[20:21], v86 offset:64
  v_mfma_f32_16x16x32_bf16 v[212:215], v[32:35], v[40:43], v[212:215]
  ds_read_b64_tr_b16 v[22:23], v86 offset:4672
  s_add_u32 m0, s29, 16384
  s_nop 0
  buffer_load_dwordx4 v8, s[8:11], s30 offen lds
  s_waitcnt lgkmcnt(10)
  v_mfma_f32_16x16x32_bf16 v[216:219], v[240:243], v[36:39], v[216:219]
  ds_read_b64_tr_b16 v[24:25], v87 offset:96
  v_mfma_f32_16x16x32_bf16 v[220:223], v[240:243], v[40:43], v[220:223]
  ds_read_b64_tr_b16 v[26:27], v87 offset:4704
  s_add_u32 s30, s30, 36864
  s_add_u32 s29, s29, 20480
  s_cmp_ge_u32 s29, 81920
  s_cselect_b32 s33, 81920, 0
  s_sub_u32 s29, s29, s33
  s_waitcnt lgkmcnt(10)
  v_mfma_f32_16x16x32_bf16 v[224:227], v[244:247], v[36:39], v[224:227]
  ds_read_b64_tr_b16 v[28:29], v86 offset:128
  v_mfma_f32_16x16x32_bf16 v[228:231], v[244:247], v[40:43], v[228:231]
  ds_read_b64_tr_b16 v[30:31], v86 offset:4736
  s_waitcnt lgkmcnt(10)
  v_mfma_f32_16x16x32_bf16 v[232:235], v[248:251], v[36:39], v[232:235]
  ds_read_b64_tr_b16 v[32:33], v87 offset:160
  v_mfma_f32_16x16x32_bf16 v[236:239], v[248:251], v[40:43], v[236:239]
  ds_read_b64_tr_b16 v[34:35], v87 offset:4768
  s_waitcnt vmcnt(7)
  s_barrier
  s_waitcnt lgkmcnt(10)
  v_mfma_f32_16x16x32_bf16 v[96:99], v[12:15], v[44:47], v[96:99]
  ds_read_b64_tr_b16 v[240:241], v86 offset:192
  v_mfma_f32_16x16x32_bf16 v[100:103], v[12:15], v[48:51], v[100:103]
  ds_read_b64_tr_b16 v[242:243], v86 offset:4800
  s_waitcnt lgkmcnt(10)
  v_mfma_f32_16x16x32_bf16 v[104:107], v[16:19], v[44:47], v[104:107]
  ds_read_b64_tr_b16 v[244:245], v87 offset:224
  v_mfma_f32_16x16x32_bf16 v[108:111], v[16:19], v[48:51], v[108:111]
  ds_read_b64_tr_b16 v[246:247], v87 offset:4832
  buffer_load_dwordx4 v[36:39], v3, s[12:15], s31 offen offset:0
  s_waitcnt lgkmcnt(10)
  v_mfma_f32_16x16x32_bf16 v[112:115], v[20:23], v[44:47], v[112:115]
  ds_read_b64_tr_b16 v[248:249], v86 offset:256
  v_mfma_f32_16x16x32_bf16 v[116:119], v[20:23], v[48:51], v[116:119]
  ds_read_b64_tr_b16 v[250:251], v86 offset:4864
  s_add_u32 m0, s29, 0
  s_nop 0
  buffer_load_dwordx4 v4, s[8:11], s30 offen lds
  s_waitcnt lgkmcnt(10)
  v_mfma_f32_16x16x32_bf16 v[120:123], v[24:27], v[44:47], v[120:123]
  ds_read_b64_tr_b16 v[12:13], v87 offset:288
  v_mfma_f32_16x16x32_bf16 v[124:127], v[24:27], v[48:51], v[124:127]
  ds_read_b64_tr_b16 v[14:15], v87 offset:4896
  s_waitcnt lgkmcnt(10)
  v_mfma_f32_16x16x32_bf16 v[128:131], v[28:31], v[44:47], v[128:131]
  ds_read_b64_tr_b16 v[16:17], v86 offset:320
  v_mfma_f32_16x16x32_bf16 v[132:135], v[28:31], v[48:51], v[132:135]
  ds_read_b64_tr_b16 v[18:19], v86 offset:4928
  s_waitcnt lgkmcnt(10)
  v_mfma_f32_16x16x32_bf16 v[136:139], v[32:35], v[44:47], v[136:139]
  ds_read_b64_tr_b16 v[20:21], v87 offset:352
  v_mfma_f32_16x16x32_bf16 v[140:143], v[32:35], v[48:51], v[140:143]
  ds_read_b64_tr_b16 v[22:23], v87 offset:4960
  s_add_u32 m0, s29, 4096
  s_nop 0
  buffer_load_dwordx4 v5, s[8:11], s30 offen lds
  s_waitcnt lgkmcnt(10)
  v_mfma_f32_16x16x32_bf16 v[144:147], v[240:243], v[44:47], v[144:147]
  ds_read_b64_tr_b16 v[24:25], v86 offset:384
  v_mfma_f32_16x16x32_bf16 v[148:151], v[240:243], v[48:51], v[148:151]
  ds_read_b64_tr_b16 v[26:27], v86 offset:4992
  s_waitcnt lgkmcnt(10)
  v_mfma_f32_16x16x32_bf16 v[152:155], v[244:247], v[44:47], v[152:155]
  ds_read_b64_tr_b16 v[28:29], v87 offset:416
  v_mfma_f32_16x16x32_bf16 v[156:159], v[244:247], v[48:51], v[156:159]
  ds_read_b64_tr_b16 v[30:31], v87 offset:5024
  s_waitcnt lgkmcnt(10)
  v_mfma_f32_16x16x32_bf16 v[160:163], v[248:251], v[44:47], v[160:163]
  ds_read_b64_tr_b16 v[32:33], v86 offset:448
  v_mfma_f32_16x16x32_bf16 v[164:167], v[248:251], v[48:51], v[164:167]
  ds_read_b64_tr_b16 v[34:35], v86 offset:5056
  s_add_u32 m0, s29, 8192
  s_nop 0
  buffer_load_dwordx4 v6, s[8:11], s30 offen lds
  s_waitcnt lgkmcnt(10)
  v_mfma_f32_16x16x32_bf16 v[168:171], v[12:15], v[44:47], v[168:171]
  ds_read_b64_tr_b16 v[240:241], v87 offset:480
  v_mfma_f32_16x16x32_bf16 v[172:175], v[12:15], v[48:51], v[172:175]
  ds_read_b64_tr_b16 v[242:243], v87 offset:5088
  s_waitcnt lgkmcnt(10)
  v_mfma_f32_16x16x32_bf16 v[176:179], v[16:19], v[44:47], v[176:179]
  s_add_u32 s28, s28, 20480
  s_cmp_eq_u32 s28, 81920
  s_cselect_b32 s28, 0, s28
  v_add_u32 v84, s28, v2
  v_add_u32 v85, s28, v88
  ds_read_b64_tr_b16 v[244:245], v86 offset:512
  v_mfma_f32_16x16x32_bf16 v[180:183], v[16:19], v[48:51], v[180:183]
  ds_read_b64_tr_b16 v[246:247], v86 offset:5120
  buffer_load_dwordx4 v[40:43], v3, s[12:15], s31 offen offset:256
  s_add_u32 s31, s31, 2048
  s_waitcnt lgkmcnt(10)
  v_mfma_f32_16x16x32_bf16 v[184:187], v[20:23], v[44:47], v[184:187]
  ds_read_b64_tr_b16 v[248:249], v87 offset:544
  v_mfma_f32_16x16x32_bf16 v[188:191], v[20:23], v[48:51], v[188:191]
  ds_read_b64_tr_b16 v[250:251], v87 offset:5152
  s_add_u32 m0, s29, 12288
  s_nop 0
  buffer_load_dwordx4 v7, s[8:11], s30 offen lds
  s_waitcnt lgkmcnt(10)
  v_mfma_f32_16x16x32_bf16 v[192:195], v[24:27], v[44:47], v[192:195]
  ds_read_b64_tr_b16 v[12:13], v84 offset:0
  v_mfma_f32_16x16x32_bf16 v[196:199], v[24:27], v[48:51], v[196:199]
  ds_read_b64_tr_b16 v[14:15], v84 offset:4608
  s_waitcnt lgkmcnt(10)
  v_mfma_f32_16x16x32_bf16 v[200:203], v[28:31], v[44:47], v[200:203]
  ds_read_b64_tr_b16 v[16:17], v85 offset:32
  v_mfma_f32_16x16x32_bf16 v[204:207], v[28:31], v[48:51], v[204:207]
  ds_read_b64_tr_b16 v[18:19], v85 offset:4640
  s_waitcnt lgkmcnt(10)
  v_mfma_f32_16x16x32_bf16 v[208:211], v[32:35], v[44:47], v[208:211]
  ds_read_b64_tr_b16 v[20:21], v84 offset:64
  v_mfma_f32_16x16x32_bf16 v[212:215], v[32:35], v[48:51], v[212:215]
  ds_read_b64_tr_b16 v[22:23], v84 offset:4672
  s_add_u32 m0, s29, 16384
  s_nop 0
  buffer_load_dwordx4 v8, s[8:11], s30 offen lds
  s_waitcnt lgkmcnt(10)
  v_mfma_f32_16x16x32_bf16 v[216:219], v[240:243], v[44:47], v[216:219]
  ds_read_b64_tr_b16 v[24:25], v85 offset:96
  v_mfma_f32_16x16x32_bf16 v[220:223], v[240:243], v[48:51], v[220:223]
  ds_read_b64_tr_b16 v[26:27], v85 offset:4704
  s_add_u32 s30, s30, 36864
  s_add_u32 s29, s29, 20480
  s_cmp_ge_u32 s29, 81920
  s_cselect_b32 s33, 81920, 0
  s_sub_u32 s29, s29, s33
  s_waitcnt lgkmcnt(10)
  v_mfma_f32_16x16x32_bf16 v[224:227], v[244:247], v[44:47], v[224:227]
  ds_read_b64_tr_b16 v[28:29], v84 offset:128
  v_mfma_f32_16x16x32_bf16 v[228:231], v[244:247], v[48:51], v[228:231]
  ds_read_b64_tr_b16 v[30:31], v84 offset:4736
  s_waitcnt lgkmcnt(10)
  v_mfma_f32_16x16x32_bf16 v[232:235], v[248:251], v[44:47], v[232:235]
  ds_read_b64_tr_b16 v[32:33], v85 offset:160
  v_mfma_f32_16x16x32_bf16 v[236:239], v[248:251], v[48:51], v[236:239]
  ds_read_b64_tr_b16 v[34:35], v85 offset:4768
  s_waitcnt vmcnt(7)
  s_barrier
  s_waitcnt lgkmcnt(10)
  v_mfma_f32_16x16x32_bf16 v[96:99], v[12:15], v[52:55], v[96:99]
  ds_read_b64_tr_b16 v[240:241], v84 offset:192
  v_mfma_f32_16x16x32_bf16 v[100:103], v[12:15], v[56:59], v[100:103]
  ds_read_b64_tr_b16 v[242:243], v84 offset:4800
  s_waitcnt lgkmcnt(10)
  v_mfma_f32_16x16x32_bf16 v[104:107], v[16:19], v[52:55], v[104:107]
  ds_read_b64_tr_b16 v[244:245], v85 offset:224
  v_mfma_f32_16x16x32_bf16 v[108:111], v[16:19], v[56:59], v[108:111]
  ds_read_b64_tr_b16 v[246:247], v85 offset:4832
  buffer_load_dwordx4 v[44:47], v3, s[12:15], s31 offen offset:0
  s_waitcnt lgkmcnt(10)
  v_mfma_f32_16x16x32_bf16 v[112:115], v[20:23], v[52:55], v[112:115]
  ds_read_b64_tr_b16 v[248:249], v84 offset:256
  v_mfma_f32_16x16x32_bf16 v[116:119], v[20:23], v[56:59], v[116:119]
  ds_read_b64_tr_b16 v[250:251], v84 offset:4864
  s_add_u32 m0, s29, 0
  s_nop 0
  buffer_load_dwordx4 v4, s[8:11], s30 offen lds
  s_waitcnt lgkmcnt(10)
  v_mfma_f32_16x16x32_bf16 v[120:123], v[24:27], v[52:55], v[120:123]
  ds_read_b64_tr_b16 v[12:13], v85 offset:288
  v_mfma_f32_16x16x32_bf16 v[124:127], v[24:27], v[56:59], v[124:127]
  ds_read_b64_tr_b16 v[14:15], v85 offset:4896
  s_waitcnt lgkmcnt(10)
  v_mfma_f32_16x16x32_bf16 v[128:131], v[28:31], v[52:55], v[128:131]
  ds_read_b64_tr_b16 v[16:17], v84 offset:320
  v_mfma_f32_16x16x32_bf16 v[132:135], v[28:31], v[56:59], v[132:135]
  ds_read_b64_tr_b16 v[18:19], v84 offset:4928
  s_waitcnt lgkmcnt(10)
  v_mfma_f32_16x16x32_bf16 v[136:139], v[32:35], v[52:55], v[136:139]
  ds_read_b64_tr_b16 v[20:21], v85 offset:352
  v_mfma_f32_16x16x32_bf16 v[140:143], v[32:35], v[56:59], v[140:143]
  ds_read_b64_tr_b16 v[22:23], v85 offset:4960
  s_add_u32 m0, s29, 4096
  s_nop 0
  buffer_load_dwordx4 v5, s[8:11], s30 offen lds
  s_waitcnt lgkmcnt(10)
  v_mfma_f32_16x16x32_bf16 v[144:147], v[240:243], v[52:55], v[144:147]
  ds_read_b64_tr_b16 v[24:25], v84 offset:384
  v_mfma_f32_16x16x32_bf16 v[148:151], v[240:243], v[56:59], v[148:151]
  ds_read_b64_tr_b16 v[26:27], v84 offset:4992
  s_waitcnt lgkmcnt(10)
  v_mfma_f32_16x16x32_bf16 v[152:155], v[244:247], v[52:55], v[152:155]
  ds_read_b64_tr_b16 v[28:29], v85 offset:416
  v_mfma_f32_16x16x32_bf16 v[156:159], v[244:247], v[56:59], v[156:159]
  ds_read_b64_tr_b16 v[30:31], v85 offset:5024
  s_waitcnt lgkmcnt(10)
  v_mfma_f32_16x16x32_bf16 v[160:163], v[248:251], v[52:55], v[160:163]
  ds_read_b64_tr_b16 v[32:33], v84 offset:448
  v_mfma_f32_16x16x32_bf16 v[164:167], v[248:251], v[56:59], v[164:167]
  ds_read_b64_tr_b16 v[34:35], v84 offset:5056
  s_add_u32 m0, s29, 8192
  s_nop 0
  buffer_load_dwordx4 v6, s[8:11], s30 offen lds
  s_waitcnt lgkmcnt(10)
  v_mfma_f32_16x16x32_bf16 v[168:171], v[12:15], v[52:55], v[168:171]
  ds_read_b64_tr_b16 v[240:241], v85 offset:480
  v_mfma_f32_16x16x32_bf16 v[172:175], v[12:15], v[56:59], v[172:175]
  ds_read_b64_tr_b16 v[242:243], v85 offset:5088
  s_waitcnt lgkmcnt(10)
  v_mfma_f32_16x16x32_bf16 v[176:179], v[16:19], v[52:55], v[176:179]
  s_add_u32 s28, s28, 20480
  s_cmp_eq_u32 s28, 81920
  s_cselect_b32 s28, 0, s28
  v_add_u32 v86, s28, v2
  v_add_u32 v87, s28, v88
  ds_read_b64_tr_b16 v[244:245], v84 offset:512
  v_mfma_f32_16x16x32_bf16 v[180:183], v[16:19], v[56:59], v[180:183]
  ds_read_b64_tr_b16 v[246:247], v84 offset:5120
  buffer_load_dwordx4 v[48:51], v3, s[12:15], s31 offen offset:256
  s_add_u32 s31, s31, 2048
  s_waitcnt lgkmcnt(10)
  v_mfma_f32_16x16x32_bf16 v[184:187], v[20:23], v[52:55], v[184:187]
  ds_read_b64_tr_b16 v[248:249], v85 offset:544
  v_mfma_f32_16x16x32_bf16 v[188:191], v[20:23], v[56:59], v[188:191]
  ds_read_b64_tr_b16 v[250:251], v85 offset:5152
  s_add_u32 m0, s29, 12288
  s_nop 0
  buffer_load_dwordx4 v7, s[8:11], s30 offen lds
  s_waitcnt lgkmcnt(10)
  v_mfma_f32_16x16x32_bf16 v[192:195], v[24:27], v[52:55], v[192:195]
  ds_read_b64_tr_b16 v[12:13], v86 offset:0
  v_mfma_f32_16x16x32_bf16 v[196:199], v[24:27], v[56:59], v[196:199]
  ds_read_b64_tr_b16 v[14:15], v86 offset:4608
  s_waitcnt lgkmcnt(10)
  v_mfma_f32_16x16x32_bf16 v[200:203], v[28:31], v[52:55], v[200:203]
  ds_read_b64_tr_b16 v[16:17], v87 offset:32
  v_mfma_f32_16x16x32_bf16 v[204:207], v[28:31], v[56:59], v[204:207]
  ds_read_b64_tr_b16 v[18:19], v87 offset:4640
  s_waitcnt lgkmcnt(10)
  v_mfma_f32_16x16x32_bf16 v[208:211], v[32:35], v[52:55], v[208:211]
  ds_read_b64_tr_b16 v[20:21], v86 offset:64
  v_mfma_f32_16x16x32_bf16 v[212:215], v[32:35], v[56:59], v[212:215]
  ds_read_b64_tr_b16 v[22:23], v86 offset:4672
  s_add_u32 m0, s29, 16384
  s_nop 0
  buffer_load_dwordx4 v8, s[8:11], s30 offen lds
  s_waitcnt lgkmcnt(10)
  v_mfma_f32_16x16x32_bf16 v[216:219], v[240:243], v[52:55], v[216:219]
  ds_read_b64_tr_b16 v[24:25], v87 offset:96
  v_mfma_f32_16x16x32_bf16 v[220:223], v[240:243], v[56:59], v[220:223]
  ds_read_b64_tr_b16 v[26:27], v87 offset:4704
  s_add_u32 s30, s30, 36864
  s_add_u32 s29, s29, 20480
  s_cmp_ge_u32 s29, 81920
  s_cselect_b32 s33, 81920, 0
  s_sub_u32 s29, s29, s33
  s_waitcnt lgkmcnt(10)
  v_mfma_f32_16x16x32_bf16 v[224:227], v[244:247], v[52:55], v[224:227]
  ds_read_b64_tr_b16 v[28:29], v86 offset:128
  v_mfma_f32_16x16x32_bf16 v[228:231], v[244:247], v[56:59], v[228:231]
  ds_read_b64_tr_b16 v[30:31], v86 offset:4736
  s_waitcnt lgkmcnt(10)
  v_mfma_f32_16x16x32_bf16 v[232:235], v[248:251], v[52:55], v[232:235]
  ds_read_b64_tr_b16 v[32:33], v87 offset:160
  v_mfma_f32_16x16x32_bf16 v[236:239], v[248:251], v[56:59], v[236:239]
  ds_read_b64_tr_b16 v[34:35], v87 offset:4768
  s_waitcnt vmcnt(7)
  s_barrier
  s_waitcnt lgkmcnt(10)
  v_mfma_f32_16x16x32_bf16 v[96:99], v[12:15], v[60:63], v[96:99]
  ds_read_b64_tr_b16 v[240:241], v86 offset:192
  v_mfma_f32_16x16x32_bf16 v[100:103], v[12:15], v[64:67], v[100:103]
  ds_read_b64_tr_b16 v[242:243], v86 offset:4800
  s_cmp_eq_u32 s32, 1
  s_cselect_b32 s10, 0, 5308416
  s_waitcnt lgkmcnt(10)
  v_mfma_f32_16x16x32_bf16 v[104:107], v[16:19], v[60:63], v[104:107]
  ds_read_b64_tr_b16 v[244:245], v87 offset:224
  v_mfma_f32_16x16x32_bf16 v[108:111], v[16:19], v[64:67], v[108:111]
  ds_read_b64_tr_b16 v[246:247], v87 offset:4832
  buffer_load_dwordx4 v[52:55], v3, s[12:15], s31 offen offset:0
  s_waitcnt lgkmcnt(10)
  v_mfma_f32_16x16x32_bf16 v[112:115], v[20:23], v[60:63], v[112:115]
  ds_read_b64_tr_b16 v[248:249], v86 offset:256
  v_mfma_f32_16x16x32_bf16 v[116:119], v[20:23], v[64:67], v[116:119]
  ds_read_b64_tr_b16 v[250:251], v86 offset:4864
  s_add_u32 m0, s29, 0
  s_nop 0
  buffer_load_dwordx4 v4, s[8:11], s30 offen lds
  s_waitcnt lgkmcnt(10)
  v_mfma_f32_16x16x32_bf16 v[120:123], v[24:27], v[60:63], v[120:123]
  ds_read_b64_tr_b16 v[12:13], v87 offset:288
  v_mfma_f32_16x16x32_bf16 v[124:127], v[24:27], v[64:67], v[124:127]
  ds_read_b64_tr_b16 v[14:15], v87 offset:4896
  s_waitcnt lgkmcnt(10)
  v_mfma_f32_16x16x32_bf16 v[128:131], v[28:31], v[60:63], v[128:131]
  ds_read_b64_tr_b16 v[16:17], v86 offset:320
  v_mfma_f32_16x16x32_bf16 v[132:135], v[28:31], v[64:67], v[132:135]
  ds_read_b64_tr_b16 v[18:19], v86 offset:4928
  s_waitcnt lgkmcnt(10)
  v_mfma_f32_16x16x32_bf16 v[136:139], v[32:35], v[60:63], v[136:139]
  ds_read_b64_tr_b16 v[20:21], v87 offset:352
  v_mfma_f32_16x16x32_bf16 v[140:143], v[32:35], v[64:67], v[140:143]
  ds_read_b64_tr_b16 v[22:23], v87 offset:4960
  s_add_u32 m0, s29, 4096
  s_nop 0
  buffer_load_dwordx4 v5, s[8:11], s30 offen lds
  s_waitcnt lgkmcnt(10)
  v_mfma_f32_16x16x32_bf16 v[144:147], v[240:243], v[60:63], v[144:147]
  ds_read_b64_tr_b16 v[24:25], v86 offset:384
  v_mfma_f32_16x16x32_bf16 v[148:151], v[240:243], v[64:67], v[148:151]
  ds_read_b64_tr_b16 v[26:27], v86 offset:4992
  s_waitcnt lgkmcnt(10)
  v_mfma_f32_16x16x32_bf16 v[152:155], v[244:247], v[60:63], v[152:155]
  ds_read_b64_tr_b16 v[28:29], v87 offset:416
  v_mfma_f32_16x16x32_bf16 v[156:159], v[244:247], v[64:67], v[156:159]
  ds_read_b64_tr_b16 v[30:31], v87 offset:5024
  s_waitcnt lgkmcnt(10)
  v_mfma_f32_16x16x32_bf16 v[160:163], v[248:251], v[60:63], v[160:163]
  ds_read_b64_tr_b16 v[32:33], v86 offset:448
  v_mfma_f32_16x16x32_bf16 v[164:167], v[248:251], v[64:67], v[164:167]
  ds_read_b64_tr_b16 v[34:35], v86 offset:5056
  s_add_u32 m0, s29, 8192
  s_nop 0
  buffer_load_dwordx4 v6, s[8:11], s30 offen lds
  s_waitcnt lgkmcnt(10)
  v_mfma_f32_16x16x32_bf16 v[168:171], v[12:15], v[60:63], v[168:171]
  ds_read_b64_tr_b16 v[240:241], v87 offset:480
  v_mfma_f32_16x16x32_bf16 v[172:175], v[12:15], v[64:67], v[172:175]
  ds_read_b64_tr_b16 v[242:243], v87 offset:5088
  s_waitcnt lgkmcnt(10)
  v_mfma_f32_16x16x32_bf16 v[176:179], v[16:19], v[60:63], v[176:179]
  s_add_u32 s28, s28, 20480
  s_cmp_eq_u32 s28, 81920
  s_cselect_b32 s28, 0, s28
  v_add_u32 v84, s28, v2
  v_add_u32 v85, s28, v88
  ds_read_b64_tr_b16 v[244:245], v86 offset:512
  v_mfma_f32_16x16x32_bf16 v[180:183], v[16:19], v[64:67], v[180:183]
  ds_read_b64_tr_b16 v[246:247], v86 offset:5120
  buffer_load_dwordx4 v[56:59], v3, s[12:15], s31 offen offset:256
  s_add_u32 s31, s31, 2048
  s_waitcnt lgkmcnt(10)
  v_mfma_f32_16x16x32_bf16 v[184:187], v[20:23], v[60:63], v[184:187]
  ds_read_b64_tr_b16 v[248:249], v87 offset:544
  v_mfma_f32_16x16x32_bf16 v[188:191], v[20:23], v[64:67], v[188:191]
  ds_read_b64_tr_b16 v[250:251], v87 offset:5152
  s_add_u32 m0, s29, 12288
  s_nop 0
  buffer_load_dwordx4 v7, s[8:11], s30 offen lds
  s_waitcnt lgkmcnt(10)
  v_mfma_f32_16x16x32_bf16 v[192:195], v[24:27], v[60:63], v[192:195]
  ds_read_b64_tr_b16 v[12:13], v84 offset:0
  v_mfma_f32_16x16x32_bf16 v[196:199], v[24:27], v[64:67], v[196:199]
  ds_read_b64_tr_b16 v[14:15], v84 offset:4608
  s_waitcnt lgkmcnt(10)
  v_mfma_f32_16x16x32_bf16 v[200:203], v[28:31], v[60:63], v[200:203]
  ds_read_b64_tr_b16 v[16:17], v85 offset:32
  v_mfma_f32_16x16x32_bf16 v[204:207], v[28:31], v[64:67], v[204:207]
  ds_read_b64_tr_b16 v[18:19], v85 offset:4640
  s_waitcnt lgkmcnt(10)
  v_mfma_f32_16x16x32_bf16 v[208:211], v[32:35], v[60:63], v[208:211]
  ds_read_b64_tr_b16 v[20:21], v84 offset:64
  v_mfma_f32_16x16x32_bf16 v[212:215], v[32:35], v[64:67], v[212:215]
  ds_read_b64_tr_b16 v[22:23], v84 offset:4672
  s_add_u32 m0, s29, 16384
  s_nop 0
  buffer_load_dwordx4 v8, s[8:11], s30 offen lds
  s_waitcnt lgkmcnt(10)
  v_mfma_f32_16x16x32_bf16 v[216:219], v[240:243], v[60:63], v[216:219]
  ds_read_b64_tr_b16 v[24:25], v85 offset:96
  v_mfma_f32_16x16x32_bf16 v[220:223], v[240:243], v[64:67], v[220:223]
  ds_read_b64_tr_b16 v[26:27], v85 offset:4704
  s_add_u32 s30, s30, 36864
  s_add_u32 s29, s29, 20480
  s_cmp_ge_u32 s29, 81920
  s_cselect_b32 s33, 81920, 0
  s_sub_u32 s29, s29, s33
  s_waitcnt lgkmcnt(10)
  v_mfma_f32_16x16x32_bf16 v[224:227], v[244:247], v[60:63], v[224:227]
  ds_read_b64_tr_b16 v[28:29], v84 offset:128
  v_mfma_f32_16x16x32_bf16 v[228:231], v[244:247], v[64:67], v[228:231]
  ds_read_b64_tr_b16 v[30:31], v84 offset:4736
  s_waitcnt lgkmcnt(10)
  v_mfma_f32_16x16x32_bf16 v[232:235], v[248:251], v[60:63], v[232:235]
  ds_read_b64_tr_b16 v[32:33], v85 offset:160
  v_mfma_f32_16x16x32_bf16 v[236:239], v[248:251], v[64:67], v[236:239]
  ds_read_b64_tr_b16 v[34:35], v85 offset:4768
  s_waitcnt vmcnt(7)
  s_barrier
  s_waitcnt lgkmcnt(10)
  v_mfma_f32_16x16x32_bf16 v[96:99], v[12:15], v[68:71], v[96:99]
  ds_read_b64_tr_b16 v[240:241], v84 offset:192
  v_mfma_f32_16x16x32_bf16 v[100:103], v[12:15], v[72:75], v[100:103]
  ds_read_b64_tr_b16 v[242:243], v84 offset:4800
  s_waitcnt lgkmcnt(10)
  v_mfma_f32_16x16x32_bf16 v[104:107], v[16:19], v[68:71], v[104:107]
  ds_read_b64_tr_b16 v[244:245], v85 offset:224
  v_mfma_f32_16x16x32_bf16 v[108:111], v[16:19], v[72:75], v[108:111]
  ds_read_b64_tr_b16 v[246:247], v85 offset:4832
  buffer_load_dwordx4 v[60:63], v3, s[12:15], s31 offen offset:0
  s_waitcnt lgkmcnt(10)
  v_mfma_f32_16x16x32_bf16 v[112:115], v[20:23], v[68:71], v[112:115]
  ds_read_b64_tr_b16 v[248:249], v84 offset:256
  v_mfma_f32_16x16x32_bf16 v[116:119], v[20:23], v[72:75], v[116:119]
  ds_read_b64_tr_b16 v[250:251], v84 offset:4864
  s_add_u32 m0, s29, 0
  s_nop 0
  buffer_load_dwordx4 v4, s[8:11], s30 offen lds
  s_waitcnt lgkmcnt(10)
  v_mfma_f32_16x16x32_bf16 v[120:123], v[24:27], v[68:71], v[120:123]
  ds_read_b64_tr_b16 v[12:13], v85 offset:288
  v_mfma_f32_16x16x32_bf16 v[124:127], v[24:27], v[72:75], v[124:127]
  ds_read_b64_tr_b16 v[14:15], v85 offset:4896
  s_waitcnt lgkmcnt(10)
  v_mfma_f32_16x16x32_bf16 v[128:131], v[28:31], v[68:71], v[128:131]
  ds_read_b64_tr_b16 v[16:17], v84 offset:320
  v_mfma_f32_16x16x32_bf16 v[132:135], v[28:31], v[72:75], v[132:135]
  ds_read_b64_tr_b16 v[18:19], v84 offset:4928
  s_waitcnt lgkmcnt(10)
  v_mfma_f32_16x16x32_bf16 v[136:139], v[32:35], v[68:71], v[136:139]
  ds_read_b64_tr_b16 v[20:21], v85 offset:352
  v_mfma_f32_16x16x32_bf16 v[140:143], v[32:35], v[72:75], v[140:143]
  ds_read_b64_tr_b16 v[22:23], v85 offset:4960
  s_add_u32 m0, s29, 4096
  s_nop 0
  buffer_load_dwordx4 v5, s[8:11], s30 offen lds
  s_waitcnt lgkmcnt(10)
  v_mfma_f32_16x16x32_bf16 v[144:147], v[240:243], v[68:71], v[144:147]
  ds_read_b64_tr_b16 v[24:25], v84 offset:384
  v_mfma_f32_16x16x32_bf16 v[148:151], v[240:243], v[72:75], v[148:151]
  ds_read_b64_tr_b16 v[26:27], v84 offset:4992
  s_waitcnt lgkmcnt(10)
  v_mfma_f32_16x16x32_bf16 v[152:155], v[244:247], v[68:71], v[152:155]
  ds_read_b64_tr_b16 v[28:29], v85 offset:416
  v_mfma_f32_16x16x32_bf16 v[156:159], v[244:247], v[72:75], v[156:159]
  ds_read_b64_tr_b16 v[30:31], v85 offset:5024
  s_waitcnt lgkmcnt(10)
  v_mfma_f32_16x16x32_bf16 v[160:163], v[248:251], v[68:71], v[160:163]
  ds_read_b64_tr_b16 v[32:33], v84 offset:448
  v_mfma_f32_16x16x32_bf16 v[164:167], v[248:251], v[72:75], v[164:167]
  ds_read_b64_tr_b16 v[34:35], v84 offset:5056
  s_add_u32 m0, s29, 8192
  s_nop 0
  buffer_load_dwordx4 v6, s[8:11], s30 offen lds
  s_waitcnt lgkmcnt(10)
  v_mfma_f32_16x16x32_bf16 v[168:171], v[12:15], v[68:71], v[168:171]
  ds_read_b64_tr_b16 v[240:241], v85 offset:480
  v_mfma_f32_16x16x32_bf16 v[172:175], v[12:15], v[72:75], v[172:175]
  ds_read_b64_tr_b16 v[242:243], v85 offset:5088
  s_waitcnt lgkmcnt(10)
  v_mfma_f32_16x16x32_bf16 v[176:179], v[16:19], v[68:71], v[176:179]
  s_add_u32 s28, s28, 20480
  s_cmp_eq_u32 s28, 81920
  s_cselect_b32 s28, 0, s28
  v_add_u32 v86, s28, v2
  v_add_u32 v87, s28, v88
  ds_read_b64_tr_b16 v[244:245], v84 offset:512
  v_mfma_f32_16x16x32_bf16 v[180:183], v[16:19], v[72:75], v[180:183]
  ds_read_b64_tr_b16 v[246:247], v84 offset:5120
  buffer_load_dwordx4 v[64:67], v3, s[12:15], s31 offen offset:256
  s_add_u32 s31, s31, 2048
  s_waitcnt lgkmcnt(10)
  v_mfma_f32_16x16x32_bf16 v[184:187], v[20:23], v[68:71], v[184:187]
  ds_read_b64_tr_b16 v[248:249], v85 offset:544
  v_mfma_f32_16x16x32_bf16 v[188:191], v[20:23], v[72:75], v[188:191]
  ds_read_b64_tr_b16 v[250:251], v85 offset:5152
  s_add_u32 m0, s29, 12288
  s_nop 0
  buffer_load_dwordx4 v7, s[8:11], s30 offen lds
  s_waitcnt lgkmcnt(10)
  v_mfma_f32_16x16x32_bf16 v[192:195], v[24:27], v[68:71], v[192:195]
  ds_read_b64_tr_b16 v[12:13], v86 offset:0
  v_mfma_f32_16x16x32_bf16 v[196:199], v[24:27], v[72:75], v[196:199]
  ds_read_b64_tr_b16 v[14:15], v86 offset:4608
  s_waitcnt lgkmcnt(10)
  v_mfma_f32_16x16x32_bf16 v[200:203], v[28:31], v[68:71], v[200:203]
  ds_read_b64_tr_b16 v[16:17], v87 offset:32
  v_mfma_f32_16x16x32_bf16 v[204:207], v[28:31], v[72:75], v[204:207]
  ds_read_b64_tr_b16 v[18:19], v87 offset:4640
  s_waitcnt lgkmcnt(10)
  v_mfma_f32_16x16x32_bf16 v[208:211], v[32:35], v[68:71], v[208:211]
  ds_read_b64_tr_b16 v[20:21], v86 offset:64
  v_mfma_f32_16x16x32_bf16 v[212:215], v[32:35], v[72:75], v[212:215]
  ds_read_b64_tr_b16 v[22:23], v86 offset:4672
  s_add_u32 m0, s29, 16384
  s_nop 0
  buffer_load_dwordx4 v8, s[8:11], s30 offen lds
  s_waitcnt lgkmcnt(10)
  v_mfma_f32_16x16x32_bf16 v[216:219], v[240:243], v[68:71], v[216:219]
  ds_read_b64_tr_b16 v[24:25], v87 offset:96
  v_mfma_f32_16x16x32_bf16 v[220:223], v[240:243], v[72:75], v[220:223]
  ds_read_b64_tr_b16 v[26:27], v87 offset:4704
  s_add_u32 s30, s30, 36864
  s_add_u32 s29, s29, 20480
  s_cmp_ge_u32 s29, 81920
  s_cselect_b32 s33, 81920, 0
  s_sub_u32 s29, s29, s33
  s_waitcnt lgkmcnt(10)
  v_mfma_f32_16x16x32_bf16 v[224:227], v[244:247], v[68:71], v[224:227]
  ds_read_b64_tr_b16 v[28:29], v86 offset:128
  v_mfma_f32_16x16x32_bf16 v[228:231], v[244:247], v[72:75], v[228:231]
  ds_read_b64_tr_b16 v[30:31], v86 offset:4736
  s_waitcnt lgkmcnt(10)
  v_mfma_f32_16x16x32_bf16 v[232:235], v[248:251], v[68:71], v[232:235]
  ds_read_b64_tr_b16 v[32:33], v87 offset:160
  v_mfma_f32_16x16x32_bf16 v[236:239], v[248:251], v[72:75], v[236:239]
  ds_read_b64_tr_b16 v[34:35], v87 offset:4768
  s_waitcnt vmcnt(7)
  s_barrier
  s_waitcnt lgkmcnt(10)
  v_mfma_f32_16x16x32_bf16 v[96:99], v[12:15], v[76:79], v[96:99]
  ds_read_b64_tr_b16 v[240:241], v86 offset:192
  v_mfma_f32_16x16x32_bf16 v[100:103], v[12:15], v[80:83], v[100:103]
  ds_read_b64_tr_b16 v[242:243], v86 offset:4800
  s_waitcnt lgkmcnt(10)
  v_mfma_f32_16x16x32_bf16 v[104:107], v[16:19], v[76:79], v[104:107]
  ds_read_b64_tr_b16 v[244:245], v87 offset:224
  v_mfma_f32_16x16x32_bf16 v[108:111], v[16:19], v[80:83], v[108:111]
  ds_read_b64_tr_b16 v[246:247], v87 offset:4832
  buffer_load_dwordx4 v[68:71], v3, s[12:15], s31 offen offset:0
  s_waitcnt lgkmcnt(10)
  v_mfma_f32_16x16x32_bf16 v[112:115], v[20:23], v[76:79], v[112:115]
  ds_read_b64_tr_b16 v[248:249], v86 offset:256
  v_mfma_f32_16x16x32_bf16 v[116:119], v[20:23], v[80:83], v[116:119]
  ds_read_b64_tr_b16 v[250:251], v86 offset:4864
  s_add_u32 m0, s29, 0
  s_nop 0
  buffer_load_dwordx4 v4, s[8:11], s30 offen lds
  s_waitcnt lgkmcnt(10)
  v_mfma_f32_16x16x32_bf16 v[120:123], v[24:27], v[76:79], v[120:123]
  ds_read_b64_tr_b16 v[12:13], v87 offset:288
  v_mfma_f32_16x16x32_bf16 v[124:127], v[24:27], v[80:83], v[124:127]
  ds_read_b64_tr_b16 v[14:15], v87 offset:4896
  s_waitcnt lgkmcnt(10)
  v_mfma_f32_16x16x32_bf16 v[128:131], v[28:31], v[76:79], v[128:131]
  ds_read_b64_tr_b16 v[16:17], v86 offset:320
  v_mfma_f32_16x16x32_bf16 v[132:135], v[28:31], v[80:83], v[132:135]
  ds_read_b64_tr_b16 v[18:19], v86 offset:4928
  s_waitcnt lgkmcnt(10)
  v_mfma_f32_16x16x32_bf16 v[136:139], v[32:35], v[76:79], v[136:139]
  ds_read_b64_tr_b16 v[20:21], v87 offset:352
  v_mfma_f32_16x16x32_bf16 v[140:143], v[32:35], v[80:83], v[140:143]
  ds_read_b64_tr_b16 v[22:23], v87 offset:4960
  s_add_u32 m0, s29, 4096
  s_nop 0
  buffer_load_dwordx4 v5, s[8:11], s30 offen lds
  s_waitcnt lgkmcnt(10)
  v_mfma_f32_16x16x32_bf16 v[144:147], v[240:243], v[76:79], v[144:147]
  ds_read_b64_tr_b16 v[24:25], v86 offset:384
  v_mfma_f32_16x16x32_bf16 v[148:151], v[240:243], v[80:83], v[148:151]
  ds_read_b64_tr_b16 v[26:27], v86 offset:4992
  s_waitcnt lgkmcnt(10)
  v_mfma_f32_16x16x32_bf16 v[152:155], v[244:247], v[76:79], v[152:155]
  ds_read_b64_tr_b16 v[28:29], v87 offset:416
  v_mfma_f32_16x16x32_bf16 v[156:159], v[244:247], v[80:83], v[156:159]
  ds_read_b64_tr_b16 v[30:31], v87 offset:5024
  s_waitcnt lgkmcnt(10)
  v_mfma_f32_16x16x32_bf16 v[160:163], v[248:251], v[76:79], v[160:163]
  ds_read_b64_tr_b16 v[32:33], v86 offset:448
  v_mfma_f32_16x16x32_bf16 v[164:167], v[248:251], v[80:83], v[164:167]
  ds_read_b64_tr_b16 v[34:35], v86 offset:5056
  s_add_u32 m0, s29, 8192
  s_nop 0
  buffer_load_dwordx4 v6, s[8:11], s30 offen lds
  s_waitcnt lgkmcnt(10)
  v_mfma_f32_16x16x32_bf16 v[168:171], v[12:15], v[76:79], v[168:171]
  ds_read_b64_tr_b16 v[240:241], v87 offset:480
  v_mfma_f32_16x16x32_bf16 v[172:175], v[12:15], v[80:83], v[172:175]
  ds_read_b64_tr_b16 v[242:243], v87 offset:5088
  s_waitcnt lgkmcnt(10)
  v_mfma_f32_16x16x32_bf16 v[176:179], v[16:19], v[76:79], v[176:179]
  s_add_u32 s28, s28, 20480
  s_cmp_eq_u32 s28, 81920
  s_cselect_b32 s28, 0, s28
  v_add_u32 v84, s28, v2
  v_add_u32 v85, s28, v88
  ds_read_b64_tr_b16 v[244:245], v86 offset:512
  v_mfma_f32_16x16x32_bf16 v[180:183], v[16:19], v[80:83], v[180:183]
  ds_read_b64_tr_b16 v[246:247], v86 offset:5120
  buffer_load_dwordx4 v[72:75], v3, s[12:15], s31 offen offset:256
  s_add_u32 s31, s31, 2048
  s_waitcnt lgkmcnt(10)
  v_mfma_f32_16x16x32_bf16 v[184:187], v[20:23], v[76:79], v[184:187]
  ds_read_b64_tr_b16 v[248:249], v87 offset:544
  v_mfma_f32_16x16x32_bf16 v[188:191], v[20:23], v[80:83], v[188:191]
  ds_read_b64_tr_b16 v[250:251], v87 offset:5152
  s_add_u32 m0, s29, 12288
  s_nop 0
  buffer_load_dwordx4 v7, s[8:11], s30 offen lds
  s_waitcnt lgkmcnt(10)
  v_mfma_f32_16x16x32_bf16 v[192:195], v[24:27], v[76:79], v[192:195]
  ds_read_b64_tr_b16 v[12:13], v84 offset:0
  v_mfma_f32_16x16x32_bf16 v[196:199], v[24:27], v[80:83], v[196:199]
  ds_read_b64_tr_b16 v[14:15], v84 offset:4608
  s_waitcnt lgkmcnt(10)
  v_mfma_f32_16x16x32_bf16 v[200:203], v[28:31], v[76:79], v[200:203]
  ds_read_b64_tr_b16 v[16:17], v85 offset:32
  v_mfma_f32_16x16x32_bf16 v[204:207], v[28:31], v[80:83], v[204:207]
  ds_read_b64_tr_b16 v[18:19], v85 offset:4640
  s_waitcnt lgkmcnt(10)
  v_mfma_f32_16x16x32_bf16 v[208:211], v[32:35], v[76:79], v[208:211]
  ds_read_b64_tr_b16 v[20:21], v84 offset:64
  v_mfma_f32_16x16x32_bf16 v[212:215], v[32:35], v[80:83], v[212:215]
  ds_read_b64_tr_b16 v[22:23], v84 offset:4672
  s_add_u32 m0, s29, 16384
  s_nop 0
  buffer_load_dwordx4 v8, s[8:11], s30 offen lds
  s_waitcnt lgkmcnt(10)
  v_mfma_f32_16x16x32_bf16 v[216:219], v[240:243], v[76:79], v[216:219]
  ds_read_b64_tr_b16 v[24:25], v85 offset:96
  v_mfma_f32_16x16x32_bf16 v[220:223], v[240:243], v[80:83], v[220:223]
  ds_read_b64_tr_b16 v[26:27], v85 offset:4704
  s_add_u32 s30, s30, 36864
  s_add_u32 s29, s29, 20480
  s_cmp_ge_u32 s29, 81920
  s_cselect_b32 s33, 81920, 0
  s_sub_u32 s29, s29, s33
  s_waitcnt lgkmcnt(10)
  v_mfma_f32_16x16x32_bf16 v[224:227], v[244:247], v[76:79], v[224:227]
  ds_read_b64_tr_b16 v[28:29], v84 offset:128
  v_mfma_f32_16x16x32_bf16 v[228:231], v[244:247], v[80:83], v[228:231]
  ds_read_b64_tr_b16 v[30:31], v84 offset:4736
  s_waitcnt lgkmcnt(10)
  v_mfma_f32_16x16x32_bf16 v[232:235], v[248:251], v[76:79], v[232:235]
  ds_read_b64_tr_b16 v[32:33], v85 offset:160
  v_mfma_f32_16x16x32_bf16 v[236:239], v[248:251], v[80:83], v[236:239]
  ds_read_b64_tr_b16 v[34:35], v85 offset:4768
  s_cmp_eq_u32 s32, 1
  s_cbranch_scc0 L_dn_keep
  s_setprio 0
L_dn_keep:
  s_sub_u32 s32, s32, 1
  s_cmp_lg_u32 s32, 0
  s_cbranch_scc1 L_dn_loop
  s_waitcnt vmcnt(0) lgkmcnt(0)
  s_nop 7
  s_nop 3
  s_lshl_b32 s33, s25, 6
  s_add_u32 s33, s33, s26
  s_mul_i32 s33, s33, 18
  s_mul_i32 s34, s27, 9
  s_add_u32 s33, s33, s34
  s_lshl_b32 s33, s33, 11
  v_cvt_pk_bf16_f32 v36, v96, v97
  v_cvt_pk_bf16_f32 v37, v98, v99
  v_cvt_pk_bf16_f32 v38, v100, v101
  v_cvt_pk_bf16_f32 v39, v102, v103
  buffer_store_dwordx4 v[36:39], v1, s[16:19], s33 offen offset:0 sc1
  v_cvt_pk_bf16_f32 v40, v104, v105
  v_cvt_pk_bf16_f32 v41, v106, v107
  v_cvt_pk_bf16_f32 v42, v108, v109
  v_cvt_pk_bf16_f32 v43, v110, v111
  buffer_store_dwordx4 v[40:43], v1, s[16:19], s33 offen offset:1024 sc1
  s_add_u32 s33, s33, 2048
  v_cvt_pk_bf16_f32 v44, v112, v113
  v_cvt_pk_bf16_f32 v45, v114, v115
  v_cvt_pk_bf16_f32 v46, v116, v117
  v_cvt_pk_bf16_f32 v47, v118, v119
  buffer_store_dwordx4 v[44:47], v1, s[16:19], s33 offen offset:0 sc1
  v_cvt_pk_bf16_f32 v48, v120, v121
  v_cvt_pk_bf16_f32 v49, v122, v123
  v_cvt_pk_bf16_f32 v50, v124, v125
  v_cvt_pk_bf16_f32 v51, v126, v127
  buffer_store_dwordx4 v[48:51], v1, s[16:19], s33 offen offset:1024 sc1
  s_add_u32 s33, s33, 2048
  v_cvt_pk_bf16_f32 v52, v128, v129
  v_cvt_pk_bf16_f32 v53, v130, v131
  v_cvt_pk_bf16_f32 v54, v132, v133
  v_cvt_pk_bf16_f32 v55, v134, v135
  buffer_store_dwordx4 v[52:55], v1, s[16:19], s33 offen offset:0 sc1
  v_cvt_pk_bf16_f32 v56, v136, v137
  v_cvt_pk_bf16_f32 v57, v138, v139
  v_cvt_pk_bf16_f32 v58, v140, v141
  v_cvt_pk_bf16_f32 v59, v142, v143
  buffer_store_dwordx4 v[56:59], v1, s[16:19], s33 offen offset:1024 sc1
  s_add_u32 s33, s33, 2048
  v_cvt_pk_bf16_f32 v60, v144, v145
  v_cvt_pk_bf16_f32 v61, v146, v147
  v_cvt_pk_bf16_f32 v62, v148, v149
  v_cvt_pk_bf16_f32 v63, v150, v151
  buffer_store_dwordx4 v[60:63], v1, s[16:19], s33 offen offset:0 sc1
  v_cvt_pk_bf16_f32 v64, v152, v153
  v_cvt_pk_bf16_f32 v65, v154, v155
  v_cvt_pk_bf16_f32 v66, v156, v157
  v_cvt_pk_bf16_f32 v67, v158, v159
  buffer_store_dwordx4 v[64:67], v1, s[16:19], s33 offen offset:1024 sc1
  s_add_u32 s33, s33, 2048
  v_cvt_pk_bf16_f32 v36, v160, v161
  v_cvt_pk_bf16_f32 v37, v162, v163
  v_cvt_pk_bf16_f32 v38, v164, v165
  v_cvt_pk_bf16_f32 v39, v166, v167
  buffer_store_dwordx4 v[36:39], v1, s[16:19], s33 offen offset:0 sc1
  v_cvt_pk_bf16_f32 v40, v168, v169
  v_cvt_pk_bf16_f32 v41, v170, v171
  v_cvt_pk_bf16_f32 v42, v172, v173
  v_cvt_pk_bf16_f32 v43, v174, v175
  buffer_store_dwordx4 v[40:43], v1, s[16:19], s33 offen offset:1024 sc1
  s_add_u32 s33, s33, 2048
  v_cvt_pk_bf16_f32 v44, v176, v177
  v_cvt_pk_bf16_f32 v45, v178, v179
  v_cvt_pk_bf16_f32 v46, v180, v181
  v_cvt_pk_bf16_f32 v47, v182, v183
  buffer_store_dwordx4 v[44:47], v1, s[16:19], s33 offen offset:0 sc1
  v_cvt_pk_bf16_f32 v48, v184, v185
  v_cvt_pk_bf16_f32 v49, v186, v187
  v_cvt_pk_bf16_f32 v50, v188, v189
  v_cvt_pk_bf16_f32 v51, v190, v191
  buffer_store_dwordx4 v[48:51], v1, s[16:19], s33 offen offset:1024 sc1
  s_add_u32 s33, s33, 2048
  v_cvt_pk_bf16_f32 v52, v192, v193
  v_cvt_pk_bf16_f32 v53, v194, v195
  v_cvt_pk_bf16_f32 v54, v196, v197
  v_cvt_pk_bf16_f32 v55, v198, v199
  buffer_store_dwordx4 v[52:55], v1, s[16:19], s33 offen offset:0 sc1
  v_cvt_pk_bf16_f32 v56, v200, v201
  v_cvt_pk_bf16_f32 v57, v202, v203
  v_cvt_pk_bf16_f32 v58, v204, v205
  v_cvt_pk_bf16_f32 v59, v206, v207
  buffer_store_dwordx4 v[56:59], v1, s[16:19], s33 offen offset:1024 sc1
  s_add_u32 s33, s33, 2048
  v_cvt_pk_bf16_f32 v60, v208, v209
  v_cvt_pk_bf16_f32 v61, v210, v211
  v_cvt_pk_bf16_f32 v62, v212, v213
  v_cvt_pk_bf16_f32 v63, v214, v215
  buffer_store_dwordx4 v[60:63], v1, s[16:19], s33 offen offset:0 sc1
  v_cvt_pk_bf16_f32 v64, v216, v217
  v_cvt_pk_bf16_f32 v65, v218, v219
  v_cvt_pk_bf16_f32 v66, v220, v221
  v_cvt_pk_bf16_f32 v67, v222, v223
  buffer_store_dwordx4 v[64:67], v1, s[16:19], s33 offen offset:1024 sc1
  s_add_u32 s33, s33, 2048
  v_cvt_pk_bf16_f32 v36, v224, v225
  v_cvt_pk_bf16_f32 v37, v226, v227
  v_cvt_pk_bf16_f32 v38, v228, v229
  v_cvt_pk_bf16_f32 v39, v230, v231
  buffer_store_dwordx4 v[36:39], v1, s[16:19], s33 offen offset:0 sc1
  v_cvt_pk_bf16_f32 v40, v232, v233
  v_cvt_pk_bf16_f32 v41, v234, v235
  v_cvt_pk_bf16_f32 v42, v236, v237
  v_cvt_pk_bf16_f32 v43, v238, v239
  buffer_store_dwordx4 v[40:43], v1, s[16:19], s33 offen offset:1024 sc1
  s_add_u32 s33, s33, 2048
  s_waitcnt vmcnt(0)
  s_barrier
  s_cmp_lg_u32 s24, 0
  s_cbranch_scc1 L_sigd
  s_lshr_b32 s33, s26, 2
  s_lshl_b32 s33, s33, 1
  s_add_u32 s33, s33, s27
  s_add_u32 s33, s33, 64
  s_lshl_b32 s33, s33, 7
  s_add_u32 s33, s33, 50216960
  v_lshlrev_b32 v10, 7, v0
  v_add_u32 v10, s33, v10
  v_mov_b32 v11, 1
  s_mov_b64 exec, 1
  global_atomic_add v10, v11, s[4:5] sc1
  s_mov_b64 exec, -1
L_sigd:
  s_lshr_b32 s33, s2, 3
  s_and_b32 s33, s33, 31
  s_lshl_b32 s33, s33, 2
  s_add_u32 s33, s33, s24
  s_mul_i32 s33, s33, 6144
  s_add_u32 s8, s4, 49545216
  s_addc_u32 s9, s5, 0
  s_mov_b32 s10, 663552
  s_mov_b32 s11, 0x20000
  buffer_load_dwordx4 v[96:99], v1, s[8:11], s33 offen
  s_add_u32 s33, s33, 1024
  buffer_load_dwordx4 v[100:103], v1, s[8:11], s33 offen
  s_add_u32 s33, s33, 1024
  buffer_load_dwordx4 v[104:107], v1, s[8:11], s33 offen
  s_add_u32 s33, s33, 1024
  buffer_load_dwordx4 v[108:111], v1, s[8:11], s33 offen
  s_add_u32 s33, s33, 1024
  buffer_load_dwordx4 v[112:115], v1, s[8:11], s33 offen
  s_add_u32 s33, s33, 1024
  buffer_load_dwordx4 v[116:119], v1, s[8:11], s33 offen
  s_add_u32 s33, s33, 1024
  s_branch L_mix_done
L_mix_third:
  s_load_dwordx2 s[4:5], s[0:1], 72
  s_load_dwordx2 s[8:9], s[0:1], 0
  s_load_dwordx2 s[10:11], s[0:1], 56
  v_readfirstlane_b32 s32, v0
  v_and_b32 v0, 63, v0
  s_lshr_b32 s32, s32, 6
  s_and_b32 s33, s2, 7
  s_bfe_u32 s35, s2, 0x30005
  s_lshl_b32 s35, s35, 3
  s_add_u32 s33, s33, s35
  s_bfe_u32 s34, s2, 0x20003
  s_mul_i32 s38, s34, 9
  s_lshl_b32 s39, s32, 10
  s_and_b32 s40, s32, 1
  v_lshlrev_b32 v1, 4, v0
  v_and_b32 v4, 15, v0
  v_mul_u32_u24 v4, 288, v4
  v_lshrrev_b32 v5, 4, v0
  v_lshl_add_u32 v2, v5, 3, v4
  v_add_u32 v2, 57344, v2
  s_waitcnt lgkmcnt(0)
  s_add_u32 s12, s4, 49545216
  s_addc_u32 s13, s5, 0
  s_mov_b32 s14, 663552
  s_mov_b32 s15, 0x20000
  s_add_u32 s16, s4, 9437184
  s_addc_u32 s17, s5, 0
  s_mov_b32 s18, 2359296
  s_mov_b32 s19, 0x20000
  s_add_u32 s20, s4, 30670848
  s_addc_u32 s21, s5, 0
  s_mov_b32 s22, 18874368
  s_mov_b32 s23, 0x20000
  s_mov_b32 s24, s8
  s_mov_b32 s25, s9
  s_mov_b32 s26, 2359296
  s_mov_b32 s27, 0x20000
  s_mov_b32 s28, s10
  s_mov_b32 s29, s11
  s_mov_b32 s30, 2359296
  s_mov_b32 s31, 0x20000
  s_mul_i32 s37, s33, 36864
  s_mul_i32 s35, s34, 288
  s_add_u32 s37, s37, s35
  s_add_u32 s35, s32, 0
  s_lshl_b32 s35, s35, 6
  v_add_u32 v4, s35, v0
  v_mul_u32_u24 v5, 3641, v4
  v_lshrrev_b32 v5, 16, v5
  v_mul_u32_u24 v5, 864, v5
  v_lshl_add_u32 v3, v4, 4, v5
  s_add_u32 m0, s39, 57344
  s_nop 0
  buffer_load_dwordx4 v3, s[24:27], s37 offen lds
  s_add_u32 s35, s32, 4
  s_lshl_b32 s35, s35, 6
  v_add_u32 v4, s35, v0
  v_mul_u32_u24 v5, 3641, v4
  v_lshrrev_b32 v5, 16, v5
  v_mul_u32_u24 v5, 864, v5
  v_lshl_add_u32 v3, v4, 4, v5
  s_add_u32 m0, s39, 61440
  s_nop 0
  buffer_load_dwordx4 v3, s[24:27], s37 offen lds
  s_add_u32 s35, s32, 8
  s_lshl_b32 s35, s35, 6
  v_add_u32 v4, s35, v0
  v_mul_u32_u24 v5, 3641, v4
  v_lshrrev_b32 v5, 16, v5
  v_mul_u32_u24 v5, 864, v5
  v_lshl_add_u32 v3, v4, 4, v5
  v_cmp_gt_u32 vcc, 576, v4
  v_mov_b32 v5, 0x7f000000
  s_nop 0
  v_cndmask_b32 v3, v5, v3, vcc
  s_add_u32 m0, s39, 65536
  s_nop 0
  buffer_load_dwordx4 v3, s[24:27], s37 offen lds
  s_mov_b32 s43, s37
  s_mul_i32 s37, s32, 36
  s_add_u32 s37, s37, s38
  s_add_u32 s37, s37, 8
  s_lshl_b32 s37, s37, 10
  s_add_u32 m0, s39, 36864
  s_nop 0
  buffer_load_dwordx4 v1, s[12:15], s37 offen lds
  s_add_u32 s37, s37, 147456
  s_add_u32 m0, s39, 40960
  s_nop 0
  buffer_load_dwordx4 v1, s[12:15], s37 offen lds
  s_add_u32 s37, s37, 147456
  s_add_u32 m0, s39, 45056
  s_nop 0
  buffer_load_dwordx4 v1, s[12:15], s37 offen lds
  s_add_u32 s37, s37, 147456
  s_add_u32 m0, s39, 49152
  s_nop 0
  buffer_load_dwordx4 v1, s[12:15], s37 offen lds
  s_add_u32 s37, s37, 147456
  s_add_u32 m0, s39, 53248
  s_nop 0
  buffer_load_dwordx4 v1, s[12:15], s37 offen lds
  s_add_u32 s37, s37, 147456
  s_lshl_b32 s37, s32, 1
  s_add_u32 s37, s37, s38
  s_lshl_b32 s37, s37, 10
  s_mov_b32 s42, s37
  buffer_load_dwordx4 v[112:115], v1, s[12:15], s42 offen offset:0
  buffer_load_dwordx4 v[116:119], v1, s[12:15], s42 offen offset:1024
  s_add_u32 s42, s42, 36864
  buffer_load_dwordx4 v[120:123], v1, s[12:15], s42 offen offset:0
  buffer_load_dwordx4 v[124:127], v1, s[12:15], s42 offen offset:1024
  s_add_u32 s42, s42, 36864
  buffer_load_dwordx4 v[128:131], v1, s[12:15], s42 offen offset:0
  buffer_load_dwordx4 v[132:135], v1, s[12:15], s42 offen offset:1024
  s_add_u32 s42, s42, 36864
  buffer_load_dwordx4 v[136:139], v1, s[12:15], s42 offen offset:0
  buffer_load_dwordx4 v[140:143], v1, s[12:15], s42 offen offset:1024
  s_add_u32 s42, s42, 36864
  buffer_load_dwordx4 v[144:147], v1, s[12:15], s42 offen offset:0
  buffer_load_dwordx4 v[148:151], v1, s[12:15], s42 offen offset:1024
  s_add_u32 s42, s42, 36864
  buffer_load_dwordx4 v[152:155], v1, s[12:15], s42 offen offset:0
  buffer_load_dwordx4 v[156:159], v1, s[12:15], s42 offen offset:1024
  s_add_u32 s42, s42, 36864
  s_waitcnt vmcnt(12)
  s_barrier
  s_lshl_b32 s35, s32, 6
  v_add_u32 v4, s35, v2
  ds_read_b64 v[28:29], v4 offset:0
  ds_read_b64 v[30:31], v4 offset:4608
  ds_read_b64 v[32:33], v4 offset:32
  ds_read_b64 v[34:35], v4 offset:4640
  s_mul_i32 s35, s40, 4608
  v_add_u32 v5, s35, v2
  ds_read_b64 v[36:37], v5 offset:256
  s_waitcnt lgkmcnt(0)
  v_lshlrev_b32 v8, 16, v28
  v_and_b32 v9, 0xffff0000, v28
  v_lshlrev_b32 v10, 16, v29
  v_and_b32 v11, 0xffff0000, v29
  v_lshlrev_b32 v12, 16, v30
  v_and_b32 v13, 0xffff0000, v30
  v_lshlrev_b32 v14, 16, v31
  v_and_b32 v15, 0xffff0000, v31
  v_lshlrev_b32 v16, 16, v32
  v_and_b32 v17, 0xffff0000, v32
  v_lshlrev_b32 v18, 16, v33
  v_and_b32 v19, 0xffff0000, v33
  v_lshlrev_b32 v20, 16, v34
  v_and_b32 v21, 0xffff0000, v34
  v_lshlrev_b32 v22, 16, v35
  v_and_b32 v23, 0xffff0000, v35
  v_lshlrev_b32 v24, 16, v36
  v_and_b32 v25, 0xffff0000, v36
  v_lshlrev_b32 v26, 16, v37
  v_and_b32 v27, 0xffff0000, v37
  s_lshr_b32 s36, s33, 2
  s_lshl_b32 s36, s36, 1
  s_lshr_b32 s35, s34, 1
  s_add_u32 s36, s36, s35
  s_add_u32 s36, s36, 64
  s_cmp_lg_u32 s32, 0
  s_cbranch_scc1 L_f_gop
  s_lshl_b32 s35, s36, 7
  s_add_u32 s35, s35, 50216960
  v_mov_b32 v6, s35
  s_mov_b32 s41, 0x4000
L_f_spinp:
  global_load_dword v4, v6, s[4:5] sc1
  s_waitcnt vmcnt(0)
  v_readfirstlane_b32 s35, v4
  s_nop 3
  s_cmp_ge_u32 s35, 8
  s_cbranch_scc1 L_f_gop
  s_sleep 2
  s_sub_u32 s41, s41, 1
  s_cmp_lg_u32 s41, 0
  s_cbranch_scc1 L_f_spinp
L_f_gop:
  s_barrier
  s_mul_i32 s37, s33, 36
  s_add_u32 s37, s37, s38
  s_add_u32 s36, s37, 8
  s_lshl_b32 s36, s36, 10
  s_cmp_lt_u32 s32, 2
  s_cselect_b32 s36, s36, 0x70000000
  s_lshl_b32 s35, s32, 1
  s_add_u32 s37, s37, s35
  s_lshl_b32 s37, s37, 10
  s_cmp_lg_u32 s40, 0
  s_cselect_b64 s[46:47], -1, 0
  buffer_load_dwordx4 v[28:31], v1, s[20:23], s37 offen sc1
  buffer_load_dwordx4 v[32:35], v1, s[20:23], s37 offen offset:1024 sc1
  buffer_load_dwordx4 v[36:39], v1, s[20:23], s36 offen sc1
  s_add_u32 s37, s37, 2359296
  s_add_u32 s36, s36, 2359296
  buffer_load_dwordx4 v[40:43], v1, s[20:23], s37 offen sc1
  buffer_load_dwordx4 v[44:47], v1, s[20:23], s37 offen offset:1024 sc1
  buffer_load_dwordx4 v[48:51], v1, s[20:23], s36 offen sc1
  s_add_u32 s37, s37, 2359296
  s_add_u32 s36, s36, 2359296
  buffer_load_dwordx4 v[52:55], v1, s[20:23], s37 offen sc1
  buffer_load_dwordx4 v[56:59], v1, s[20:23], s37 offen offset:1024 sc1
  buffer_load_dwordx4 v[60:63], v1, s[20:23], s36 offen sc1
  s_add_u32 s37, s37, 2359296
  s_add_u32 s36, s36, 2359296
  s_waitcnt vmcnt(6)
  v_lshlrev_b32 v4, 16, v28
  v_and_b32 v28, 0xffff0000, v28
  v_add_f32 v8, v8, v4
  v_add_f32 v9, v9, v28
  v_lshlrev_b32 v4, 16, v29
  v_and_b32 v29, 0xffff0000, v29
  v_add_f32 v10, v10, v4
  v_add_f32 v11, v11, v29
  v_lshlrev_b32 v4, 16, v30
  v_and_b32 v30, 0xffff0000, v30
  v_add_f32 v12, v12, v4
  v_add_f32 v13, v13, v30
  v_lshlrev_b32 v4, 16, v31
  v_and_b32 v31, 0xffff0000, v31
  v_add_f32 v14, v14, v4
  v_add_f32 v15, v15, v31
  v_lshlrev_b32 v4, 16, v32
  v_and_b32 v32, 0xffff0000, v32
  v_add_f32 v16, v16, v4
  v_add_f32 v17, v17, v32
  v_lshlrev_b32 v4, 16, v33
  v_and_b32 v33, 0xffff0000, v33
  v_add_f32 v18, v18, v4
  v_add_f32 v19, v19, v33
  v_lshlrev_b32 v4, 16, v34
  v_and_b32 v34, 0xffff0000, v34
  v_add_f32 v20, v20, v4
  v_add_f32 v21, v21, v34
  v_lshlrev_b32 v4, 16, v35
  v_and_b32 v35, 0xffff0000, v35
  v_add_f32 v22, v22, v4
  v_add_f32 v23, v23, v35
  v_cndmask_b32 v36, v36, v38, s[46:47]
  v_cndmask_b32 v37, v37, v39, s[46:47]
  v_lshlrev_b32 v4, 16, v36
  v_and_b32 v36, 0xffff0000, v36
  v_add_f32 v24, v24, v4
  v_add_f32 v25, v25, v36
  v_lshlrev_b32 v4, 16, v37
  v_and_b32 v37, 0xffff0000, v37
  v_add_f32 v26, v26, v4
  v_add_f32 v27, v27, v37
  buffer_load_dwordx4 v[28:31], v1, s[20:23], s37 offen sc1
  buffer_load_dwordx4 v[32:35], v1, s[20:23], s37 offen offset:1024 sc1
  buffer_load_dwordx4 v[36:39], v1, s[20:23], s36 offen sc1
  s_add_u32 s37, s37, 2359296
  s_add_u32 s36, s36, 2359296
  s_waitcnt vmcnt(6)
  v_lshlrev_b32 v4, 16, v40
  v_and_b32 v40, 0xffff0000, v40
  v_add_f32 v8, v8, v4
  v_add_f32 v9, v9, v40
  v_lshlrev_b32 v4, 16, v41
  v_and_b32 v41, 0xffff0000, v41
  v_add_f32 v10, v10, v4
  v_add_f32 v11, v11, v41
  v_lshlrev_b32 v4, 16, v42
  v_and_b32 v42, 0xffff0000, v42
  v_add_f32 v12, v12, v4
  v_add_f32 v13, v13, v42
  v_lshlrev_b32 v4, 16, v43
  v_and_b32 v43, 0xffff0000, v43
  v_add_f32 v14, v14, v4
  v_add_f32 v15, v15, v43
  v_lshlrev_b32 v4, 16, v44
  v_and_b32 v44, 0xffff0000, v44
  v_add_f32 v16, v16, v4
  v_add_f32 v17, v17, v44
  v_lshlrev_b32 v4, 16, v45
  v_and_b32 v45, 0xffff0000, v45
  v_add_f32 v18, v18, v4
  v_add_f32 v19, v19, v45
  v_lshlrev_b32 v4, 16, v46
  v_and_b32 v46, 0xffff0000, v46
  v_add_f32 v20, v20, v4
  v_add_f32 v21, v21, v46
  v_lshlrev_b32 v4, 16, v47
  v_and_b32 v47, 0xffff0000, v47
  v_add_f32 v22, v22, v4
  v_add_f32 v23, v23, v47
  v_cndmask_b32 v48, v48, v50, s[46:47]
  v_cndmask_b32 v49, v49, v51, s[46:47]
  v_lshlrev_b32 v4, 16, v48
  v_and_b32 v48, 0xffff0000, v48
  v_add_f32 v24, v24, v4
  v_add_f32 v25, v25, v48
  v_lshlrev_b32 v4, 16, v49
  v_and_b32 v49, 0xffff0000, v49
  v_add_f32 v26, v26, v4
  v_add_f32 v27, v27, v49
  buffer_load_dwordx4 v[40:43], v1, s[20:23], s37 offen sc1
  buffer_load_dwordx4 v[44:47], v1, s[20:23], s37 offen offset:1024 sc1
  buffer_load_dwordx4 v[48:51], v1, s[20:23], s36 offen sc1
  s_add_u32 s37, s37, 2359296
  s_add_u32 s36, s36, 2359296
  s_waitcnt vmcnt(6)
  v_lshlrev_b32 v4, 16, v52
  v_and_b32 v52, 0xffff0000, v52
  v_add_f32 v8, v8, v4
  v_add_f32 v9, v9, v52
  v_lshlrev_b32 v4, 16, v53
  v_and_b32 v53, 0xffff0000, v53
  v_add_f32 v10, v10, v4
  v_add_f32 v11, v11, v53
  v_lshlrev_b32 v4, 16, v54
  v_and_b32 v54, 0xffff0000, v54
  v_add_f32 v12, v12, v4
  v_add_f32 v13, v13, v54
  v_lshlrev_b32 v4, 16, v55
  v_and_b32 v55, 0xffff0000, v55
  v_add_f32 v14, v14, v4
  v_add_f32 v15, v15, v55
  v_lshlrev_b32 v4, 16, v56
  v_and_b32 v56, 0xffff0000, v56
  v_add_f32 v16, v16, v4
  v_add_f32 v17, v17, v56
  v_lshlrev_b32 v4, 16, v57
  v_and_b32 v57, 0xffff0000, v57
  v_add_f32 v18, v18, v4
  v_add_f32 v19, v19, v57
  v_lshlrev_b32 v4, 16, v58
  v_and_b32 v58, 0xffff0000, v58
  v_add_f32 v20, v20, v4
  v_add_f32 v21, v21, v58
  v_lshlrev_b32 v4, 16, v59
  v_and_b32 v59, 0xffff0000, v59
  v_add_f32 v22, v22, v4
  v_add_f32 v23, v23, v59
  v_cndmask_b32 v60, v60, v62, s[46:47]
  v_cndmask_b32 v61, v61, v63, s[46:47]
  v_lshlrev_b32 v4, 16, v60
  v_and_b32 v60, 0xffff0000, v60
  v_add_f32 v24, v24, v4
  v_add_f32 v25, v25, v60
  v_lshlrev_b32 v4, 16, v61
  v_and_b32 v61, 0xffff0000, v61
  v_add_f32 v26, v26, v4
  v_add_f32 v27, v27, v61
  buffer_load_dwordx4 v[52:55], v1, s[20:23], s37 offen sc1
  buffer_load_dwordx4 v[56:59], v1, s[20:23], s37 offen offset:1024 sc1
  buffer_load_dwordx4 v[60:63], v1, s[20:23], s36 offen sc1
  s_add_u32 s37, s37, 2359296
  s_add_u32 s36, s36, 2359296
  s_waitcnt vmcnt(6)
  v_lshlrev_b32 v4, 16, v28
  v_and_b32 v28, 0xffff0000, v28
  v_add_f32 v8, v8, v4
  v_add_f32 v9, v9, v28
  v_lshlrev_b32 v4, 16, v29
  v_and_b32 v29, 0xffff0000, v29
  v_add_f32 v10, v10, v4
  v_add_f32 v11, v11, v29
  v_lshlrev_b32 v4, 16, v30
  v_and_b32 v30, 0xffff0000, v30
  v_add_f32 v12, v12, v4
  v_add_f32 v13, v13, v30
  v_lshlrev_b32 v4, 16, v31
  v_and_b32 v31, 0xffff0000, v31
  v_add_f32 v14, v14, v4
  v_add_f32 v15, v15, v31
  v_lshlrev_b32 v4, 16, v32
  v_and_b32 v32, 0xffff0000, v32
  v_add_f32 v16, v16, v4
  v_add_f32 v17, v17, v32
  v_lshlrev_b32 v4, 16, v33
  v_and_b32 v33, 0xffff0000, v33
  v_add_f32 v18, v18, v4
  v_add_f32 v19, v19, v33
  v_lshlrev_b32 v4, 16, v34
  v_and_b32 v34, 0xffff0000, v34
  v_add_f32 v20, v20, v4
  v_add_f32 v21, v21, v34
  v_lshlrev_b32 v4, 16, v35
  v_and_b32 v35, 0xffff0000, v35
  v_add_f32 v22, v22, v4
  v_add_f32 v23, v23, v35
  v_cndmask_b32 v36, v36, v38, s[46:47]
  v_cndmask_b32 v37, v37, v39, s[46:47]
  v_lshlrev_b32 v4, 16, v36
  v_and_b32 v36, 0xffff0000, v36
  v_add_f32 v24, v24, v4
  v_add_f32 v25, v25, v36
  v_lshlrev_b32 v4, 16, v37
  v_and_b32 v37, 0xffff0000, v37
  v_add_f32 v26, v26, v4
  v_add_f32 v27, v27, v37
  buffer_load_dwordx4 v[28:31], v1, s[20:23], s37 offen sc1
  buffer_load_dwordx4 v[32:35], v1, s[20:23], s37 offen offset:1024 sc1
  buffer_load_dwordx4 v[36:39], v1, s[20:23], s36 offen sc1
  s_add_u32 s37, s37, 2359296
  s_add_u32 s36, s36, 2359296
  s_waitcnt vmcnt(6)
  v_lshlrev_b32 v4, 16, v40
  v_and_b32 v40, 0xffff0000, v40
  v_add_f32 v8, v8, v4
  v_add_f32 v9, v9, v40
  v_lshlrev_b32 v4, 16, v41
  v_and_b32 v41, 0xffff0000, v41
  v_add_f32 v10, v10, v4
  v_add_f32 v11, v11, v41
  v_lshlrev_b32 v4, 16, v42
  v_and_b32 v42, 0xffff0000, v42
  v_add_f32 v12, v12, v4
  v_add_f32 v13, v13, v42
  v_lshlrev_b32 v4, 16, v43
  v_and_b32 v43, 0xffff0000, v43
  v_add_f32 v14, v14, v4
  v_add_f32 v15, v15, v43
  v_lshlrev_b32 v4, 16, v44
  v_and_b32 v44, 0xffff0000, v44
  v_add_f32 v16, v16, v4
  v_add_f32 v17, v17, v44
  v_lshlrev_b32 v4, 16, v45
  v_and_b32 v45, 0xffff0000, v45
  v_add_f32 v18, v18, v4
  v_add_f32 v19, v19, v45
  v_lshlrev_b32 v4, 16, v46
  v_and_b32 v46, 0xffff0000, v46
  v_add_f32 v20, v20, v4
  v_add_f32 v21, v21, v46
  v_lshlrev_b32 v4, 16, v47
  v_and_b32 v47, 0xffff0000, v47
  v_add_f32 v22, v22, v4
  v_add_f32 v23, v23, v47
  v_cndmask_b32 v48, v48, v50, s[46:47]
  v_cndmask_b32 v49, v49, v51, s[46:47]
  v_lshlrev_b32 v4, 16, v48
  v_and_b32 v48, 0xffff0000, v48
  v_add_f32 v24, v24, v4
  v_add_f32 v25, v25, v48
  v_lshlrev_b32 v4, 16, v49
  v_and_b32 v49, 0xffff0000, v49
  v_add_f32 v26, v26, v4
  v_add_f32 v27, v27, v49
  buffer_load_dwordx4 v[40:43], v1, s[20:23], s37 offen sc1
  buffer_load_dwordx4 v[44:47], v1, s[20:23], s37 offen offset:1024 sc1
  buffer_load_dwordx4 v[48:51], v1, s[20:23], s36 offen sc1
  s_add_u32 s37, s37, 2359296
  s_add_u32 s36, s36, 2359296
  s_waitcnt vmcnt(6)
  v_lshlrev_b32 v4, 16, v52
  v_and_b32 v52, 0xffff0000, v52
  v_add_f32 v8, v8, v4
  v_add_f32 v9, v9, v52
  v_lshlrev_b32 v4, 16, v53
  v_and_b32 v53, 0xffff0000, v53
  v_add_f32 v10, v10, v4
  v_add_f32 v11, v11, v53
  v_lshlrev_b32 v4, 16, v54
  v_and_b32 v54, 0xffff0000, v54
  v_add_f32 v12, v12, v4
  v_add_f32 v13, v13, v54
  v_lshlrev_b32 v4, 16, v55
  v_and_b32 v55, 0xffff0000, v55
  v_add_f32 v14, v14, v4
  v_add_f32 v15, v15, v55
  v_lshlrev_b32 v4, 16, v56
  v_and_b32 v56, 0xffff0000, v56
  v_add_f32 v16, v16, v4
  v_add_f32 v17, v17, v56
  v_lshlrev_b32 v4, 16, v57
  v_and_b32 v57, 0xffff0000, v57
  v_add_f32 v18, v18, v4
  v_add_f32 v19, v19, v57
  v_lshlrev_b32 v4, 16, v58
  v_and_b32 v58, 0xffff0000, v58
  v_add_f32 v20, v20, v4
  v_add_f32 v21, v21, v58
  v_lshlrev_b32 v4, 16, v59
  v_and_b32 v59, 0xffff0000, v59
  v_add_f32 v22, v22, v4
  v_add_f32 v23, v23, v59
  v_cndmask_b32 v60, v60, v62, s[46:47]
  v_cndmask_b32 v61, v61, v63, s[46:47]
  v_lshlrev_b32 v4, 16, v60
  v_and_b32 v60, 0xffff0000, v60
  v_add_f32 v24, v24, v4
  v_add_f32 v25, v25, v60
  v_lshlrev_b32 v4, 16, v61
  v_and_b32 v61, 0xffff0000, v61
  v_add_f32 v26, v26, v4
  v_add_f32 v27, v27, v61
  buffer_load_dwordx4 v[160:163], v1, s[12:15], s42 offen offset:0
  buffer_load_dwordx4 v[164:167], v1, s[12:15], s42 offen offset:1024
  s_add_u32 s42, s42, 36864
  buffer_load_dwordx4 v[168:171], v1, s[12:15], s42 offen offset:0
  buffer_load_dwordx4 v[172:175], v1, s[12:15], s42 offen offset:1024
  s_add_u32 s42, s42, 36864
  buffer_load_dwordx4 v[176:179], v1, s[12:15], s42 offen offset:0
  buffer_load_dwordx4 v[180:183], v1, s[12:15], s42 offen offset:1024
  s_add_u32 s42, s42, 36864
  buffer_load_dwordx4 v[184:187], v1, s[12:15], s42 offen offset:0
  buffer_load_dwordx4 v[188:191], v1, s[12:15], s42 offen offset:1024
  s_add_u32 s42, s42, 36864
  s_waitcnt vmcnt(11)
  v_lshlrev_b32 v4, 16, v28
  v_and_b32 v28, 0xffff0000, v28
  v_add_f32 v8, v8, v4
  v_add_f32 v9, v9, v28
  v_lshlrev_b32 v4, 16, v29
  v_and_b32 v29, 0xffff0000, v29
  v_add_f32 v10, v10, v4
  v_add_f32 v11, v11, v29
  v_lshlrev_b32 v4, 16, v30
  v_and_b32 v30, 0xffff0000, v30
  v_add_f32 v12, v12, v4
  v_add_f32 v13, v13, v30
  v_lshlrev_b32 v4, 16, v31
  v_and_b32 v31, 0xffff0000, v31
  v_add_f32 v14, v14, v4
  v_add_f32 v15, v15, v31
  v_lshlrev_b32 v4, 16, v32
  v_and_b32 v32, 0xffff0000, v32
  v_add_f32 v16, v16, v4
  v_add_f32 v17, v17, v32
  v_lshlrev_b32 v4, 16, v33
  v_and_b32 v33, 0xffff0000, v33
  v_add_f32 v18, v18, v4
  v_add_f32 v19, v19, v33
  v_lshlrev_b32 v4, 16, v34
  v_and_b32 v34, 0xffff0000, v34
  v_add_f32 v20, v20, v4
  v_add_f32 v21, v21, v34
  v_lshlrev_b32 v4, 16, v35
  v_and_b32 v35, 0xffff0000, v35
  v_add_f32 v22, v22, v4
  v_add_f32 v23, v23, v35
  v_cndmask_b32 v36, v36, v38, s[46:47]
  v_cndmask_b32 v37, v37, v39, s[46:47]
  v_lshlrev_b32 v4, 16, v36
  v_and_b32 v36, 0xffff0000, v36
  v_add_f32 v24, v24, v4
  v_add_f32 v25, v25, v36
  v_lshlrev_b32 v4, 16, v37
  v_and_b32 v37, 0xffff0000, v37
  v_add_f32 v26, v26, v4
  v_add_f32 v27, v27, v37
  buffer_load_dwordx4 v[192:195], v1, s[12:15], s42 offen offset:0
  buffer_load_dwordx4 v[196:199], v1, s[12:15], s42 offen offset:1024
  s_add_u32 s42, s42, 36864
  buffer_load_dwordx4 v[200:203], v1, s[12:15], s42 offen offset:0
  buffer_load_dwordx4 v[204:207], v1, s[12:15], s42 offen offset:1024
  s_add_u32 s42, s42, 36864
  buffer_load_dwordx4 v[208:211], v1, s[12:15], s42 offen offset:0
  buffer_load_dwordx4 v[212:215], v1, s[12:15], s42 offen offset:1024
  s_add_u32 s42, s42, 36864
  buffer_load_dwordx4 v[216:219], v1, s[12:15], s42 offen offset:0
  buffer_load_dwordx4 v[220:223], v1, s[12:15], s42 offen offset:1024
  s_add_u32 s42, s42, 36864
  s_waitcnt vmcnt(16)
  v_lshlrev_b32 v4, 16, v40
  v_and_b32 v40, 0xffff0000, v40
  v_add_f32 v8, v8, v4
  v_add_f32 v9, v9, v40
  v_lshlrev_b32 v4, 16, v41
  v_and_b32 v41, 0xffff0000, v41
  v_add_f32 v10, v10, v4
  v_add_f32 v11, v11, v41
  v_lshlrev_b32 v4, 16, v42
  v_and_b32 v42, 0xffff0000, v42
  v_add_f32 v12, v12, v4
  v_add_f32 v13, v13, v42
  v_lshlrev_b32 v4, 16, v43
  v_and_b32 v43, 0xffff0000, v43
  v_add_f32 v14, v14, v4
  v_add_f32 v15, v15, v43
  v_lshlrev_b32 v4, 16, v44
  v_and_b32 v44, 0xffff0000, v44
  v_add_f32 v16, v16, v4
  v_add_f32 v17, v17, v44
  v_lshlrev_b32 v4, 16, v45
  v_and_b32 v45, 0xffff0000, v45
  v_add_f32 v18, v18, v4
  v_add_f32 v19, v19, v45
  v_lshlrev_b32 v4, 16, v46
  v_and_b32 v46, 0xffff0000, v46
  v_add_f32 v20, v20, v4
  v_add_f32 v21, v21, v46
  v_lshlrev_b32 v4, 16, v47
  v_and_b32 v47, 0xffff0000, v47
  v_add_f32 v22, v22, v4
  v_add_f32 v23, v23, v47
  v_cndmask_b32 v48, v48, v50, s[46:47]
  v_cndmask_b32 v49, v49, v51, s[46:47]
  v_lshlrev_b32 v4, 16, v48
  v_and_b32 v48, 0xffff0000, v48
  v_add_f32 v24, v24, v4
  v_add_f32 v25, v25, v48
  v_lshlrev_b32 v4, 16, v49
  v_and_b32 v49, 0xffff0000, v49
  v_add_f32 v26, v26, v4
  v_add_f32 v27, v27, v49
  buffer_load_dwordx4 v[224:227], v1, s[12:15], s42 offen offset:0
  buffer_load_dwordx4 v[228:231], v1, s[12:15], s42 offen offset:1024
  s_add_u32 s42, s42, 36864
  buffer_load_dwordx4 v[232:235], v1, s[12:15], s42 offen offset:0
  buffer_load_dwordx4 v[236:239], v1, s[12:15], s42 offen offset:1024
  s_add_u32 s42, s42, 36864
  buffer_load_dwordx4 v[240:243], v1, s[12:15], s42 offen offset:0
  buffer_load_dwordx4 v[244:247], v1, s[12:15], s42 offen offset:1024
  s_add_u32 s42, s42, 36864
  buffer_load_dwordx4 v[248:251], v1, s[12:15], s42 offen offset:0
  buffer_load_dwordx4 v[252:255], v1, s[12:15], s42 offen offset:1024
  s_add_u32 s42, s42, 36864
  s_lshr_b32 s36, s33, 3
  s_lshl_b32 s36, s36, 3
  s_and_b32 s37, s2, 7
  s_add_u32 s36, s36, s37
  s_cmp_lg_u32 s32, 0
  s_cbranch_scc1 L_f_goo
  s_lshl_b32 s35, s36, 7
  s_add_u32 s35, s35, 50216960
  v_mov_b32 v6, s35
  s_mov_b32 s41, 0x4000
L_f_spino:
  global_load_dword v4, v6, s[4:5] sc1
  s_waitcnt vmcnt(0)
  v_readfirstlane_b32 s35, v4
  s_nop 3
  s_cmp_ge_u32 s35, 32
  s_cbranch_scc1 L_f_goo
  s_sleep 2
  s_sub_u32 s41, s41, 1
  s_cmp_lg_u32 s41, 0
  s_cbranch_scc1 L_f_spino
L_f_goo:
  s_barrier
  s_mul_i32 s35, s33, 36864
  s_add_u32 s35, s35, s39
  buffer_load_dwordx4 v[28:31], v1, s[16:19], s35 offen sc1
  s_add_u32 s35, s35, 4096
  buffer_load_dwordx4 v[32:35], v1, s[16:19], s35 offen sc1
  s_add_u32 s35, s35, 4096
  buffer_load_dwordx4 v[36:39], v1, s[16:19], s35 offen sc1
  s_add_u32 s35, s35, 4096
  buffer_load_dwordx4 v[40:43], v1, s[16:19], s35 offen sc1
  s_add_u32 s35, s35, 4096
  buffer_load_dwordx4 v[44:47], v1, s[16:19], s35 offen sc1
  s_add_u32 s35, s35, 4096
  buffer_load_dwordx4 v[48:51], v1, s[16:19], s35 offen sc1
  s_add_u32 s35, s35, 4096
  buffer_load_dwordx4 v[52:55], v1, s[16:19], s35 offen sc1
  s_add_u32 s35, s35, 4096
  buffer_load_dwordx4 v[56:59], v1, s[16:19], s35 offen sc1
  s_add_u32 s35, s35, 4096
  buffer_load_dwordx4 v[60:63], v1, s[16:19], s35 offen sc1
  s_add_u32 s35, s35, 4096
  v_add_u32 v4, s39, v1
  s_waitcnt vmcnt(8)
  ds_write_b128 v4, v[28:31] offset:0
  s_waitcnt vmcnt(7)
  ds_write_b128 v4, v[32:35] offset:4096
  s_waitcnt vmcnt(6)
  ds_write_b128 v4, v[36:39] offset:8192
  s_waitcnt vmcnt(5)
  ds_write_b128 v4, v[40:43] offset:12288
  s_waitcnt vmcnt(4)
  ds_write_b128 v4, v[44:47] offset:16384
  s_waitcnt vmcnt(3)
  ds_write_b128 v4, v[48:51] offset:20480
  s_waitcnt vmcnt(2)
  ds_write_b128 v4, v[52:55] offset:24576
  s_waitcnt vmcnt(1)
  ds_write_b128 v4, v[56:59] offset:28672
  s_waitcnt vmcnt(0)
  ds_write_b128 v4, v[60:63] offset:32768
  s_waitcnt lgkmcnt(0)
  s_barrier
  s_lshl_b32 s35, s40, 10
  v_add_u32 v6, s35, v1
  ds_read_b128 v[64:67], v1 offset:0
  ds_read_b128 v[68:71], v1 offset:1024
  ds_read_b128 v[88:91], v1 offset:36864
  ds_read_b128 v[92:95], v6 offset:0
  ds_read_b128 v[72:75], v1 offset:2048
  ds_read_b128 v[76:79], v1 offset:3072
  ds_read_b128 v[96:99], v1 offset:37888
  ds_read_b128 v[100:103], v6 offset:2048
  s_waitcnt lgkmcnt(4)
  v_mfma_f32_16x16x32_bf16 v[8:11], v[112:115], v[64:67], v[8:11]
  v_mfma_f32_16x16x32_bf16 v[12:15], v[112:115], v[68:71], v[12:15]
  v_mfma_f32_16x16x32_bf16 v[16:19], v[116:119], v[64:67], v[16:19]
  v_mfma_f32_16x16x32_bf16 v[20:23], v[116:119], v[68:71], v[20:23]
  v_mfma_f32_16x16x32_bf16 v[24:27], v[88:91], v[92:95], v[24:27]
  ds_read_b128 v[80:83], v1 offset:4096
  ds_read_b128 v[84:87], v1 offset:5120
  ds_read_b128 v[104:107], v1 offset:38912
  ds_read_b128 v[108:111], v6 offset:4096
  s_waitcnt lgkmcnt(4)
  v_mfma_f32_16x16x32_bf16 v[8:11], v[120:123], v[72:75], v[8:11]
  v_mfma_f32_16x16x32_bf16 v[12:15], v[120:123], v[76:79], v[12:15]
  v_mfma_f32_16x16x32_bf16 v[16:19], v[124:127], v[72:75], v[16:19]
  v_mfma_f32_16x16x32_bf16 v[20:23], v[124:127], v[76:79], v[20:23]
  v_mfma_f32_16x16x32_bf16 v[24:27], v[96:99], v[100:103], v[24:27]
  ds_read_b128 v[64:67], v1 offset:6144
  ds_read_b128 v[68:71], v1 offset:7168
  ds_read_b128 v[88:91], v1 offset:39936
  ds_read_b128 v[92:95], v6 offset:6144
  s_waitcnt lgkmcnt(4)
  v_mfma_f32_16x16x32_bf16 v[8:11], v[128:131], v[80:83], v[8:11]
  v_mfma_f32_16x16x32_bf16 v[12:15], v[128:131], v[84:87], v[12:15]
  v_mfma_f32_16x16x32_bf16 v[16:19], v[132:135], v[80:83], v[16:19]
  v_mfma_f32_16x16x32_bf16 v[20:23], v[132:135], v[84:87], v[20:23]
  v_mfma_f32_16x16x32_bf16 v[24:27], v[104:107], v[108:111], v[24:27]
  ds_read_b128 v[72:75], v1 offset:8192
  ds_read_b128 v[76:79], v1 offset:9216
  ds_read_b128 v[96:99], v1 offset:40960
  ds_read_b128 v[100:103], v6 offset:8192
  s_add_u32 s35, s32, 0
  s_lshl_b32 s35, s35, 6
  v_add_u32 v4, s35, v0
  v_mul_u32_u24 v5, 3641, v4
  v_lshrrev_b32 v5, 16, v5
  v_mul_u32_u24 v5, 864, v5
  v_lshl_add_u32 v40, v4, 4, v5
  v_lshlrev_b32 v43, 4, v4
  s_waitcnt lgkmcnt(4)
  v_mfma_f32_16x16x32_bf16 v[8:11], v[136:139], v[64:67], v[8:11]
  v_mfma_f32_16x16x32_bf16 v[12:15], v[136:139], v[68:71], v[12:15]
  v_mfma_f32_16x16x32_bf16 v[16:19], v[140:143], v[64:67], v[16:19]
  v_mfma_f32_16x16x32_bf16 v[20:23], v[140:143], v[68:71], v[20:23]
  v_mfma_f32_16x16x32_bf16 v[24:27], v[88:91], v[92:95], v[24:27]
  ds_read_b128 v[80:83], v1 offset:10240
  ds_read_b128 v[84:87], v1 offset:11264
  ds_read_b128 v[104:107], v1 offset:41984
  ds_read_b128 v[108:111], v6 offset:10240
  s_waitcnt lgkmcnt(4)
  v_mfma_f32_16x16x32_bf16 v[8:11], v[144:147], v[72:75], v[8:11]
  v_mfma_f32_16x16x32_bf16 v[12:15], v[144:147], v[76:79], v[12:15]
  v_mfma_f32_16x16x32_bf16 v[16:19], v[148:151], v[72:75], v[16:19]
  v_mfma_f32_16x16x32_bf16 v[20:23], v[148:151], v[76:79], v[20:23]
  v_mfma_f32_16x16x32_bf16 v[24:27], v[96:99], v[100:103], v[24:27]
  ds_read_b128 v[64:67], v1 offset:12288
  ds_read_b128 v[68:71], v1 offset:13312
  ds_read_b128 v[88:91], v1 offset:43008
  ds_read_b128 v[92:95], v6 offset:12288
  s_waitcnt lgkmcnt(4)
  v_mfma_f32_16x16x32_bf16 v[8:11], v[152:155], v[80:83], v[8:11]
  v_mfma_f32_16x16x32_bf16 v[12:15], v[152:155], v[84:87], v[12:15]
  v_mfma_f32_16x16x32_bf16 v[16:19], v[156:159], v[80:83], v[16:19]
  v_mfma_f32_16x16x32_bf16 v[20:23], v[156:159], v[84:87], v[20:23]
  v_mfma_f32_16x16x32_bf16 v[24:27], v[104:107], v[108:111], v[24:27]
  ds_read_b128 v[72:75], v1 offset:14336
  ds_read_b128 v[76:79], v1 offset:15360
  ds_read_b128 v[96:99], v1 offset:44032
  ds_read_b128 v[100:103], v6 offset:14336
  s_add_u32 s35, s32, 4
  s_lshl_b32 s35, s35, 6
  v_add_u32 v4, s35, v0
  v_mul_u32_u24 v5, 3641, v4
  v_lshrrev_b32 v5, 16, v5
  v_mul_u32_u24 v5, 864, v5
  v_lshl_add_u32 v41, v4, 4, v5
  v_lshlrev_b32 v44, 4, v4
  s_waitcnt lgkmcnt(4)
  v_mfma_f32_16x16x32_bf16 v[8:11], v[160:163], v[64:67], v[8:11]
  v_mfma_f32_16x16x32_bf16 v[12:15], v[160:163], v[68:71], v[12:15]
  v_mfma_f32_16x16x32_bf16 v[16:19], v[164:167], v[64:67], v[16:19]
  v_mfma_f32_16x16x32_bf16 v[20:23], v[164:167], v[68:71], v[20:23]
  v_mfma_f32_16x16x32_bf16 v[24:27], v[88:91], v[92:95], v[24:27]
  ds_read_b128 v[80:83], v1 offset:16384
  ds_read_b128 v[84:87], v1 offset:17408
  ds_read_b128 v[104:107], v1 offset:45056
  ds_read_b128 v[108:111], v6 offset:16384
  s_waitcnt lgkmcnt(4)
  v_mfma_f32_16x16x32_bf16 v[8:11], v[168:171], v[72:75], v[8:11]
  v_mfma_f32_16x16x32_bf16 v[12:15], v[168:171], v[76:79], v[12:15]
  v_mfma_f32_16x16x32_bf16 v[16:19], v[172:175], v[72:75], v[16:19]
  v_mfma_f32_16x16x32_bf16 v[20:23], v[172:175], v[76:79], v[20:23]
  v_mfma_f32_16x16x32_bf16 v[24:27], v[96:99], v[100:103], v[24:27]
  ds_read_b128 v[64:67], v1 offset:18432
  ds_read_b128 v[68:71], v1 offset:19456
  ds_read_b128 v[88:91], v1 offset:46080
  ds_read_b128 v[92:95], v6 offset:18432
  s_waitcnt lgkmcnt(4)
  v_mfma_f32_16x16x32_bf16 v[8:11], v[176:179], v[80:83], v[8:11]
  v_mfma_f32_16x16x32_bf16 v[12:15], v[176:179], v[84:87], v[12:15]
  v_mfma_f32_16x16x32_bf16 v[16:19], v[180:183], v[80:83], v[16:19]
  v_mfma_f32_16x16x32_bf16 v[20:23], v[180:183], v[84:87], v[20:23]
  v_mfma_f32_16x16x32_bf16 v[24:27], v[104:107], v[108:111], v[24:27]
  ds_read_b128 v[72:75], v1 offset:20480
  ds_read_b128 v[76:79], v1 offset:21504
  ds_read_b128 v[96:99], v1 offset:47104
  ds_read_b128 v[100:103], v6 offset:20480
  s_add_u32 s35, s32, 8
  s_lshl_b32 s35, s35, 6
  v_add_u32 v4, s35, v0
  v_mul_u32_u24 v5, 3641, v4
  v_lshrrev_b32 v5, 16, v5
  v_mul_u32_u24 v5, 864, v5
  v_lshl_add_u32 v42, v4, 4, v5
  v_cmp_gt_u32 vcc, 576, v4
  v_mov_b32 v5, 0x7f000000
  s_nop 0
  v_cndmask_b32 v42, v5, v42, vcc
  v_lshlrev_b32 v45, 4, v4
  s_waitcnt lgkmcnt(4)
  v_mfma_f32_16x16x32_bf16 v[8:11], v[184:187], v[64:67], v[8:11]
  v_mfma_f32_16x16x32_bf16 v[12:15], v[184:187], v[68:71], v[12:15]
  v_mfma_f32_16x16x32_bf16 v[16:19], v[188:191], v[64:67], v[16:19]
  v_mfma_f32_16x16x32_bf16 v[20:23], v[188:191], v[68:71], v[20:23]
  v_mfma_f32_16x16x32_bf16 v[24:27], v[88:91], v[92:95], v[24:27]
  ds_read_b128 v[80:83], v1 offset:22528
  ds_read_b128 v[84:87], v1 offset:23552
  ds_read_b128 v[104:107], v1 offset:48128
  ds_read_b128 v[108:111], v6 offset:22528
  s_waitcnt lgkmcnt(4)
  v_mfma_f32_16x16x32_bf16 v[8:11], v[192:195], v[72:75], v[8:11]
  v_mfma_f32_16x16x32_bf16 v[12:15], v[192:195], v[76:79], v[12:15]
  v_mfma_f32_16x16x32_bf16 v[16:19], v[196:199], v[72:75], v[16:19]
  v_mfma_f32_16x16x32_bf16 v[20:23], v[196:199], v[76:79], v[20:23]
  v_mfma_f32_16x16x32_bf16 v[24:27], v[96:99], v[100:103], v[24:27]
  ds_read_b128 v[64:67], v1 offset:24576
  ds_read_b128 v[68:71], v1 offset:25600
  ds_read_b128 v[88:91], v1 offset:49152
  ds_read_b128 v[92:95], v6 offset:24576
  s_waitcnt lgkmcnt(4)
  v_mfma_f32_16x16x32_bf16 v[8:11], v[200:203], v[80:83], v[8:11]
  v_mfma_f32_16x16x32_bf16 v[12:15], v[200:203], v[84:87], v[12:15]
  v_mfma_f32_16x16x32_bf16 v[16:19], v[204:207], v[80:83], v[16:19]
  v_mfma_f32_16x16x32_bf16 v[20:23], v[204:207], v[84:87], v[20:23]
  v_mfma_f32_16x16x32_bf16 v[24:27], v[104:107], v[108:111], v[24:27]
  ds_read_b128 v[72:75], v1 offset:26624
  ds_read_b128 v[76:79], v1 offset:27648
  ds_read_b128 v[96:99], v1 offset:50176
  ds_read_b128 v[100:103], v6 offset:26624
  s_waitcnt lgkmcnt(4)
  v_mfma_f32_16x16x32_bf16 v[8:11], v[208:211], v[64:67], v[8:11]
  v_mfma_f32_16x16x32_bf16 v[12:15], v[208:211], v[68:71], v[12:15]
  v_mfma_f32_16x16x32_bf16 v[16:19], v[212:215], v[64:67], v[16:19]
  v_mfma_f32_16x16x32_bf16 v[20:23], v[212:215], v[68:71], v[20:23]
  v_mfma_f32_16x16x32_bf16 v[24:27], v[88:91], v[92:95], v[24:27]
  ds_read_b128 v[80:83], v1 offset:28672
  ds_read_b128 v[84:87], v1 offset:29696
  ds_read_b128 v[104:107], v1 offset:51200
  ds_read_b128 v[108:111], v6 offset:28672
  s_waitcnt lgkmcnt(4)
  v_mfma_f32_16x16x32_bf16 v[8:11], v[216:219], v[72:75], v[8:11]
  v_mfma_f32_16x16x32_bf16 v[12:15], v[216:219], v[76:79], v[12:15]
  v_mfma_f32_16x16x32_bf16 v[16:19], v[220:223], v[72:75], v[16:19]
  v_mfma_f32_16x16x32_bf16 v[20:23], v[220:223], v[76:79], v[20:23]
  v_mfma_f32_16x16x32_bf16 v[24:27], v[96:99], v[100:103], v[24:27]
  ds_read_b128 v[64:67], v1 offset:30720
  ds_read_b128 v[68:71], v1 offset:31744
  ds_read_b128 v[88:91], v1 offset:52224
  ds_read_b128 v[92:95], v6 offset:30720
  s_waitcnt lgkmcnt(4)
  v_mfma_f32_16x16x32_bf16 v[8:11], v[224:227], v[80:83], v[8:11]
  v_mfma_f32_16x16x32_bf16 v[12:15], v[224:227], v[84:87], v[12:15]
  v_mfma_f32_16x16x32_bf16 v[16:19], v[228:231], v[80:83], v[16:19]
  v_mfma_f32_16x16x32_bf16 v[20:23], v[228:231], v[84:87], v[20:23]
  v_mfma_f32_16x16x32_bf16 v[24:27], v[104:107], v[108:111], v[24:27]
  ds_read_b128 v[72:75], v1 offset:32768
  ds_read_b128 v[76:79], v1 offset:33792
  ds_read_b128 v[96:99], v1 offset:53248
  ds_read_b128 v[100:103], v6 offset:32768
  s_waitcnt lgkmcnt(4)
  v_mfma_f32_16x16x32_bf16 v[8:11], v[232:235], v[64:67], v[8:11]
  v_mfma_f32_16x16x32_bf16 v[12:15], v[232:235], v[68:71], v[12:15]
  v_mfma_f32_16x16x32_bf16 v[16:19], v[236:239], v[64:67], v[16:19]
  v_mfma_f32_16x16x32_bf16 v[20:23], v[236:239], v[68:71], v[20:23]
  v_mfma_f32_16x16x32_bf16 v[24:27], v[88:91], v[92:95], v[24:27]
  ds_read_b128 v[80:83], v1 offset:34816
  ds_read_b128 v[84:87], v1 offset:35840
  ds_read_b128 v[104:107], v1 offset:54272
  ds_read_b128 v[108:111], v6 offset:34816
  s_waitcnt lgkmcnt(4)
  v_mfma_f32_16x16x32_bf16 v[8:11], v[240:243], v[72:75], v[8:11]
  v_mfma_f32_16x16x32_bf16 v[12:15], v[240:243], v[76:79], v[12:15]
  v_mfma_f32_16x16x32_bf16 v[16:19], v[244:247], v[72:75], v[16:19]
  v_mfma_f32_16x16x32_bf16 v[20:23], v[244:247], v[76:79], v[20:23]
  v_mfma_f32_16x16x32_bf16 v[24:27], v[96:99], v[100:103], v[24:27]
  s_waitcnt lgkmcnt(0)
  v_mfma_f32_16x16x32_bf16 v[8:11], v[248:251], v[80:83], v[8:11]
  v_mfma_f32_16x16x32_bf16 v[12:15], v[248:251], v[84:87], v[12:15]
  v_mfma_f32_16x16x32_bf16 v[16:19], v[252:255], v[80:83], v[16:19]
  v_mfma_f32_16x16x32_bf16 v[20:23], v[252:255], v[84:87], v[20:23]
  v_mfma_f32_16x16x32_bf16 v[24:27], v[104:107], v[108:111], v[24:27]
  s_nop 7
  v_cvt_pk_bf16_f32 v28, v8, v9
  v_cvt_pk_bf16_f32 v29, v10, v11
  v_cvt_pk_bf16_f32 v30, v12, v13
  v_cvt_pk_bf16_f32 v31, v14, v15
  v_cvt_pk_bf16_f32 v32, v16, v17
  v_cvt_pk_bf16_f32 v33, v18, v19
  v_cvt_pk_bf16_f32 v34, v20, v21
  v_cvt_pk_bf16_f32 v35, v22, v23
  v_cvt_pk_bf16_f32 v36, v24, v25
  v_cvt_pk_bf16_f32 v37, v26, v27
  s_lshl_b32 s35, s32, 6
  v_add_u32 v4, s35, v2
  ds_write_b64 v4, v[28:29] offset:0
  ds_write_b64 v4, v[30:31] offset:4608
  ds_write_b64 v4, v[32:33] offset:32
  ds_write_b64 v4, v[34:35] offset:4640
  s_cmp_lt_u32 s32, 2
  s_cbranch_scc0 L_f_no9
  s_mul_i32 s35, s40, 4608
  v_add_u32 v5, s35, v2
  ds_write_b64 v5, v[36:37] offset:256
L_f_no9:
  s_waitcnt lgkmcnt(0)
  s_barrier
  ds_read_b128 v[64:67], v43 offset:57344
  ds_read_b128 v[68:71], v44 offset:57344
  ds_read_b128 v[72:75], v45 offset:57344
  s_waitcnt lgkmcnt(2)
  buffer_store_dwordx4 v[64:67], v40, s[28:31], s43 offen
  s_waitcnt lgkmcnt(1)
  buffer_store_dwordx4 v[68:71], v41, s[28:31], s43 offen
  s_waitcnt lgkmcnt(0)
  buffer_store_dwordx4 v[72:75], v42, s[28:31], s43 offen
L_mix_done:
L_mix_end:
  s_endpgm

.section .rodata,"a"
.p2align 6
.amdhsa_kernel mix_kernel
  .amdhsa_next_free_vgpr 256
  .amdhsa_next_free_sgpr 100
  .amdhsa_accum_offset 256
  .amdhsa_group_segment_fixed_size 0
  .amdhsa_kernarg_size 80
  .amdhsa_user_sgpr_count 2
  .amdhsa_user_sgpr_kernarg_segment_ptr 1
  .amdhsa_system_sgpr_workgroup_id_x 1
.end_amdhsa_kernel
```
